```python
import torch

def _softmax(x, axis=-1):
    return torch.softmax(x, dim=axis)

def _gelu(x):
    return torch.nn.functional.gelu(x, approximate='tanh')

def _silu(x):
    return torch.nn.functional.silu(x)

def _sigmoid(x):
    return torch.sigmoid(x)

def _layernorm(x, axis=-1, eps=1e-05):
    m = x.mean(dim=axis, keepdim=True)
    v = x.var(dim=axis, keepdim=True, unbiased=False)
    return (x - m) / torch.sqrt(v + eps)

def _scatter_add(tgt, idx, src, axis=0):
    return tgt.clone().index_add_(axis, idx, src)

def _segment_sum(src, seg, n):
    out = torch.zeros((n,) + src.shape[1:], dtype=src.dtype)
    return out.index_add_(0, seg, src)

def _pad(x, pw):
    flat = tuple((v for pair in reversed(pw) for v in pair))
    return torch.nn.functional.pad(x, flat)
kernel_name = 'parallel_sum__memory_aug_recurrent_mem_tr__glu_gated_geglu__prompt'

def setup_inputs():

    _w = lambda a: (lambda t: t.to(torch.bfloat16) if t.is_floating_point() else t)(torch.as_tensor(a))

    def _A_setup():
        B, S, Dm = (1, 2048, 512)
        H, Dh = (32, 128)
        M, seg = (8, 32)
        seg = min(seg, S)
        S = S // seg * seg
        return {'x': _w((lambda *s: torch.randn(*s, dtype=torch.bfloat16) * 0.05)(B, S, Dm)), 'mem0': _w((lambda *s: torch.randn(*s, dtype=torch.bfloat16) * 0.2)(B, M, Dm)), 'Wq': _w((lambda *s: torch.randn(*s, dtype=torch.bfloat16) * 1.6)(Dm, H, Dh) * Dm ** (-0.5)), 'Wk': _w((lambda *s: torch.randn(*s, dtype=torch.bfloat16) * 1.6)(Dm, H, Dh) * Dm ** (-0.5)), 'Wv': _w((lambda *s: torch.randn(*s, dtype=torch.bfloat16) * 0.2)(Dm, H, Dh) * Dm ** (-0.5)), 'Wo': _w((lambda *s: torch.randn(*s, dtype=torch.bfloat16) * 0.2)(H, Dh, Dm) * (H * Dh) ** (-0.5)), 'seg_len': seg}
    _A_in = _A_setup()

    def _B_setup():
        B, S, Dm, Df = (1, 2048, 512, 1792)
        return {'x': _w((lambda *s: torch.randn(*s, dtype=torch.bfloat16) * 0.05)(B, S, Dm)), 'w_gate': _w((lambda *s: torch.randn(*s, dtype=torch.bfloat16) * 0.4)(Dm, Df) * Dm ** (-0.5)), 'w_up': _w((lambda *s: torch.randn(*s, dtype=torch.bfloat16) * 0.4)(Dm, Df) * Dm ** (-0.5)), 'w_down': _w((lambda *s: torch.randn(*s, dtype=torch.bfloat16) * 0.4)(Df, Dm) * Df ** (-0.5))}
    _B_in = _B_setup()
    return {'A_x': _A_in['x'], 'A_mem0': _A_in['mem0'], 'A_Wq': _A_in['Wq'], 'A_Wk': _A_in['Wk'], 'A_Wv': _A_in['Wv'], 'A_Wo': _A_in['Wo'], 'A_seg_len': _A_in['seg_len'], 'B_x': _B_in['x'], 'B_w_gate': _B_in['w_gate'], 'B_w_up': _B_in['w_up'], 'B_w_down': _B_in['w_down']}

def reference(A_x, A_mem0, A_Wq, A_Wk, A_Wv, A_Wo, A_seg_len, B_x, B_w_gate, B_w_up, B_w_down):

    def _A_ref(x, mem0, Wq, Wk, Wv, Wo, seg_len):
        B, S, Dm = x.shape
        H, Dh = (Wq.shape[1], Wq.shape[2])
        M = mem0.shape[1]
        scale = Dh ** (-0.5)
        n_seg = S // seg_len
        L = M + seg_len
        idx = torch.arange(L)
        mask = (idx[:, None] < M) | (idx[:, None] >= idx[None, :])
        mem = mem0
        outs = []
        for s in range(n_seg):
            xs = x[:, s * seg_len:(s + 1) * seg_len, :].clone()
            h = torch.concatenate([mem, xs], axis=1)
            q = torch.einsum('btd,dhe->bhte', h, Wq)
            k = torch.einsum('btd,dhe->bhte', h, Wk)
            v = torch.einsum('btd,dhe->bhte', h, Wv)
            scores = torch.einsum('bhqe,bhke->bhqk', q, k) * scale
            scores = torch.where(mask[None, None], scores, -1000000000.0)
            p = _softmax(scores, axis=-1)
            o = torch.einsum('bhqk,bhke->bhqe', p, v)
            o = torch.einsum('bhte,hed->btd', o, Wo)
            mem = o[:, :M, :].clone()
            outs.append(o[:, M:, :])
        return torch.concatenate(outs, axis=1)

    def _B_ref(x, w_gate, w_up, w_down):
        g = torch.einsum('bsd,df->bsf', x, w_gate)
        u = torch.einsum('bsd,df->bsf', x, w_up)
        h = _gelu(g) * u
        return torch.einsum('bsf,fd->bsd', h, w_down)
    x = A_x
    xn = _layernorm(x, axis=-1)
    return x + _A_ref(xn, A_mem0, A_Wq, A_Wk, A_Wv, A_Wo, A_seg_len) + _B_ref(xn, B_w_gate, B_w_up, B_w_down)
```

```asm
; @launch grid=(256,1,1) block=(256,1,1) lds=162560
.amdgcn_target "amdgcn-amd-amdhsa--gfx950"
.text
.globl parallel_sum__memory_aug_recurrent_mem_tr__glu_gated_geglu__prompt_kernel
.p2align 8
.type parallel_sum__memory_aug_recurrent_mem_tr__glu_gated_geglu__prompt_kernel,@function
parallel_sum__memory_aug_recurrent_mem_tr__glu_gated_geglu__prompt_kernel:
    s_cmp_ge_u32 s2, 256
    s_cbranch_scc1 Lm_exit
    s_getreg_b32 s101, hwreg(HW_REG_XCC_ID)
    s_and_b32 s101, s101, 15
    s_load_dwordx2 s[6:7], s[0:1], 104
    s_load_dwordx2 s[78:79], s[0:1], 96
    s_load_dwordx2 s[4:5], s[0:1], 0
    s_memrealtime s[92:93]
    v_lshrrev_b32 v1, 6, v0
    v_mov_b32 v253, v0
    v_readfirstlane_b32 s3, v1
    s_waitcnt lgkmcnt(0)
    s_mov_b32 s100, s92
    s_mov_b32 s8, s6
    s_and_b32 s9, s7, 0xffff
    s_mov_b32 s10, 268435456
    s_mov_b32 s11, 0x20000
    s_mov_b32 s16, s78
    s_and_b32 s17, s79, 0xffff
    s_mov_b32 s18, 256
    s_mov_b32 s19, 0x20000
    s_mov_b32 s12, s4
    s_and_b32 s13, s5, 0xffff
    s_mov_b32 s14, 2097152
    s_mov_b32 s15, 0x20000
    s_mov_b32 s93, s101
    s_cmp_lt_u32 s2, 0
    s_cselect_b32 s95, 3, 255
    s_cmp_gt_u32 s101, 2
    s_cselect_b32 s93, s95, s93
    s_mul_i32 s96, s93, 12
    s_add_u32 s96, s96, 0
    s_add_u32 s90, s101, 2
    s_cmp_ge_u32 s90, 5
    s_cselect_b32 s95, 5, 0
    s_sub_u32 s90, s90, s95
    s_cmp_ge_u32 s90, 5
    s_cselect_b32 s95, 5, 0
    s_sub_u32 s90, s90, s95
    s_cmp_ge_u32 s90, 5
    s_cselect_b32 s95, 5, 0
    s_sub_u32 s90, s90, s95
    s_mov_b32 s42, s90
    s_mov_b32 s43, 0
    s_lshl_b32 s95, s42, 2
    s_add_u32 s95, s95, 40
    s_cmp_eq_u32 s93, 255
    s_cselect_b32 s96, s95, s96
    s_lshl_b32 s20, s2, 3
    s_add_u32 s20, s20, 131072000
    s_lshr_b32 s21, s2, 4
    s_lshl_b32 s21, s21, 7
    s_add_u32 s21, s21, 131076096
    v_mov_b32 v48, 0
    v_mov_b32 v49, 0
    s_mov_b64 exec, 1
    buffer_store_dwordx2 v[48:49], off, s[8:11], s20 sc1
    buffer_store_dwordx2 v[48:49], off, s[8:11], s20 offset:2048 sc1
    buffer_store_dword v48, off, s[8:11], s21 sc1
    s_mov_b64 exec, -1
    v_mov_b32 v252, 1
    s_cmp_lg_u32 s3, 1
    s_cbranch_scc1 Lm_e0
    s_cmp_eq_u32 s93, 255
    s_cbranch_scc1 Lm_e0
    s_mov_b64 exec, 1
    buffer_atomic_add v252, off, s[16:19], s96 sc0
    s_mov_b64 exec, -1
Lm_e0:
    v_lshrrev_b32 v1, 5, v0
    s_lshl_b32 s20, s2, 3
    v_add_u32 v1, s20, v1
    v_and_b32 v2, 31, v0
    v_lshlrev_b32 v3, 10, v1
    v_lshl_add_u32 v3, v2, 4, v3
    buffer_load_dwordx4 v[4:7], v3, s[12:15], 0 offen
    buffer_load_dwordx4 v[8:11], v3, s[12:15], 0 offen offset:512
    v_lshrrev_b32 v12, 4, v1
    v_lshrrev_b32 v13, 2, v2
    v_lshl_add_u32 v12, v12, 4, v13
    v_and_b32 v13, 3, v2
    v_lshl_add_u32 v12, v12, 2, v13
    v_and_b32 v13, 15, v1
    v_lshl_add_u32 v12, v12, 4, v13
    v_lshlrev_b32 v12, 4, v12
    v_add_u32 v13, 8192, v12
    s_waitcnt vmcnt(1)
    v_lshlrev_b32 v16, 16, v4
    v_and_b32 v17, 0xffff0000, v4
    v_lshlrev_b32 v18, 16, v5
    v_and_b32 v19, 0xffff0000, v5
    v_lshlrev_b32 v20, 16, v6
    v_and_b32 v21, 0xffff0000, v6
    v_lshlrev_b32 v22, 16, v7
    v_and_b32 v23, 0xffff0000, v7
    s_waitcnt vmcnt(0)
    v_lshlrev_b32 v24, 16, v8
    v_and_b32 v25, 0xffff0000, v8
    v_lshlrev_b32 v26, 16, v9
    v_and_b32 v27, 0xffff0000, v9
    v_lshlrev_b32 v28, 16, v10
    v_and_b32 v29, 0xffff0000, v10
    v_lshlrev_b32 v30, 16, v11
    v_and_b32 v31, 0xffff0000, v11
    v_add_f32 v32, v16, v17
    v_add_f32 v32, v32, v18
    v_add_f32 v32, v32, v19
    v_add_f32 v32, v32, v20
    v_add_f32 v32, v32, v21
    v_add_f32 v32, v32, v22
    v_add_f32 v32, v32, v23
    v_add_f32 v32, v32, v24
    v_add_f32 v32, v32, v25
    v_add_f32 v32, v32, v26
    v_add_f32 v32, v32, v27
    v_add_f32 v32, v32, v28
    v_add_f32 v32, v32, v29
    v_add_f32 v32, v32, v30
    v_add_f32 v32, v32, v31
    s_nop 1
    v_add_f32_dpp v32, v32, v32 row_ror:8 row_mask:0xf bank_mask:0xf
    s_nop 1
    v_add_f32_dpp v32, v32, v32 row_ror:4 row_mask:0xf bank_mask:0xf
    s_nop 1
    v_add_f32_dpp v32, v32, v32 row_ror:2 row_mask:0xf bank_mask:0xf
    s_nop 1
    v_add_f32_dpp v32, v32, v32 row_ror:1 row_mask:0xf bank_mask:0xf
    v_mov_b32 v33, v32
    s_nop 1
    v_permlane16_swap_b32 v32, v33
    v_add_f32 v32, v32, v33
    v_mul_f32 v32, 0x3b000000, v32
    v_sub_f32 v34, v16, v32
    v_mul_f32 v35, v34, v34
    v_sub_f32 v34, v17, v32
    v_fmac_f32 v35, v34, v34
    v_sub_f32 v34, v18, v32
    v_fmac_f32 v35, v34, v34
    v_sub_f32 v34, v19, v32
    v_fmac_f32 v35, v34, v34
    v_sub_f32 v34, v20, v32
    v_fmac_f32 v35, v34, v34
    v_sub_f32 v34, v21, v32
    v_fmac_f32 v35, v34, v34
    v_sub_f32 v34, v22, v32
    v_fmac_f32 v35, v34, v34
    v_sub_f32 v34, v23, v32
    v_fmac_f32 v35, v34, v34
    v_sub_f32 v34, v24, v32
    v_fmac_f32 v35, v34, v34
    v_sub_f32 v34, v25, v32
    v_fmac_f32 v35, v34, v34
    v_sub_f32 v34, v26, v32
    v_fmac_f32 v35, v34, v34
    v_sub_f32 v34, v27, v32
    v_fmac_f32 v35, v34, v34
    v_sub_f32 v34, v28, v32
    v_fmac_f32 v35, v34, v34
    v_sub_f32 v34, v29, v32
    v_fmac_f32 v35, v34, v34
    v_sub_f32 v34, v30, v32
    v_fmac_f32 v35, v34, v34
    v_sub_f32 v34, v31, v32
    v_fmac_f32 v35, v34, v34
    s_nop 1
    v_add_f32_dpp v35, v35, v35 row_ror:8 row_mask:0xf bank_mask:0xf
    s_nop 1
    v_add_f32_dpp v35, v35, v35 row_ror:4 row_mask:0xf bank_mask:0xf
    s_nop 1
    v_add_f32_dpp v35, v35, v35 row_ror:2 row_mask:0xf bank_mask:0xf
    s_nop 1
    v_add_f32_dpp v35, v35, v35 row_ror:1 row_mask:0xf bank_mask:0xf
    v_mov_b32 v33, v35
    s_nop 1
    v_permlane16_swap_b32 v35, v33
    v_add_f32 v35, v35, v33
    v_mul_f32 v35, 0x3b000000, v35
    v_cvt_pk_bf16_f32 v32, v32, v32
    v_and_b32 v32, 0xffff0000, v32
    v_cvt_pk_bf16_f32 v35, v35, v35
    v_and_b32 v35, 0xffff0000, v35
    v_add_f32 v35, 0x3727c5ac, v35
    v_cvt_pk_bf16_f32 v35, v35, v35
    v_and_b32 v35, 0xffff0000, v35
    v_sqrt_f32 v35, v35
    s_nop 0
    v_cvt_pk_bf16_f32 v35, v35, v35
    v_and_b32 v35, 0xffff0000, v35
    v_rcp_f32 v36, v35
    v_sub_f32 v16, v16, v32
    v_sub_f32 v17, v17, v32
    v_cvt_pk_bf16_f32 v37, v16, v17
    v_lshlrev_b32 v16, 16, v37
    v_and_b32 v17, 0xffff0000, v37
    v_mul_f32 v38, v16, v36
    v_fma_f32 v39, -v38, v35, v16
    v_fma_f32 v16, v39, v36, v38
    v_mul_f32 v38, v17, v36
    v_fma_f32 v39, -v38, v35, v17
    v_fma_f32 v17, v39, v36, v38
    v_cvt_pk_bf16_f32 v40, v16, v17
    v_sub_f32 v18, v18, v32
    v_sub_f32 v19, v19, v32
    v_cvt_pk_bf16_f32 v37, v18, v19
    v_lshlrev_b32 v18, 16, v37
    v_and_b32 v19, 0xffff0000, v37
    v_mul_f32 v38, v18, v36
    v_fma_f32 v39, -v38, v35, v18
    v_fma_f32 v18, v39, v36, v38
    v_mul_f32 v38, v19, v36
    v_fma_f32 v39, -v38, v35, v19
    v_fma_f32 v19, v39, v36, v38
    v_cvt_pk_bf16_f32 v41, v18, v19
    v_sub_f32 v20, v20, v32
    v_sub_f32 v21, v21, v32
    v_cvt_pk_bf16_f32 v37, v20, v21
    v_lshlrev_b32 v20, 16, v37
    v_and_b32 v21, 0xffff0000, v37
    v_mul_f32 v38, v20, v36
    v_fma_f32 v39, -v38, v35, v20
    v_fma_f32 v20, v39, v36, v38
    v_mul_f32 v38, v21, v36
    v_fma_f32 v39, -v38, v35, v21
    v_fma_f32 v21, v39, v36, v38
    v_cvt_pk_bf16_f32 v42, v20, v21
    v_sub_f32 v22, v22, v32
    v_sub_f32 v23, v23, v32
    v_cvt_pk_bf16_f32 v37, v22, v23
    v_lshlrev_b32 v22, 16, v37
    v_and_b32 v23, 0xffff0000, v37
    v_mul_f32 v38, v22, v36
    v_fma_f32 v39, -v38, v35, v22
    v_fma_f32 v22, v39, v36, v38
    v_mul_f32 v38, v23, v36
    v_fma_f32 v39, -v38, v35, v23
    v_fma_f32 v23, v39, v36, v38
    v_cvt_pk_bf16_f32 v43, v22, v23
    v_sub_f32 v24, v24, v32
    v_sub_f32 v25, v25, v32
    v_cvt_pk_bf16_f32 v37, v24, v25
    v_lshlrev_b32 v24, 16, v37
    v_and_b32 v25, 0xffff0000, v37
    v_mul_f32 v38, v24, v36
    v_fma_f32 v39, -v38, v35, v24
    v_fma_f32 v24, v39, v36, v38
    v_mul_f32 v38, v25, v36
    v_fma_f32 v39, -v38, v35, v25
    v_fma_f32 v25, v39, v36, v38
    v_cvt_pk_bf16_f32 v44, v24, v25
    v_sub_f32 v26, v26, v32
    v_sub_f32 v27, v27, v32
    v_cvt_pk_bf16_f32 v37, v26, v27
    v_lshlrev_b32 v26, 16, v37
    v_and_b32 v27, 0xffff0000, v37
    v_mul_f32 v38, v26, v36
    v_fma_f32 v39, -v38, v35, v26
    v_fma_f32 v26, v39, v36, v38
    v_mul_f32 v38, v27, v36
    v_fma_f32 v39, -v38, v35, v27
    v_fma_f32 v27, v39, v36, v38
    v_cvt_pk_bf16_f32 v45, v26, v27
    v_sub_f32 v28, v28, v32
    v_sub_f32 v29, v29, v32
    v_cvt_pk_bf16_f32 v37, v28, v29
    v_lshlrev_b32 v28, 16, v37
    v_and_b32 v29, 0xffff0000, v37
    v_mul_f32 v38, v28, v36
    v_fma_f32 v39, -v38, v35, v28
    v_fma_f32 v28, v39, v36, v38
    v_mul_f32 v38, v29, v36
    v_fma_f32 v39, -v38, v35, v29
    v_fma_f32 v29, v39, v36, v38
    v_cvt_pk_bf16_f32 v46, v28, v29
    v_sub_f32 v30, v30, v32
    v_sub_f32 v31, v31, v32
    v_cvt_pk_bf16_f32 v37, v30, v31
    v_lshlrev_b32 v30, 16, v37
    v_and_b32 v31, 0xffff0000, v37
    v_mul_f32 v38, v30, v36
    v_fma_f32 v39, -v38, v35, v30
    v_fma_f32 v30, v39, v36, v38
    v_mul_f32 v38, v31, v36
    v_fma_f32 v39, -v38, v35, v31
    v_fma_f32 v31, v39, v36, v38
    v_cvt_pk_bf16_f32 v47, v30, v31
    buffer_store_dwordx4 v[40:43], v12, s[8:11], 0 offen sc1
    buffer_store_dwordx4 v[44:47], v13, s[8:11], 0 offen sc1
    s_cmp_lg_u32 s3, 1
    s_cbranch_scc1 Lm_l0
    s_cmp_lg_u32 s93, 255
    s_cbranch_scc1 Lm_l0
    s_mov_b64 exec, 1
    buffer_atomic_add v252, off, s[16:19], s96 sc0
    s_mov_b64 exec, -1
    s_waitcnt vmcnt(1)
    s_barrier
    s_branch Lm_l1
Lm_l0:
    s_waitcnt vmcnt(0)
Lm_q1:
    s_barrier
    s_lshr_b32 s21, s2, 4
    s_lshl_b32 s21, s21, 2
    v_mov_b32 v48, 1
    s_cmp_lg_u32 s3, 0
    s_cbranch_scc1 Lm_l1
    s_mov_b64 exec, 1
    buffer_atomic_add v48, off, s[16:19], s21 offset:128
    s_mov_b64 exec, -1
Lm_l1:
    v_mov_b32 v251, 162304
    s_cmp_lg_u32 s3, 1
    s_cbranch_scc1 Lb_1
    s_mov_b64 exec, 1
    s_cmp_eq_u32 s93, 0
    s_cbranch_scc1 Lm_q2
    s_waitcnt vmcnt(0)
Lm_q2:
    ds_write_b32 v251, v252
    s_waitcnt lgkmcnt(0)
    s_mov_b64 exec, -1
Lb_1:
    s_barrier
    ds_read_b32 v250, v251
    s_waitcnt lgkmcnt(0)
    v_readfirstlane_b32 s4, v250
    s_nop 3
    s_mov_b32 s92, s4
    s_mov_b32 s91, 0
    s_mov_b32 s84, 0
    s_mov_b32 s83, 0
    s_cmp_eq_u32 s93, 255
    s_cbranch_scc1 Lm_wtask
Lm_got:
    s_cmp_ge_u32 s4, 32
    s_cbranch_scc1 Lm_wloop
    v_mov_b32 v0, v253
    s_cmp_eq_u32 s93, 3
    s_cselect_b32 s83, 524288, 0
    s_cselect_b32 s95, 0, s93
    s_cmp_lg_u32 s95, 0
    s_cbranch_scc1 Lm_s2
    v_and_b32 v1, 63, v0
    v_and_b32 v2, 15, v1
    v_lshrrev_b32 v3, 4, v1
    v_lshlrev_b32 v85, 4, v1
    s_lshl_b32 s20, s3, 15
    v_add_u32 v86, s20, v85
    v_add_u32 v87, 131072, v85
    v_mov_b32 v4, 0x4444
    v_mov_b32 v5, 0xeeee
    v_and_b32 v6, 1, v1
    v_cmp_eq_u32 vcc, 0, v6
    s_nop 1
    v_cndmask_b32 v84, v5, v4, vcc
    v_cmp_lt_u32 s[40:41], 7, v2
    v_lshlrev_b32 v4, 4, v2
    v_lshl_add_u32 v4, v3, 2, v4
    s_lshl_b32 s20, s3, 9
    s_add_u32 s20, s20, 147456
    v_add_u32 v88, s20, v4
    v_lshrrev_b32 v4, 2, v1
    v_lshlrev_b32 v4, 4, v4
    v_lshl_add_u32 v4, v6, 3, v4
    v_add_u32 v89, s20, v4
    v_and_b32 v4, 2, v1
    v_cmp_ne_u32 s[76:77], 0, v4
    v_and_b32 v7, 7, v2
    v_lshlrev_b32 v4, 4, v3
    v_lshl_add_u32 v4, v7, 1, v4
    v_lshlrev_b32 v4, 4, v4
    v_lshrrev_b32 v5, 3, v2
    v_lshl_add_u32 v4, v5, 3, v4
    s_lshr_b32 s20, s3, 1
    s_lshl_b32 s20, s20, 10
    s_and_b32 s21, s3, 1
    s_lshl_b32 s21, s21, 4
    s_add_u32 s20, s20, s21
    s_add_u32 s20, s20, 147456
    v_add_u32 v90, s20, v4
    s_lshl_b32 s20, s3, 2
    v_add_u32 v91, s20, v87
    v_mov_b32 v4, 0
    v_mov_b32 v5, 0
    v_mov_b32 v6, 0
    v_mov_b32 v7, 0
    v_lshlrev_b32 v8, 4, v0
    v_add_u32 v8, 149504, v8
    ds_write_b128 v8, v[4:7]
    v_and_b32 v6, 1, v1
    v_and_b32 v7, 7, v2
    v_mov_b32 v4, 0
    v_mov_b32 v5, 0
    v_lshlrev_b32 v8, 3, v1
    v_add_u32 v8, 161792, v8
    ds_write_b64 v8, v[4:5]
    s_lshl_b32 s87, s3, 10
    s_add_u32 s88, s87, 83968
    s_lshl_b32 s89, s3, 2
    s_mov_b32 s90, 161792
    v_lshrrev_b32 v4, 3, v2
    v_lshlrev_b32 v4, 13, v4
    v_lshrrev_b32 v8, 1, v3
    v_lshl_add_u32 v8, v8, 3, v7
    v_lshl_add_u32 v4, v8, 4, v4
    v_and_b32 v9, 1, v3
    v_lshl_add_u32 v4, v9, 3, v4
    s_lshl_b32 s20, s3, 16
    v_add_u32 v92, s20, v4
    v_lshrrev_b32 v4, 2, v7
    v_lshlrev_b32 v4, 1, v4
    v_and_b32 v8, 1, v7
    v_or_b32 v4, v4, v8
    v_lshrrev_b32 v8, 1, v3
    v_lshl_add_u32 v4, v8, 2, v4
    v_bfe_u32 v8, v7, 1, 1
    v_lshl_add_u32 v4, v4, 1, v8
    v_lshlrev_b32 v4, 4, v4
    v_lshl_add_u32 v93, v9, 3, v4
    v_lshrrev_b32 v4, 1, v7
    v_cmp_eq_u32 s[32:33], 0, v4
    v_cmp_eq_u32 s[34:35], 1, v4
    v_cmp_eq_u32 s[36:37], 2, v4
    v_cmp_eq_u32 s[38:39], 3, v4
    s_mov_b32 s42, 0x3e0293ee
    s_mov_b32 s45, 0
    s_mov_b32 s44, 0
    s_lshl_b32 s20, s4, 13
    s_add_u32 s20, s20, s83
    s_add_u32 s24, s20, 117440512
    s_add_u32 s25, s24, 4096
    s_lshl_b32 s20, s4, 8
    s_add_u32 s20, s20, s83
    s_add_u32 s72, s20, 117440512
    s_add_u32 s73, s72, 16384
    s_add_u32 s74, s72, 32768
    s_add_u32 s75, s72, 49152
    s_add_u32 s26, s20, 118489088
    s_add_u32 s27, s83, 118358016
    s_add_u32 s28, s83, 118362112
    s_add_u32 s84, s83, 116391936
    s_add_u32 s43, s83, 118472704
    s_lshl_b32 s82, s4, 2
    s_add_u32 s82, s82, s83
    s_add_u32 s82, s82, 118505472
    s_sub_u32 s85, s24, 131072
    s_sub_u32 s86, s25, 131072
    s_lshl_b32 s31, s3, 11
    v_and_b32 v4, 1, v3
    s_and_b32 s20, s3, 1
    s_lshl_b32 s20, s20, 1
    v_or_b32 v4, s20, v4
    v_lshlrev_b32 v4, 1, v4
    v_xor_b32 v4, v4, v2
    v_lshlrev_b32 v4, 4, v4
    s_lshl_b32 s20, s3, 2
    v_add_u32 v5, s20, v3
    v_lshl_add_u32 v8, v5, 13, v4
    s_lshl_b32 s20, s4, 8
    v_add_u32 v8, s20, v8
    v_xor_b32 v9, 128, v8
    v_bfe_u32 v4, v1, 2, 2
    v_and_b32 v5, 1, v4
    v_lshrrev_b32 v6, 1, v4
    v_and_b32 v7, 1, v3
    v_lshrrev_b32 v17, 1, v3
    v_lshl_add_u32 v13, v6, 4, v5
    v_lshl_add_u32 v13, v17, 3, v13
    v_lshl_add_u32 v13, v7, 2, v13
    v_lshlrev_b32 v13, 8, v13
    v_and_b32 v14, 3, v1
    v_lshl_add_u32 v13, v14, 3, v13
    v_lshl_add_u32 v15, v7, 1, v5
    v_lshl_add_u32 v15, v6, 2, v15
    s_lshl_b32 s20, s3, 1
    v_xor_b32 v14, s20, v15
    v_lshl_add_u32 v10, v14, 5, v13
    v_xor_b32 v11, 32, v10
    v_add_u32 v20, 0x10000, v10
    v_add_u32 v21, 0x10000, v11
    v_lshl_add_u32 v13, v6, 5, v5
    v_lshl_add_u32 v13, v7, 4, v13
    v_lshl_add_u32 v13, v17, 2, v13
    v_lshlrev_b32 v13, 8, v13
    v_and_b32 v14, 3, v1
    v_lshl_add_u32 v13, v14, 3, v13
    v_lshl_add_u32 v13, v15, 5, v13
    s_lshl_b32 s20, s3, 15
    v_add_u32 v16, s20, v13
    v_and_b32 v4, 1, v3
    v_lshlrev_b32 v4, 1, v4
    v_xor_b32 v4, v4, v2
    v_lshlrev_b32 v4, 4, v4
    v_lshl_add_u32 v12, v3, 10, v4
    s_lshl_b32 s20, s3, 12
    v_add_u32 v12, s20, v12
    s_lshl_b32 s55, s4, 17
    s_load_dwordx2 s[46:47], s[0:1], 16
    s_load_dwordx2 s[48:49], s[0:1], 24
    s_load_dwordx2 s[50:51], s[0:1], 32
    s_load_dwordx2 s[52:53], s[0:1], 40
    s_waitcnt lgkmcnt(0)
    s_mov_b32 s56, s46
    s_and_b32 s57, s47, 0xffff
    s_mov_b32 s58, 4194304
    s_mov_b32 s59, 0x20000
    s_mov_b32 s60, s48
    s_and_b32 s61, s49, 0xffff
    s_mov_b32 s62, 4194304
    s_mov_b32 s63, 0x20000
    s_mov_b32 s64, s50
    s_and_b32 s65, s51, 0xffff
    s_mov_b32 s66, 4194304
    s_mov_b32 s67, 0x20000
    s_mov_b32 s68, s52
    s_and_b32 s69, s53, 0xffff
    s_mov_b32 s70, 4194304
    s_mov_b32 s71, 0x20000
    s_lshl_b32 s54, s3, 10
    s_add_u32 m0, s54, 0
    s_mov_b32 s20, 0
    buffer_load_dwordx4 v8, s[56:59], s20 offen lds
    s_add_u32 m0, s54, 4096
    s_mov_b32 s20, 131072
    buffer_load_dwordx4 v9, s[56:59], s20 offen lds
    s_add_u32 m0, s54, 8192
    s_mov_b32 s20, 262144
    buffer_load_dwordx4 v8, s[56:59], s20 offen lds
    s_add_u32 m0, s54, 12288
    s_mov_b32 s20, 393216
    buffer_load_dwordx4 v9, s[56:59], s20 offen lds
    s_add_u32 m0, s54, 16384
    s_mov_b32 s20, 524288
    buffer_load_dwordx4 v8, s[56:59], s20 offen lds
    s_add_u32 m0, s54, 20480
    s_mov_b32 s20, 655360
    buffer_load_dwordx4 v9, s[56:59], s20 offen lds
    s_add_u32 m0, s54, 24576
    s_mov_b32 s20, 786432
    buffer_load_dwordx4 v8, s[56:59], s20 offen lds
    s_add_u32 m0, s54, 28672
    s_mov_b32 s20, 917504
    buffer_load_dwordx4 v9, s[56:59], s20 offen lds
    s_add_u32 m0, s54, 32768
    s_mov_b32 s20, 1048576
    buffer_load_dwordx4 v8, s[56:59], s20 offen lds
    s_add_u32 m0, s54, 36864
    s_mov_b32 s20, 1179648
    buffer_load_dwordx4 v9, s[56:59], s20 offen lds
    s_add_u32 m0, s54, 40960
    s_mov_b32 s20, 1310720
    buffer_load_dwordx4 v8, s[56:59], s20 offen lds
    s_add_u32 m0, s54, 45056
    s_mov_b32 s20, 1441792
    buffer_load_dwordx4 v9, s[56:59], s20 offen lds
    s_add_u32 m0, s54, 49152
    s_mov_b32 s20, 1572864
    buffer_load_dwordx4 v8, s[56:59], s20 offen lds
    s_add_u32 m0, s54, 53248
    s_mov_b32 s20, 1703936
    buffer_load_dwordx4 v9, s[56:59], s20 offen lds
    s_add_u32 m0, s54, 57344
    s_mov_b32 s20, 1835008
    buffer_load_dwordx4 v8, s[56:59], s20 offen lds
    s_add_u32 m0, s54, 61440
    s_mov_b32 s20, 1966080
    buffer_load_dwordx4 v9, s[56:59], s20 offen lds
    s_add_u32 m0, s54, 65536
    s_mov_b32 s20, 2097152
    buffer_load_dwordx4 v8, s[56:59], s20 offen lds
    s_add_u32 m0, s54, 69632
    s_mov_b32 s20, 2228224
    buffer_load_dwordx4 v9, s[56:59], s20 offen lds
    s_add_u32 m0, s54, 73728
    s_mov_b32 s20, 2359296
    buffer_load_dwordx4 v8, s[56:59], s20 offen lds
    s_add_u32 m0, s54, 77824
    s_mov_b32 s20, 2490368
    buffer_load_dwordx4 v9, s[56:59], s20 offen lds
    s_add_u32 m0, s54, 81920
    s_mov_b32 s20, 2621440
    buffer_load_dwordx4 v8, s[56:59], s20 offen lds
    s_add_u32 m0, s54, 86016
    s_mov_b32 s20, 2752512
    buffer_load_dwordx4 v9, s[56:59], s20 offen lds
    s_add_u32 m0, s54, 90112
    s_mov_b32 s20, 2883584
    buffer_load_dwordx4 v8, s[56:59], s20 offen lds
    s_add_u32 m0, s54, 94208
    s_mov_b32 s20, 3014656
    buffer_load_dwordx4 v9, s[56:59], s20 offen lds
    s_add_u32 m0, s54, 98304
    s_mov_b32 s20, 3145728
    buffer_load_dwordx4 v8, s[56:59], s20 offen lds
    s_add_u32 m0, s54, 102400
    s_mov_b32 s20, 3276800
    buffer_load_dwordx4 v9, s[56:59], s20 offen lds
    s_add_u32 m0, s54, 106496
    s_mov_b32 s20, 3407872
    buffer_load_dwordx4 v8, s[56:59], s20 offen lds
    s_add_u32 m0, s54, 110592
    s_mov_b32 s20, 3538944
    buffer_load_dwordx4 v9, s[56:59], s20 offen lds
    s_load_dwordx2 s[80:81], s[0:1], 8
    v_mov_b32 v24, -1
    v_mov_b32 v25, -1
    v_mov_b32 v26, -1
    v_mov_b32 v27, -1
    v_lshlrev_b32 v28, 4, v0
    buffer_store_dwordx4 v[24:27], v28, s[8:11], s24 offen sc1
    buffer_store_dwordx4 v[24:27], v28, s[8:11], s25 offen sc1
    s_waitcnt lgkmcnt(0)
    s_mov_b32 s12, s80
    s_and_b32 s13, s81, 0xffff
    s_mov_b32 s14, 8192
    s_mov_b32 s15, 0x20000
    v_mov_b32 v30, 0
    v_mov_b32 v31, 0
    buffer_store_dwordx2 v[30:31], v93, s[8:11], s26 offen sc1
    buffer_store_dword v30, off, s[8:11], s82 sc1
    s_lshl_b32 s20, s3, 7
    s_add_u32 s20, s20, s82
    buffer_store_dword v24, off, s[8:11], s20 offset:1024 sc1
    v_lshrrev_b32 v29, 1, v2
    v_lshlrev_b32 v29, 10, v29
    v_lshrrev_b32 v28, 1, v3
    v_lshl_add_u32 v29, v28, 6, v29
    v_and_b32 v28, 1, v2
    v_lshl_add_u32 v29, v28, 5, v29
    v_and_b32 v28, 1, v3
    v_lshl_add_u32 v29, v28, 4, v29
    s_lshl_b32 s20, s3, 8
    s_add_u32 m0, s31, 139264
    s_nop 0
    buffer_load_dwordx4 v29, s[12:15], s20 offen lds
    s_add_u32 m0, s31, 140160
    s_nop 0
    buffer_load_dwordx4 v29, s[12:15], s20 offen offset:128 lds
    s_waitcnt vmcnt(31)
    s_waitcnt lgkmcnt(0)
    s_barrier
    s_add_u32 m0, s54, 114688
    s_mov_b32 s20, 3670016
    buffer_load_dwordx4 v8, s[56:59], s20 offen lds
    s_add_u32 m0, s54, 118784
    s_mov_b32 s20, 3801088
    buffer_load_dwordx4 v9, s[56:59], s20 offen lds
    s_add_u32 m0, s54, 122880
    s_mov_b32 s20, 3932160
    buffer_load_dwordx4 v8, s[56:59], s20 offen lds
    s_add_u32 m0, s54, 126976
    s_mov_b32 s20, 4063232
    buffer_load_dwordx4 v9, s[56:59], s20 offen lds
    ds_read_b64_tr_b16 a[0:1], v10 offset:0
    ds_read_b64_tr_b16 a[2:3], v10 offset:512
    ds_read_b64_tr_b16 a[4:5], v10 offset:8192
    ds_read_b64_tr_b16 a[6:7], v10 offset:8704
    ds_read_b64_tr_b16 a[64:65], v11 offset:0
    ds_read_b64_tr_b16 a[66:67], v11 offset:512
    ds_read_b64_tr_b16 a[68:69], v11 offset:8192
    ds_read_b64_tr_b16 a[70:71], v11 offset:8704
    s_waitcnt vmcnt(31)
    s_waitcnt lgkmcnt(0)
    s_barrier
    s_add_u32 m0, s54, 0
    s_mov_b32 s20, 0
    buffer_load_dwordx4 v8, s[60:63], s20 offen lds
    s_add_u32 m0, s54, 4096
    s_mov_b32 s20, 131072
    buffer_load_dwordx4 v9, s[60:63], s20 offen lds
    s_add_u32 m0, s54, 8192
    s_mov_b32 s20, 262144
    buffer_load_dwordx4 v8, s[60:63], s20 offen lds
    s_add_u32 m0, s54, 12288
    s_mov_b32 s20, 393216
    buffer_load_dwordx4 v9, s[60:63], s20 offen lds
    ds_read_b64_tr_b16 a[8:9], v10 offset:16384
    ds_read_b64_tr_b16 a[10:11], v10 offset:16896
    ds_read_b64_tr_b16 a[12:13], v10 offset:24576
    ds_read_b64_tr_b16 a[14:15], v10 offset:25088
    ds_read_b64_tr_b16 a[72:73], v11 offset:16384
    ds_read_b64_tr_b16 a[74:75], v11 offset:16896
    ds_read_b64_tr_b16 a[76:77], v11 offset:24576
    ds_read_b64_tr_b16 a[78:79], v11 offset:25088
    s_waitcnt vmcnt(31)
    s_waitcnt lgkmcnt(0)
    s_barrier
    s_add_u32 m0, s54, 16384
    s_mov_b32 s20, 524288
    buffer_load_dwordx4 v8, s[60:63], s20 offen lds
    s_add_u32 m0, s54, 20480
    s_mov_b32 s20, 655360
    buffer_load_dwordx4 v9, s[60:63], s20 offen lds
    s_add_u32 m0, s54, 24576
    s_mov_b32 s20, 786432
    buffer_load_dwordx4 v8, s[60:63], s20 offen lds
    s_add_u32 m0, s54, 28672
    s_mov_b32 s20, 917504
    buffer_load_dwordx4 v9, s[60:63], s20 offen lds
    ds_read_b64_tr_b16 a[16:17], v10 offset:32768
    ds_read_b64_tr_b16 a[18:19], v10 offset:33280
    ds_read_b64_tr_b16 a[20:21], v10 offset:40960
    ds_read_b64_tr_b16 a[22:23], v10 offset:41472
    ds_read_b64_tr_b16 a[80:81], v11 offset:32768
    ds_read_b64_tr_b16 a[82:83], v11 offset:33280
    ds_read_b64_tr_b16 a[84:85], v11 offset:40960
    ds_read_b64_tr_b16 a[86:87], v11 offset:41472
    s_waitcnt vmcnt(31)
    s_waitcnt lgkmcnt(0)
    s_barrier
    s_add_u32 m0, s54, 32768
    s_mov_b32 s20, 1048576
    buffer_load_dwordx4 v8, s[60:63], s20 offen lds
    s_add_u32 m0, s54, 36864
    s_mov_b32 s20, 1179648
    buffer_load_dwordx4 v9, s[60:63], s20 offen lds
    s_add_u32 m0, s54, 40960
    s_mov_b32 s20, 1310720
    buffer_load_dwordx4 v8, s[60:63], s20 offen lds
    s_add_u32 m0, s54, 45056
    s_mov_b32 s20, 1441792
    buffer_load_dwordx4 v9, s[60:63], s20 offen lds
    ds_read_b64_tr_b16 a[24:25], v10 offset:49152
    ds_read_b64_tr_b16 a[26:27], v10 offset:49664
    ds_read_b64_tr_b16 a[28:29], v10 offset:57344
    ds_read_b64_tr_b16 a[30:31], v10 offset:57856
    ds_read_b64_tr_b16 a[88:89], v11 offset:49152
    ds_read_b64_tr_b16 a[90:91], v11 offset:49664
    ds_read_b64_tr_b16 a[92:93], v11 offset:57344
    ds_read_b64_tr_b16 a[94:95], v11 offset:57856
    s_waitcnt vmcnt(31)
    s_waitcnt lgkmcnt(0)
    s_barrier
    s_add_u32 m0, s54, 49152
    s_mov_b32 s20, 1572864
    buffer_load_dwordx4 v8, s[60:63], s20 offen lds
    s_add_u32 m0, s54, 53248
    s_mov_b32 s20, 1703936
    buffer_load_dwordx4 v9, s[60:63], s20 offen lds
    s_add_u32 m0, s54, 57344
    s_mov_b32 s20, 1835008
    buffer_load_dwordx4 v8, s[60:63], s20 offen lds
    s_add_u32 m0, s54, 61440
    s_mov_b32 s20, 1966080
    buffer_load_dwordx4 v9, s[60:63], s20 offen lds
    ds_read_b64_tr_b16 a[32:33], v20 offset:0
    ds_read_b64_tr_b16 a[34:35], v20 offset:512
    ds_read_b64_tr_b16 a[36:37], v20 offset:8192
    ds_read_b64_tr_b16 a[38:39], v20 offset:8704
    ds_read_b64_tr_b16 a[96:97], v21 offset:0
    ds_read_b64_tr_b16 a[98:99], v21 offset:512
    ds_read_b64_tr_b16 a[100:101], v21 offset:8192
    ds_read_b64_tr_b16 a[102:103], v21 offset:8704
    s_waitcnt vmcnt(31)
    s_waitcnt lgkmcnt(0)
    s_barrier
    s_add_u32 m0, s54, 65536
    s_mov_b32 s20, 2097152
    buffer_load_dwordx4 v8, s[60:63], s20 offen lds
    s_add_u32 m0, s54, 69632
    s_mov_b32 s20, 2228224
    buffer_load_dwordx4 v9, s[60:63], s20 offen lds
    s_add_u32 m0, s54, 73728
    s_mov_b32 s20, 2359296
    buffer_load_dwordx4 v8, s[60:63], s20 offen lds
    s_add_u32 m0, s54, 77824
    s_mov_b32 s20, 2490368
    buffer_load_dwordx4 v9, s[60:63], s20 offen lds
    ds_read_b64_tr_b16 a[40:41], v20 offset:16384
    ds_read_b64_tr_b16 a[42:43], v20 offset:16896
    ds_read_b64_tr_b16 a[44:45], v20 offset:24576
    ds_read_b64_tr_b16 a[46:47], v20 offset:25088
    ds_read_b64_tr_b16 a[104:105], v21 offset:16384
    ds_read_b64_tr_b16 a[106:107], v21 offset:16896
    ds_read_b64_tr_b16 a[108:109], v21 offset:24576
    ds_read_b64_tr_b16 a[110:111], v21 offset:25088
    s_waitcnt vmcnt(31)
    s_waitcnt lgkmcnt(0)
    s_barrier
    s_add_u32 m0, s54, 81920
    s_mov_b32 s20, 2621440
    buffer_load_dwordx4 v8, s[60:63], s20 offen lds
    s_add_u32 m0, s54, 86016
    s_mov_b32 s20, 2752512
    buffer_load_dwordx4 v9, s[60:63], s20 offen lds
    s_add_u32 m0, s54, 90112
    s_mov_b32 s20, 2883584
    buffer_load_dwordx4 v8, s[60:63], s20 offen lds
    s_add_u32 m0, s54, 94208
    s_mov_b32 s20, 3014656
    buffer_load_dwordx4 v9, s[60:63], s20 offen lds
    ds_read_b64_tr_b16 a[48:49], v20 offset:32768
    ds_read_b64_tr_b16 a[50:51], v20 offset:33280
    ds_read_b64_tr_b16 a[52:53], v20 offset:40960
    ds_read_b64_tr_b16 a[54:55], v20 offset:41472
    ds_read_b64_tr_b16 a[112:113], v21 offset:32768
    ds_read_b64_tr_b16 a[114:115], v21 offset:33280
    ds_read_b64_tr_b16 a[116:117], v21 offset:40960
    ds_read_b64_tr_b16 a[118:119], v21 offset:41472
    s_waitcnt vmcnt(24)
    s_waitcnt lgkmcnt(0)
    s_barrier
    s_add_u32 m0, s54, 98304
    s_mov_b32 s20, 3145728
    buffer_load_dwordx4 v8, s[60:63], s20 offen lds
    s_add_u32 m0, s54, 102400
    s_mov_b32 s20, 3276800
    buffer_load_dwordx4 v9, s[60:63], s20 offen lds
    s_add_u32 m0, s54, 106496
    s_mov_b32 s20, 3407872
    buffer_load_dwordx4 v8, s[60:63], s20 offen lds
    s_add_u32 m0, s54, 110592
    s_mov_b32 s20, 3538944
    buffer_load_dwordx4 v9, s[60:63], s20 offen lds
    ds_read_b64_tr_b16 a[56:57], v20 offset:49152
    ds_read_b64_tr_b16 a[58:59], v20 offset:49664
    ds_read_b64_tr_b16 a[60:61], v20 offset:57344
    ds_read_b64_tr_b16 a[62:63], v20 offset:57856
    ds_read_b64_tr_b16 a[120:121], v21 offset:49152
    ds_read_b64_tr_b16 a[122:123], v21 offset:49664
    ds_read_b64_tr_b16 a[124:125], v21 offset:57344
    ds_read_b64_tr_b16 a[126:127], v21 offset:57856
    s_waitcnt vmcnt(24)
    s_waitcnt lgkmcnt(0)
    s_barrier
    s_add_u32 m0, s54, 114688
    s_mov_b32 s20, 3670016
    buffer_load_dwordx4 v8, s[60:63], s20 offen lds
    s_add_u32 m0, s54, 118784
    s_mov_b32 s20, 3801088
    buffer_load_dwordx4 v9, s[60:63], s20 offen lds
    s_add_u32 m0, s54, 122880
    s_mov_b32 s20, 3932160
    buffer_load_dwordx4 v8, s[60:63], s20 offen lds
    s_add_u32 m0, s54, 126976
    s_mov_b32 s20, 4063232
    buffer_load_dwordx4 v9, s[60:63], s20 offen lds
    s_lshl_b32 s96, s93, 3
    s_add_u32 s96, s96, 64
    s_cmp_lg_u32 s3, 0
    s_cbranch_scc1 Lta_2
    s_and_b32 s97, s101, 7
    s_mul_i32 s97, s97, 6
    s_lshl_b64 s[94:95], 1, s97
    s_or_b32 s95, s95, 0x1000000
    v_mov_b32 v30, s94
    v_mov_b32 v31, s95
    s_mov_b64 exec, 1
    buffer_atomic_add_x2 v[30:31], off, s[16:19], s96
    s_mov_b64 exec, -1
Lta_2:
    ds_read_b64_tr_b16 a[128:129], v10 offset:0
    ds_read_b64_tr_b16 a[130:131], v10 offset:512
    ds_read_b64_tr_b16 a[132:133], v10 offset:8192
    ds_read_b64_tr_b16 a[134:135], v10 offset:8704
    ds_read_b64_tr_b16 a[192:193], v11 offset:0
    ds_read_b64_tr_b16 a[194:195], v11 offset:512
    ds_read_b64_tr_b16 a[196:197], v11 offset:8192
    ds_read_b64_tr_b16 a[198:199], v11 offset:8704
    s_waitcnt vmcnt(24)
    s_waitcnt lgkmcnt(0)
    s_barrier
    s_add_u32 m0, s54, 0
    s_mov_b32 s20, 0
    buffer_load_dwordx4 v8, s[64:67], s20 offen lds
    s_add_u32 m0, s54, 4096
    s_mov_b32 s20, 131072
    buffer_load_dwordx4 v9, s[64:67], s20 offen lds
    s_add_u32 m0, s54, 8192
    s_mov_b32 s20, 262144
    buffer_load_dwordx4 v8, s[64:67], s20 offen lds
    s_add_u32 m0, s54, 12288
    s_mov_b32 s20, 393216
    buffer_load_dwordx4 v9, s[64:67], s20 offen lds
    ds_read_b64_tr_b16 a[136:137], v10 offset:16384
    ds_read_b64_tr_b16 a[138:139], v10 offset:16896
    ds_read_b64_tr_b16 a[140:141], v10 offset:24576
    ds_read_b64_tr_b16 a[142:143], v10 offset:25088
    ds_read_b64_tr_b16 a[200:201], v11 offset:16384
    ds_read_b64_tr_b16 a[202:203], v11 offset:16896
    ds_read_b64_tr_b16 a[204:205], v11 offset:24576
    ds_read_b64_tr_b16 a[206:207], v11 offset:25088
    s_waitcnt vmcnt(24)
    s_waitcnt lgkmcnt(0)
    s_barrier
    s_add_u32 m0, s54, 16384
    s_mov_b32 s20, 524288
    buffer_load_dwordx4 v8, s[64:67], s20 offen lds
    s_add_u32 m0, s54, 20480
    s_mov_b32 s20, 655360
    buffer_load_dwordx4 v9, s[64:67], s20 offen lds
    s_add_u32 m0, s54, 24576
    s_mov_b32 s20, 786432
    buffer_load_dwordx4 v8, s[64:67], s20 offen lds
    s_add_u32 m0, s54, 28672
    s_mov_b32 s20, 917504
    buffer_load_dwordx4 v9, s[64:67], s20 offen lds
    ds_read_b64_tr_b16 a[144:145], v10 offset:32768
    ds_read_b64_tr_b16 a[146:147], v10 offset:33280
    ds_read_b64_tr_b16 a[148:149], v10 offset:40960
    ds_read_b64_tr_b16 a[150:151], v10 offset:41472
    ds_read_b64_tr_b16 a[208:209], v11 offset:32768
    ds_read_b64_tr_b16 a[210:211], v11 offset:33280
    ds_read_b64_tr_b16 a[212:213], v11 offset:40960
    ds_read_b64_tr_b16 a[214:215], v11 offset:41472
    s_waitcnt vmcnt(24)
    s_waitcnt lgkmcnt(0)
    s_barrier
    s_add_u32 m0, s54, 32768
    s_mov_b32 s20, 1048576
    buffer_load_dwordx4 v8, s[64:67], s20 offen lds
    s_add_u32 m0, s54, 36864
    s_mov_b32 s20, 1179648
    buffer_load_dwordx4 v9, s[64:67], s20 offen lds
    s_add_u32 m0, s54, 40960
    s_mov_b32 s20, 1310720
    buffer_load_dwordx4 v8, s[64:67], s20 offen lds
    s_add_u32 m0, s54, 45056
    s_mov_b32 s20, 1441792
    buffer_load_dwordx4 v9, s[64:67], s20 offen lds
    ds_read_b64_tr_b16 a[152:153], v10 offset:49152
    ds_read_b64_tr_b16 a[154:155], v10 offset:49664
    ds_read_b64_tr_b16 a[156:157], v10 offset:57344
    ds_read_b64_tr_b16 a[158:159], v10 offset:57856
    ds_read_b64_tr_b16 a[216:217], v11 offset:49152
    ds_read_b64_tr_b16 a[218:219], v11 offset:49664
    ds_read_b64_tr_b16 a[220:221], v11 offset:57344
    ds_read_b64_tr_b16 a[222:223], v11 offset:57856
    s_waitcnt vmcnt(24)
    s_waitcnt lgkmcnt(0)
    s_barrier
    s_add_u32 m0, s54, 49152
    s_mov_b32 s20, 1572864
    buffer_load_dwordx4 v8, s[64:67], s20 offen lds
    s_add_u32 m0, s54, 53248
    s_mov_b32 s20, 1703936
    buffer_load_dwordx4 v9, s[64:67], s20 offen lds
    s_add_u32 m0, s54, 57344
    s_mov_b32 s20, 1835008
    buffer_load_dwordx4 v8, s[64:67], s20 offen lds
    s_add_u32 m0, s54, 61440
    s_mov_b32 s20, 1966080
    buffer_load_dwordx4 v9, s[64:67], s20 offen lds
    ds_read_b64_tr_b16 a[160:161], v20 offset:0
    ds_read_b64_tr_b16 a[162:163], v20 offset:512
    ds_read_b64_tr_b16 a[164:165], v20 offset:8192
    ds_read_b64_tr_b16 a[166:167], v20 offset:8704
    ds_read_b64_tr_b16 a[224:225], v21 offset:0
    ds_read_b64_tr_b16 a[226:227], v21 offset:512
    ds_read_b64_tr_b16 a[228:229], v21 offset:8192
    ds_read_b64_tr_b16 a[230:231], v21 offset:8704
    s_waitcnt vmcnt(24)
    s_waitcnt lgkmcnt(0)
    s_barrier
    s_add_u32 m0, s54, 65536
    s_mov_b32 s20, 2097152
    buffer_load_dwordx4 v8, s[64:67], s20 offen lds
    s_add_u32 m0, s54, 69632
    s_mov_b32 s20, 2228224
    buffer_load_dwordx4 v9, s[64:67], s20 offen lds
    s_add_u32 m0, s54, 73728
    s_mov_b32 s20, 2359296
    buffer_load_dwordx4 v8, s[64:67], s20 offen lds
    s_add_u32 m0, s54, 77824
    s_mov_b32 s20, 2490368
    buffer_load_dwordx4 v9, s[64:67], s20 offen lds
    ds_read_b64_tr_b16 a[168:169], v20 offset:16384
    ds_read_b64_tr_b16 a[170:171], v20 offset:16896
    ds_read_b64_tr_b16 a[172:173], v20 offset:24576
    ds_read_b64_tr_b16 a[174:175], v20 offset:25088
    ds_read_b64_tr_b16 a[232:233], v21 offset:16384
    ds_read_b64_tr_b16 a[234:235], v21 offset:16896
    ds_read_b64_tr_b16 a[236:237], v21 offset:24576
    ds_read_b64_tr_b16 a[238:239], v21 offset:25088
    s_waitcnt vmcnt(24)
    s_waitcnt lgkmcnt(0)
    s_barrier
    s_add_u32 m0, s54, 81920
    s_mov_b32 s20, 2621440
    buffer_load_dwordx4 v8, s[64:67], s20 offen lds
    s_add_u32 m0, s54, 86016
    s_mov_b32 s20, 2752512
    buffer_load_dwordx4 v9, s[64:67], s20 offen lds
    s_add_u32 m0, s54, 90112
    s_mov_b32 s20, 2883584
    buffer_load_dwordx4 v8, s[64:67], s20 offen lds
    s_add_u32 m0, s54, 94208
    s_mov_b32 s20, 3014656
    buffer_load_dwordx4 v9, s[64:67], s20 offen lds
    ds_read_b64_tr_b16 a[176:177], v20 offset:32768
    ds_read_b64_tr_b16 a[178:179], v20 offset:33280
    ds_read_b64_tr_b16 a[180:181], v20 offset:40960
    ds_read_b64_tr_b16 a[182:183], v20 offset:41472
    ds_read_b64_tr_b16 a[240:241], v21 offset:32768
    ds_read_b64_tr_b16 a[242:243], v21 offset:33280
    ds_read_b64_tr_b16 a[244:245], v21 offset:40960
    ds_read_b64_tr_b16 a[246:247], v21 offset:41472
    s_waitcnt vmcnt(24)
    s_waitcnt lgkmcnt(0)
    s_barrier
    s_add_u32 m0, s54, 98304
    s_mov_b32 s20, 3145728
    buffer_load_dwordx4 v8, s[64:67], s20 offen lds
    s_add_u32 m0, s54, 102400
    s_mov_b32 s20, 3276800
    buffer_load_dwordx4 v9, s[64:67], s20 offen lds
    s_add_u32 m0, s54, 106496
    s_mov_b32 s20, 3407872
    buffer_load_dwordx4 v8, s[64:67], s20 offen lds
    s_add_u32 m0, s54, 110592
    s_mov_b32 s20, 3538944
    buffer_load_dwordx4 v9, s[64:67], s20 offen lds
    ds_read_b64_tr_b16 a[184:185], v20 offset:49152
    ds_read_b64_tr_b16 a[186:187], v20 offset:49664
    ds_read_b64_tr_b16 a[188:189], v20 offset:57344
    ds_read_b64_tr_b16 a[190:191], v20 offset:57856
    ds_read_b64_tr_b16 a[248:249], v21 offset:49152
    ds_read_b64_tr_b16 a[250:251], v21 offset:49664
    ds_read_b64_tr_b16 a[252:253], v21 offset:57344
    ds_read_b64_tr_b16 a[254:255], v21 offset:57856
    s_waitcnt vmcnt(24)
    s_waitcnt lgkmcnt(0)
    s_barrier
    s_add_u32 m0, s54, 114688
    s_mov_b32 s20, 3670016
    buffer_load_dwordx4 v8, s[64:67], s20 offen lds
    s_add_u32 m0, s54, 118784
    s_mov_b32 s20, 3801088
    buffer_load_dwordx4 v9, s[64:67], s20 offen lds
    s_add_u32 m0, s54, 122880
    s_mov_b32 s20, 3932160
    buffer_load_dwordx4 v8, s[64:67], s20 offen lds
    s_add_u32 m0, s54, 126976
    s_mov_b32 s20, 4063232
    buffer_load_dwordx4 v9, s[64:67], s20 offen lds
    ds_read_b64_tr_b16 v[128:129], v10 offset:0
    ds_read_b64_tr_b16 v[130:131], v10 offset:512
    ds_read_b64_tr_b16 v[132:133], v10 offset:8192
    ds_read_b64_tr_b16 v[134:135], v10 offset:8704
    ds_read_b64_tr_b16 v[96:97], v11 offset:0
    ds_read_b64_tr_b16 v[98:99], v11 offset:512
    ds_read_b64_tr_b16 v[100:101], v11 offset:8192
    ds_read_b64_tr_b16 v[102:103], v11 offset:8704
    s_waitcnt vmcnt(24)
    s_waitcnt lgkmcnt(0)
    s_barrier
    v_xor_b32 v22, 0, v12
    s_add_u32 m0, s54, 0
    s_add_u32 s20, s55, 0
    buffer_load_dwordx4 v22, s[68:71], s20 offen lds
    v_xor_b32 v22, 64, v12
    s_add_u32 m0, s54, 4096
    s_add_u32 s20, s55, 16384
    buffer_load_dwordx4 v22, s[68:71], s20 offen lds
    v_xor_b32 v22, 128, v12
    s_add_u32 m0, s54, 8192
    s_add_u32 s20, s55, 32768
    buffer_load_dwordx4 v22, s[68:71], s20 offen lds
    v_xor_b32 v22, 192, v12
    s_add_u32 m0, s54, 12288
    s_add_u32 s20, s55, 49152
    buffer_load_dwordx4 v22, s[68:71], s20 offen lds
    ds_read_b64_tr_b16 v[136:137], v10 offset:16384
    ds_read_b64_tr_b16 v[138:139], v10 offset:16896
    ds_read_b64_tr_b16 v[140:141], v10 offset:24576
    ds_read_b64_tr_b16 v[142:143], v10 offset:25088
    ds_read_b64_tr_b16 v[104:105], v11 offset:16384
    ds_read_b64_tr_b16 v[106:107], v11 offset:16896
    ds_read_b64_tr_b16 v[108:109], v11 offset:24576
    ds_read_b64_tr_b16 v[110:111], v11 offset:25088
    s_waitcnt vmcnt(24)
    s_waitcnt lgkmcnt(0)
    s_barrier
    v_xor_b32 v22, 0, v12
    s_add_u32 m0, s54, 16384
    s_add_u32 s20, s55, 65536
    buffer_load_dwordx4 v22, s[68:71], s20 offen lds
    v_xor_b32 v22, 64, v12
    s_add_u32 m0, s54, 20480
    s_add_u32 s20, s55, 81920
    buffer_load_dwordx4 v22, s[68:71], s20 offen lds
    v_xor_b32 v22, 128, v12
    s_add_u32 m0, s54, 24576
    s_add_u32 s20, s55, 98304
    buffer_load_dwordx4 v22, s[68:71], s20 offen lds
    v_xor_b32 v22, 192, v12
    s_add_u32 m0, s54, 28672
    s_add_u32 s20, s55, 114688
    buffer_load_dwordx4 v22, s[68:71], s20 offen lds
    ds_read_b64_tr_b16 v[144:145], v10 offset:32768
    ds_read_b64_tr_b16 v[146:147], v10 offset:33280
    ds_read_b64_tr_b16 v[148:149], v10 offset:40960
    ds_read_b64_tr_b16 v[150:151], v10 offset:41472
    ds_read_b64_tr_b16 v[112:113], v11 offset:32768
    ds_read_b64_tr_b16 v[114:115], v11 offset:33280
    ds_read_b64_tr_b16 v[116:117], v11 offset:40960
    ds_read_b64_tr_b16 v[118:119], v11 offset:41472
    s_waitcnt vmcnt(24)
    s_waitcnt lgkmcnt(0)
    s_barrier
    v_xor_b32 v22, 0, v12
    s_add_u32 m0, s54, 32768
    s_add_u32 s20, s55, 256
    buffer_load_dwordx4 v22, s[68:71], s20 offen lds
    v_xor_b32 v22, 64, v12
    s_add_u32 m0, s54, 36864
    s_add_u32 s20, s55, 16640
    buffer_load_dwordx4 v22, s[68:71], s20 offen lds
    v_xor_b32 v22, 128, v12
    s_add_u32 m0, s54, 40960
    s_add_u32 s20, s55, 33024
    buffer_load_dwordx4 v22, s[68:71], s20 offen lds
    v_xor_b32 v22, 192, v12
    s_add_u32 m0, s54, 45056
    s_add_u32 s20, s55, 49408
    buffer_load_dwordx4 v22, s[68:71], s20 offen lds
    ds_read_b64_tr_b16 v[152:153], v10 offset:49152
    ds_read_b64_tr_b16 v[154:155], v10 offset:49664
    ds_read_b64_tr_b16 v[156:157], v10 offset:57344
    ds_read_b64_tr_b16 v[158:159], v10 offset:57856
    ds_read_b64_tr_b16 v[120:121], v11 offset:49152
    ds_read_b64_tr_b16 v[122:123], v11 offset:49664
    ds_read_b64_tr_b16 v[124:125], v11 offset:57344
    ds_read_b64_tr_b16 v[126:127], v11 offset:57856
    s_waitcnt vmcnt(24)
    s_waitcnt lgkmcnt(0)
    s_barrier
    v_xor_b32 v22, 0, v12
    s_add_u32 m0, s54, 49152
    s_add_u32 s20, s55, 65792
    buffer_load_dwordx4 v22, s[68:71], s20 offen lds
    v_xor_b32 v22, 64, v12
    s_add_u32 m0, s54, 53248
    s_add_u32 s20, s55, 82176
    buffer_load_dwordx4 v22, s[68:71], s20 offen lds
    v_xor_b32 v22, 128, v12
    s_add_u32 m0, s54, 57344
    s_add_u32 s20, s55, 98560
    buffer_load_dwordx4 v22, s[68:71], s20 offen lds
    v_xor_b32 v22, 192, v12
    s_add_u32 m0, s54, 61440
    s_add_u32 s20, s55, 114944
    buffer_load_dwordx4 v22, s[68:71], s20 offen lds
    ds_read_b64_tr_b16 v[160:161], v20 offset:0
    ds_read_b64_tr_b16 v[162:163], v20 offset:512
    ds_read_b64_tr_b16 v[164:165], v20 offset:8192
    ds_read_b64_tr_b16 v[166:167], v20 offset:8704
    ds_read_b64_tr_b16 v[32:33], v21 offset:0
    ds_read_b64_tr_b16 v[34:35], v21 offset:512
    ds_read_b64_tr_b16 v[36:37], v21 offset:8192
    ds_read_b64_tr_b16 v[38:39], v21 offset:8704
    s_waitcnt vmcnt(24)
    s_waitcnt lgkmcnt(0)
    s_barrier
    v_xor_b32 v22, 0, v12
    s_add_u32 m0, s54, 65536
    s_add_u32 s20, s55, 512
    buffer_load_dwordx4 v22, s[68:71], s20 offen lds
    v_xor_b32 v22, 64, v12
    s_add_u32 m0, s54, 69632
    s_add_u32 s20, s55, 16896
    buffer_load_dwordx4 v22, s[68:71], s20 offen lds
    v_xor_b32 v22, 128, v12
    s_add_u32 m0, s54, 73728
    s_add_u32 s20, s55, 33280
    buffer_load_dwordx4 v22, s[68:71], s20 offen lds
    v_xor_b32 v22, 192, v12
    s_add_u32 m0, s54, 77824
    s_add_u32 s20, s55, 49664
    buffer_load_dwordx4 v22, s[68:71], s20 offen lds
    ds_read_b64_tr_b16 v[168:169], v20 offset:16384
    ds_read_b64_tr_b16 v[170:171], v20 offset:16896
    ds_read_b64_tr_b16 v[172:173], v20 offset:24576
    ds_read_b64_tr_b16 v[174:175], v20 offset:25088
    ds_read_b64_tr_b16 v[40:41], v21 offset:16384
    ds_read_b64_tr_b16 v[42:43], v21 offset:16896
    ds_read_b64_tr_b16 v[44:45], v21 offset:24576
    ds_read_b64_tr_b16 v[46:47], v21 offset:25088
    s_waitcnt vmcnt(24)
    s_waitcnt lgkmcnt(0)
    s_barrier
    v_xor_b32 v22, 0, v12
    s_add_u32 m0, s54, 81920
    s_add_u32 s20, s55, 66048
    buffer_load_dwordx4 v22, s[68:71], s20 offen lds
    v_xor_b32 v22, 64, v12
    s_add_u32 m0, s54, 86016
    s_add_u32 s20, s55, 82432
    buffer_load_dwordx4 v22, s[68:71], s20 offen lds
    v_xor_b32 v22, 128, v12
    s_add_u32 m0, s54, 90112
    s_add_u32 s20, s55, 98816
    buffer_load_dwordx4 v22, s[68:71], s20 offen lds
    v_xor_b32 v22, 192, v12
    s_add_u32 m0, s54, 94208
    s_add_u32 s20, s55, 115200
    buffer_load_dwordx4 v22, s[68:71], s20 offen lds
    ds_read_b64_tr_b16 v[176:177], v20 offset:32768
    ds_read_b64_tr_b16 v[178:179], v20 offset:33280
    ds_read_b64_tr_b16 v[180:181], v20 offset:40960
    ds_read_b64_tr_b16 v[182:183], v20 offset:41472
    ds_read_b64_tr_b16 v[48:49], v21 offset:32768
    ds_read_b64_tr_b16 v[50:51], v21 offset:33280
    ds_read_b64_tr_b16 v[52:53], v21 offset:40960
    ds_read_b64_tr_b16 v[54:55], v21 offset:41472
    s_waitcnt vmcnt(24)
    s_waitcnt lgkmcnt(0)
    s_barrier
    v_xor_b32 v22, 0, v12
    s_add_u32 m0, s54, 98304
    s_add_u32 s20, s55, 768
    buffer_load_dwordx4 v22, s[68:71], s20 offen lds
    v_xor_b32 v22, 64, v12
    s_add_u32 m0, s54, 102400
    s_add_u32 s20, s55, 17152
    buffer_load_dwordx4 v22, s[68:71], s20 offen lds
    v_xor_b32 v22, 128, v12
    s_add_u32 m0, s54, 106496
    s_add_u32 s20, s55, 33536
    buffer_load_dwordx4 v22, s[68:71], s20 offen lds
    v_xor_b32 v22, 192, v12
    s_add_u32 m0, s54, 110592
    s_add_u32 s20, s55, 49920
    buffer_load_dwordx4 v22, s[68:71], s20 offen lds
    ds_read_b64_tr_b16 v[184:185], v20 offset:49152
    ds_read_b64_tr_b16 v[186:187], v20 offset:49664
    ds_read_b64_tr_b16 v[188:189], v20 offset:57344
    ds_read_b64_tr_b16 v[190:191], v20 offset:57856
    ds_read_b64_tr_b16 v[56:57], v21 offset:49152
    ds_read_b64_tr_b16 v[58:59], v21 offset:49664
    ds_read_b64_tr_b16 v[60:61], v21 offset:57344
    ds_read_b64_tr_b16 v[62:63], v21 offset:57856
    s_waitcnt lgkmcnt(0)
    s_barrier
    v_xor_b32 v22, 0, v12
    s_add_u32 m0, s54, 114688
    s_add_u32 s20, s55, 66304
    buffer_load_dwordx4 v22, s[68:71], s20 offen lds
    v_xor_b32 v22, 64, v12
    s_add_u32 m0, s54, 118784
    s_add_u32 s20, s55, 82688
    buffer_load_dwordx4 v22, s[68:71], s20 offen lds
    v_xor_b32 v22, 128, v12
    s_add_u32 m0, s54, 122880
    s_add_u32 s20, s55, 99072
    buffer_load_dwordx4 v22, s[68:71], s20 offen lds
    v_xor_b32 v22, 192, v12
    s_add_u32 m0, s54, 126976
    s_add_u32 s20, s55, 115456
    buffer_load_dwordx4 v22, s[68:71], s20 offen lds
    s_waitcnt vmcnt(0)
    s_barrier
    v_xor_b32 v23, 0, v16
    ds_read_b64_tr_b16 v[192:193], v23 offset:0
    ds_read_b64_tr_b16 v[194:195], v23 offset:512
    ds_read_b64_tr_b16 v[196:197], v23 offset:2048
    ds_read_b64_tr_b16 v[198:199], v23 offset:2560
    v_xor_b32 v23, 32, v16
    ds_read_b64_tr_b16 v[208:209], v23 offset:0
    ds_read_b64_tr_b16 v[210:211], v23 offset:512
    ds_read_b64_tr_b16 v[212:213], v23 offset:2048
    ds_read_b64_tr_b16 v[214:215], v23 offset:2560
    v_xor_b32 v23, 64, v16
    ds_read_b64_tr_b16 v[224:225], v23 offset:0
    ds_read_b64_tr_b16 v[226:227], v23 offset:512
    ds_read_b64_tr_b16 v[228:229], v23 offset:2048
    ds_read_b64_tr_b16 v[230:231], v23 offset:2560
    v_xor_b32 v23, 96, v16
    ds_read_b64_tr_b16 v[240:241], v23 offset:0
    ds_read_b64_tr_b16 v[242:243], v23 offset:512
    ds_read_b64_tr_b16 v[244:245], v23 offset:2048
    ds_read_b64_tr_b16 v[246:247], v23 offset:2560
    v_xor_b32 v23, 128, v16
    ds_read_b64_tr_b16 v[200:201], v23 offset:0
    ds_read_b64_tr_b16 v[202:203], v23 offset:512
    ds_read_b64_tr_b16 v[204:205], v23 offset:2048
    ds_read_b64_tr_b16 v[206:207], v23 offset:2560
    v_xor_b32 v23, 160, v16
    ds_read_b64_tr_b16 v[216:217], v23 offset:0
    ds_read_b64_tr_b16 v[218:219], v23 offset:512
    ds_read_b64_tr_b16 v[220:221], v23 offset:2048
    ds_read_b64_tr_b16 v[222:223], v23 offset:2560
    v_xor_b32 v23, 192, v16
    ds_read_b64_tr_b16 v[232:233], v23 offset:0
    ds_read_b64_tr_b16 v[234:235], v23 offset:512
    ds_read_b64_tr_b16 v[236:237], v23 offset:2048
    ds_read_b64_tr_b16 v[238:239], v23 offset:2560
    v_xor_b32 v23, 224, v16
    ds_read_b64_tr_b16 v[248:249], v23 offset:0
    ds_read_b64_tr_b16 v[250:251], v23 offset:512
    ds_read_b64_tr_b16 v[252:253], v23 offset:2048
    ds_read_b64_tr_b16 v[254:255], v23 offset:2560
    s_waitcnt lgkmcnt(0)
    ds_write_b128 v86, v[96:99] offset:0
    ds_write_b128 v86, v[100:103] offset:1024
    ds_write_b128 v86, v[104:107] offset:2048
    ds_write_b128 v86, v[108:111] offset:3072
    ds_write_b128 v86, v[112:115] offset:4096
    ds_write_b128 v86, v[116:119] offset:5120
    ds_write_b128 v86, v[120:123] offset:6144
    ds_write_b128 v86, v[124:127] offset:7168
    ds_write_b128 v86, v[32:35] offset:8192
    ds_write_b128 v86, v[36:39] offset:9216
    ds_write_b128 v86, v[40:43] offset:10240
    ds_write_b128 v86, v[44:47] offset:11264
    ds_write_b128 v86, v[48:51] offset:12288
    ds_write_b128 v86, v[52:55] offset:13312
    ds_write_b128 v86, v[56:59] offset:14336
    ds_write_b128 v86, v[60:63] offset:15360
    s_waitcnt lgkmcnt(0)
    v_mov_b32 v32, v200
    v_mov_b32 v33, v201
    v_mov_b32 v34, v202
    v_mov_b32 v35, v203
    v_mov_b32 v36, v204
    v_mov_b32 v37, v205
    v_mov_b32 v38, v206
    v_mov_b32 v39, v207
    v_mov_b32 v40, v216
    v_mov_b32 v41, v217
    v_mov_b32 v42, v218
    v_mov_b32 v43, v219
    v_mov_b32 v44, v220
    v_mov_b32 v45, v221
    v_mov_b32 v46, v222
    v_mov_b32 v47, v223
    v_mov_b32 v48, v232
    v_mov_b32 v49, v233
    v_mov_b32 v50, v234
    v_mov_b32 v51, v235
    v_mov_b32 v52, v236
    v_mov_b32 v53, v237
    v_mov_b32 v54, v238
    v_mov_b32 v55, v239
    v_mov_b32 v56, v248
    v_mov_b32 v57, v249
    v_mov_b32 v58, v250
    v_mov_b32 v59, v251
    v_mov_b32 v60, v252
    v_mov_b32 v61, v253
    v_mov_b32 v62, v254
    v_mov_b32 v63, v255
    v_xor_b32 v23, 0, v16
    ds_read_b64_tr_b16 v[200:201], v23 offset:16384
    ds_read_b64_tr_b16 v[202:203], v23 offset:16896
    ds_read_b64_tr_b16 v[204:205], v23 offset:18432
    ds_read_b64_tr_b16 v[206:207], v23 offset:18944
    v_xor_b32 v23, 32, v16
    ds_read_b64_tr_b16 v[216:217], v23 offset:16384
    ds_read_b64_tr_b16 v[218:219], v23 offset:16896
    ds_read_b64_tr_b16 v[220:221], v23 offset:18432
    ds_read_b64_tr_b16 v[222:223], v23 offset:18944
    v_xor_b32 v23, 64, v16
    ds_read_b64_tr_b16 v[232:233], v23 offset:16384
    ds_read_b64_tr_b16 v[234:235], v23 offset:16896
    ds_read_b64_tr_b16 v[236:237], v23 offset:18432
    ds_read_b64_tr_b16 v[238:239], v23 offset:18944
    v_xor_b32 v23, 96, v16
    ds_read_b64_tr_b16 v[248:249], v23 offset:16384
    ds_read_b64_tr_b16 v[250:251], v23 offset:16896
    ds_read_b64_tr_b16 v[252:253], v23 offset:18432
    ds_read_b64_tr_b16 v[254:255], v23 offset:18944
    v_xor_b32 v23, 128, v16
    ds_read_b64_tr_b16 v[96:97], v23 offset:16384
    ds_read_b64_tr_b16 v[98:99], v23 offset:16896
    ds_read_b64_tr_b16 v[100:101], v23 offset:18432
    ds_read_b64_tr_b16 v[102:103], v23 offset:18944
    v_xor_b32 v23, 160, v16
    ds_read_b64_tr_b16 v[104:105], v23 offset:16384
    ds_read_b64_tr_b16 v[106:107], v23 offset:16896
    ds_read_b64_tr_b16 v[108:109], v23 offset:18432
    ds_read_b64_tr_b16 v[110:111], v23 offset:18944
    v_xor_b32 v23, 192, v16
    ds_read_b64_tr_b16 v[112:113], v23 offset:16384
    ds_read_b64_tr_b16 v[114:115], v23 offset:16896
    ds_read_b64_tr_b16 v[116:117], v23 offset:18432
    ds_read_b64_tr_b16 v[118:119], v23 offset:18944
    v_xor_b32 v23, 224, v16
    ds_read_b64_tr_b16 v[120:121], v23 offset:16384
    ds_read_b64_tr_b16 v[122:123], v23 offset:16896
    ds_read_b64_tr_b16 v[124:125], v23 offset:18432
    ds_read_b64_tr_b16 v[126:127], v23 offset:18944
    s_waitcnt lgkmcnt(0)
    ds_write_b128 v86, v[32:35] offset:16384
    ds_write_b128 v86, v[36:39] offset:17408
    ds_write_b128 v86, v[96:99] offset:18432
    ds_write_b128 v86, v[100:103] offset:19456
    ds_write_b128 v86, v[40:43] offset:20480
    ds_write_b128 v86, v[44:47] offset:21504
    ds_write_b128 v86, v[104:107] offset:22528
    ds_write_b128 v86, v[108:111] offset:23552
    ds_write_b128 v86, v[48:51] offset:24576
    ds_write_b128 v86, v[52:55] offset:25600
    ds_write_b128 v86, v[112:115] offset:26624
    ds_write_b128 v86, v[116:119] offset:27648
    ds_write_b128 v86, v[56:59] offset:28672
    ds_write_b128 v86, v[60:63] offset:29696
    ds_write_b128 v86, v[120:123] offset:30720
    ds_write_b128 v86, v[124:127] offset:31744
    s_waitcnt lgkmcnt(0)
    s_mov_b32 s6, 0
    s_mov_b32 s7, 255
    v_mbcnt_lo_u32_b32 v1, -1, 0
    v_and_b32 v1, 15, v1
    v_lshlrev_b32 v1, 2, v1
    s_mov_b32 s97, 0
    s_nop 0
Ltw_3_1:
    buffer_load_dwordx2 v[2:3], off, s[16:19], s96 sc1
    buffer_load_dword v4, v1, s[16:19], 0 offen offset:128 sc1
    s_waitcnt vmcnt(0)
    v_lshlrev_b32 v4, 1, v4
    v_lshrrev_b32 v5, 24, v3
    v_min_u32 v4, v4, v5
    v_cmp_gt_u32 vcc, 32, v4
    s_add_u32 s97, s97, 1
    s_cmp_gt_u32 s97, 30000000
    s_cbranch_scc1 Ltw_3_3
    s_cbranch_vccz Ltw_3_3
    s_sleep 24
    s_branch Ltw_3_1
Ltw_3_3:
    v_readfirstlane_b32 s94, v2
    v_readfirstlane_b32 s95, v3
    s_and_b32 s97, s101, 7
    s_mul_i32 s97, s97, 6
    s_lshr_b64 s[94:95], s[94:95], s97
    s_and_b32 s93, s94, 63
    s_barrier
    s_cmp_lg_u32 s93, 32
    s_cbranch_scc1 Lm_chs
    s_mov_b32 s5, s6
    s_lshr_b32 s46, s4, 3
    s_lshl_b32 s46, s46, 7
    s_add_u32 s46, s46, s43
    s_add_u32 s46, s46, 1024
    s_lshl_b32 s47, s3, 7
    s_add_u32 s47, s47, s82
    s_add_u32 s47, s47, 1024
    s_lshl_b32 s29, s4, 13
    s_add_u32 s29, s29, s31
    s_lshl_b32 s20, s6, 18
    s_add_u32 s29, s29, s20
    s_mov_b32 s30, 134217728
    s_lshl_b32 s91, s4, 2
    s_add_u32 s91, s91, 131072000
    s_mov_b32 s93, s91
    s_lshl_b32 s92, s4, 7
    s_add_u32 s92, s92, 131080192
Lfw_10:
    buffer_load_dword v85, off, s[8:11], s91 sc1
    s_waitcnt vmcnt(0)
    v_cmp_gt_u32 vcc, 3, v85
    s_add_u32 s45, s45, 1
    s_cmp_gt_u32 s45, 200000000
    s_cbranch_scc1 Lfw2_11
    s_sleep 2
    s_cbranch_vccnz Lfw_10
Lfw2_11:
    s_add_u32 s20, s29, 33423360
    buffer_load_dwordx4 v[64:67], v87, s[8:11], s20 offen sc1
    buffer_load_dwordx4 v[68:71], v87, s[8:11], s20 offen offset:1024 sc1
    s_add_u32 m0, s87, 131072
    s_add_u32 s20, s29, 50200576
    buffer_load_dwordx4 v87, s[8:11], s20 offen sc1 lds
    s_add_u32 m0, s87, 134144
    s_nop 0
    buffer_load_dwordx4 v87, s[8:11], s20 offen offset:1024 sc1 lds
    ds_read_b128 v[96:99], v86 offset:0
    ds_read_b128 v[100:103], v86 offset:1024
    ds_read_b128 v[104:107], v86 offset:2048
    ds_read_b128 v[108:111], v86 offset:3072
    ds_read_b128 v[112:115], v86 offset:4096
    ds_read_b128 v[116:119], v86 offset:5120
    ds_read_b128 v[120:123], v86 offset:6144
    ds_read_b128 v[124:127], v86 offset:7168
    v_mov_b32 v32, 0
    v_mov_b32 v33, 0
    v_mov_b32 v34, 0
    v_mov_b32 v35, 0
    v_mov_b32 v36, 0
    v_mov_b32 v37, 0
    v_mov_b32 v38, 0
    v_mov_b32 v39, 0
    v_mov_b32 v40, 0
    v_mov_b32 v41, 0
    v_mov_b32 v42, 0
    v_mov_b32 v43, 0
    v_mov_b32 v44, 0
    v_mov_b32 v45, 0
    v_mov_b32 v46, 0
    v_mov_b32 v47, 0
    v_mov_b32 v48, 0
    v_mov_b32 v49, 0
    v_mov_b32 v50, 0
    v_mov_b32 v51, 0
    v_mov_b32 v52, 0
    v_mov_b32 v53, 0
    v_mov_b32 v54, 0
    v_mov_b32 v55, 0
    v_mov_b32 v78, s90
    v_cndmask_b32 v76, v89, v78, s[76:77]
    v_cndmask_b32 v77, v78, v89, s[76:77]
    v_lshlrev_b32 v78, 1, v88
    v_add_u32 v78, -145408, v78
    v_lshrrev_b32 v79, 1, v87
    v_mov_b32 v56, v79
    v_add_u32 v79, s88, v79
    s_max_i32 s20, s5, 1
    s_sub_u32 s20, s20, 1
    v_mov_b32 v57, s20
    s_waitcnt vmcnt(0) lgkmcnt(0)
    s_nop 0
    s_branch Ltop0_6
Lmd0_8:
    s_nop 15
    s_nop 15
    s_nop 15
    v_lshrrev_b32 v95, 2, v87
    s_mov_b32 exec_hi, 0
    buffer_load_dword v94, v95, s[8:11], s43 offen offset:0 sc1
    s_mov_b32 exec_hi, -1
    s_mov_b32 m0, 139264
    s_nop 0
    buffer_load_dwordx4 v87, s[8:11], s27 offen offset:0 sc1 lds
    buffer_load_dwordx4 v87, s[8:11], s27 offen offset:1024 sc1 lds
    buffer_load_dwordx4 v87, s[8:11], s27 offen offset:2048 sc1 lds
    buffer_load_dwordx4 v87, s[8:11], s27 offen offset:3072 sc1 lds
    s_mov_b32 m0, 143360
    s_nop 0
    buffer_load_dwordx4 v87, s[8:11], s28 offen offset:0 sc1 lds
    buffer_load_dwordx4 v87, s[8:11], s28 offen offset:1024 sc1 lds
    buffer_load_dwordx4 v87, s[8:11], s28 offen offset:2048 sc1 lds
    buffer_load_dwordx4 v87, s[8:11], s28 offen offset:3072 sc1 lds
    v_mov_b32 v78, s90
    v_cndmask_b32 v76, v89, v78, s[76:77]
    v_cndmask_b32 v77, v78, v89, s[76:77]
    v_lshlrev_b32 v78, 1, v88
    v_add_u32 v78, -145408, v78
    v_lshrrev_b32 v79, 1, v87
    v_mov_b32 v56, v79
    v_add_u32 v79, s88, v79
    s_max_i32 s20, s5, 1
    s_sub_u32 s20, s20, 1
    v_mov_b32 v57, s20
    s_mov_b32 exec_hi, 0
    s_waitcnt vmcnt(8)
    v_and_b32 v94, 1, v94
    v_cmp_ne_u32 vcc, 0, v94
    s_mov_b32 exec_hi, -1
    s_cbranch_vccnz Lpr_16
    s_waitcnt vmcnt(0)
Ltop0_6:
    s_waitcnt lgkmcnt(0)
    s_barrier
Lq_13:
    ds_read_b128 v[0:3], v87 offset:8192
    ds_read_b128 v[4:7], v87 offset:9216
    ds_read_b128 v[8:11], v87 offset:10240
    ds_read_b128 v[12:15], v87 offset:11264
    ds_read_b128 v[16:19], v87 offset:12288
    s_waitcnt lgkmcnt(4)
    v_smfmac_f32_16x16x64_bf16 v[32:35], v[0:3], a[0:7], v84
    ds_read_b128 v[20:23], v87 offset:13312
    v_smfmac_f32_16x16x64_bf16 v[36:39], v[0:3], a[64:71], v84
    ds_read_b128 v[24:27], v87 offset:14336
    s_waitcnt lgkmcnt(5)
    v_smfmac_f32_16x16x64_bf16 v[32:35], v[4:7], a[8:15], v84
    ds_read_b128 v[28:31], v87 offset:15360
    v_smfmac_f32_16x16x64_bf16 v[36:39], v[4:7], a[72:79], v84
    s_waitcnt lgkmcnt(5)
    v_smfmac_f32_16x16x64_bf16 v[32:35], v[8:11], a[16:23], v84
    v_smfmac_f32_16x16x64_bf16 v[36:39], v[8:11], a[80:87], v84
    s_waitcnt lgkmcnt(4)
    v_smfmac_f32_16x16x64_bf16 v[32:35], v[12:15], a[24:31], v84
    v_smfmac_f32_16x16x64_bf16 v[36:39], v[12:15], a[88:95], v84
    s_waitcnt lgkmcnt(0)
    v_smfmac_f32_16x16x64_bf16 v[32:35], v[16:19], a[32:39], v84
    v_or_b32 v94, v0, v2
    v_smfmac_f32_16x16x64_bf16 v[36:39], v[16:19], a[96:103], v84
    v_or3_b32 v94, v94, v4, v6
    v_smfmac_f32_16x16x64_bf16 v[32:35], v[20:23], a[40:47], v84
    v_or3_b32 v94, v94, v8, v10
    v_smfmac_f32_16x16x64_bf16 v[36:39], v[20:23], a[104:111], v84
    v_or3_b32 v94, v94, v12, v14
    v_smfmac_f32_16x16x64_bf16 v[32:35], v[24:27], a[48:55], v84
    v_or3_b32 v94, v94, v16, v18
    v_smfmac_f32_16x16x64_bf16 v[36:39], v[24:27], a[112:119], v84
    v_or3_b32 v94, v94, v20, v22
    v_smfmac_f32_16x16x64_bf16 v[32:35], v[28:31], a[56:63], v84
    v_or3_b32 v94, v94, v24, v26
    v_smfmac_f32_16x16x64_bf16 v[36:39], v[28:31], a[120:127], v84
    v_or3_b32 v94, v94, v28, v30
    v_smfmac_f32_16x16x64_bf16 v[40:43], v[0:3], a[128:135], v84
    s_add_u32 s23, s30, 66977792
    buffer_store_dwordx4 v[72:75], v87, s[8:11], s23 offen sc1
    v_and_b32 v94, 1, v94
    v_smfmac_f32_16x16x64_bf16 v[44:47], v[0:3], a[192:199], v84
    s_lshr_b32 s23, s30, 1
    s_add_u32 s23, s23, 75431936
    v_cmp_ne_u32 vcc, 0, v94
    v_smfmac_f32_16x16x64_bf16 v[40:43], v[4:7], a[136:143], v84
    s_lshr_b32 s30, s29, 1
    buffer_store_dwordx2 v[82:83], v56, s[8:11], s23 offen sc1
    v_add_f32 v32, v32, v33
    v_smfmac_f32_16x16x64_bf16 v[44:47], v[4:7], a[200:207], v84
    s_add_u32 s29, s29, 262144
    s_cbranch_vccnz Lfail_12
Lqok_14:
    v_add_f32 v34, v34, v35
    v_smfmac_f32_16x16x64_bf16 v[40:43], v[8:11], a[144:151], v84
    s_add_u32 s20, s29, 33423360
    v_add_f32 v36, v36, v37
    v_smfmac_f32_16x16x64_bf16 v[44:47], v[8:11], a[208:215], v84
    s_add_u32 s21, s5, 2
    s_min_u32 s21, s21, 63
    v_add_f32 v38, v38, v39
    v_smfmac_f32_16x16x64_bf16 v[40:43], v[12:15], a[152:159], v84
    s_lshr_b32 s21, s21, 2
    s_lshl_b32 s21, s21, 7
    v_cvt_pk_bf16_f32 v32, v32, v34
    v_smfmac_f32_16x16x64_bf16 v[44:47], v[12:15], a[216:223], v84
    v_cvt_pk_bf16_f32 v36, v36, v38
    v_smfmac_f32_16x16x64_bf16 v[40:43], v[16:19], a[160:167], v84
    s_nop 0
    ds_write2_b32 v88, v32, v36 offset0:0 offset1:64
    ds_read_b64_tr_b16 v[56:57], v76
    v_smfmac_f32_16x16x64_bf16 v[44:47], v[16:19], a[224:231], v84
    ds_read_b64_tr_b16 v[58:59], v76 offset:256
    ds_read_b64_tr_b16 v[60:61], v77
    ds_read_b64_tr_b16 v[62:63], v77 offset:256
    v_smfmac_f32_16x16x64_bf16 v[40:43], v[20:23], a[168:175], v84
    v_add_u32 v76, s87, v87
    v_smfmac_f32_16x16x64_bf16 v[44:47], v[20:23], a[232:239], v84
    v_cmp_gt_u32 vcc, 3, v85
    v_smfmac_f32_16x16x64_bf16 v[40:43], v[24:27], a[176:183], v84
    v_smfmac_f32_16x16x64_bf16 v[44:47], v[24:27], a[240:247], v84
    s_cbranch_vccnz Lfl_17
Lflb_18:
    s_add_u32 s91, s21, s93
    v_smfmac_f32_16x16x64_bf16 v[40:43], v[28:31], a[184:191], v84
    buffer_load_dword v85, off, s[8:11], s91 sc1
    v_smfmac_f32_16x16x64_bf16 v[44:47], v[28:31], a[248:255], v84
    s_waitcnt lgkmcnt(0)
    v_mfma_f32_16x16x32_bf16 v[32:35], v[64:67], v[56:59], 0
    v_add_f32 v40, v40, v41
    v_add_f32 v42, v42, v43
    v_mfma_f32_16x16x32_bf16 v[32:35], v[68:71], v[60:63], v[32:35]
    v_cvt_pk_bf16_f32 v40, v40, v42
    v_add_f32 v44, v44, v45
    v_add_f32 v46, v46, v47
    v_cvt_pk_bf16_f32 v44, v44, v46
    v_smfmac_f32_16x16x64_bf16 v[52:55], v[0:3], v[96:103], v84
    s_nop 0
    ds_write2_b32 v78, v40, v44 offset0:0 offset1:128
    ds_read_b64_tr_b16 v[72:73], v79
    v_smfmac_f32_16x16x64_bf16 v[48:51], v[0:3], v[128:135], v84
    ds_read_b64_tr_b16 v[74:75], v79 offset:512
    v_smfmac_f32_16x16x64_bf16 v[52:55], v[4:7], v[104:111], v84
    ds_write_b128 v76, v[32:35] offset:22528
    v_smfmac_f32_16x16x64_bf16 v[48:51], v[4:7], v[136:143], v84
    ds_read_b128 v[96:99], v86 offset:8192
    v_mov_b32 v0, 0
    v_smfmac_f32_16x16x64_bf16 v[52:55], v[8:11], v[112:119], v84
    s_waitcnt lgkmcnt(2)
    ds_read_b128 v[100:103], v86 offset:9216
    v_mfma_f32_16x16x32_bf16 v[40:43], v[72:75], v[56:59], 0
    ds_read_b128 v[104:107], v86 offset:10240
    v_mov_b32 v1, 0
    v_mfma_f32_16x16x32_bf16 v[40:43], v[72:75], v[60:63], v[40:43]
    v_mov_b32 v2, 0
    v_mov_b32 v3, 0
    v_smfmac_f32_16x16x64_bf16 v[48:51], v[8:11], v[144:151], v84
    s_waitcnt lgkmcnt(3)
    s_barrier
    ds_read_b128 v[32:35], v87 offset:22528
    ds_read_b128 v[36:39], v87 offset:23552
    v_smfmac_f32_16x16x64_bf16 v[52:55], v[12:15], v[120:127], v84
    ds_read_b128 v[44:47], v87 offset:24576
    ds_read_b128 v[80:83], v87 offset:25600
    v_cndmask_b32 v40, v40, v41, s[40:41]
    v_smfmac_f32_16x16x64_bf16 v[48:51], v[12:15], v[152:159], v84
    s_add_u32 m0, s87, 139264
    ds_write_b32 v91, v40 offset:29696
    ds_read_b128 v[108:111], v86 offset:11264
    v_smfmac_f32_16x16x64_bf16 v[48:51], v[16:19], v[160:167], v84
    ds_read_b128 v[112:115], v86 offset:12288
    ds_read_b128 v[116:119], v86 offset:13312
    v_smfmac_f32_16x16x64_bf16 v[48:51], v[20:23], v[168:175], v84
    buffer_load_dwordx4 v[64:67], v87, s[8:11], s20 offen sc1
    ds_read_b128 v[120:123], v86 offset:14336
    v_smfmac_f32_16x16x64_bf16 v[48:51], v[24:27], v[176:183], v84
    ds_read_b128 v[124:127], v86 offset:15360
    s_waitcnt lgkmcnt(8)
    v_add_f32 v32, v32, v36
    v_add_f32 v33, v33, v37
    v_add_f32 v34, v34, v38
    v_add_f32 v35, v35, v39
    v_smfmac_f32_16x16x64_bf16 v[48:51], v[28:31], v[184:191], v84
    s_waitcnt lgkmcnt(6)
    v_add_f32 v44, v44, v80
    v_add_f32 v45, v45, v81
    v_add_f32 v46, v46, v82
    v_add_f32 v47, v47, v83
    v_smfmac_f32_16x16x64_bf16 v[52:55], v[16:19], v[96:103], v84
    s_waitcnt lgkmcnt(5)
    s_barrier
    ds_read_b128 v[40:43], v87 offset:29696
    s_waitcnt lgkmcnt(5)
    v_smfmac_f32_16x16x64_bf16 v[52:55], v[20:23], v[104:111], v84
    ds_read_b64 v[82:83], v76 offset:4096
    ds_read_b64 v[80:81], v76 offset:4104
    v_add_f32 v32, v32, v44
    s_waitcnt lgkmcnt(5)
    v_smfmac_f32_16x16x64_bf16 v[52:55], v[24:27], v[112:119], v84
    buffer_load_dwordx4 v[68:71], v87, s[8:11], s20 offen offset:1024 sc1
    ds_read_b128 v[76:79], v76 offset:0
    v_add_f32 v33, v33, v45
    v_add_f32 v34, v34, v46
    s_waitcnt lgkmcnt(4)
    v_smfmac_f32_16x16x64_bf16 v[52:55], v[28:31], v[120:127], v84
    s_add_u32 s22, s29, 50200576
    buffer_load_dwordx4 v87, s[8:11], s22 offen sc1 lds
    ds_read_b128 v[96:99], v86 offset:16384
    ds_read_b128 v[100:103], v86 offset:17408
    v_add_f32 v35, v35, v47
    v_max3_f32 v94, v32, v33, v34
    s_waitcnt lgkmcnt(5)
    v_add_f32 v40, v40, v41
    v_add_f32 v42, v42, v43
    v_add_f32 v40, v40, v42
    v_max3_f32 v94, v94, v35, v40
    v_add_f32 v48, v48, v49
    v_add_f32 v50, v50, v51
    v_max_f32_dpp v94, v94, v94 row_ror:8 row_mask:0xf bank_mask:0xf
    v_mov_b32 v95, v94
    v_cvt_pk_bf16_f32 v48, v48, v50
    v_mov_b32 v49, 0
    v_permlane32_swap_b32 v94, v95
    v_max_f32 v94, v94, v95
    v_mov_b32 v95, v94
    v_add_f32 v52, v52, v53
    v_add_f32 v54, v54, v55
    v_permlane16_swap_b32 v94, v95
    v_max_f32 v94, v94, v95
    v_mul_f32 v94, s42, v94
    v_fma_f32 v32, v32, s42, -v94
    v_fma_f32 v33, v33, s42, -v94
    v_exp_f32 v32, v32
    v_exp_f32 v33, v33
    v_fma_f32 v34, v34, s42, -v94
    v_fma_f32 v35, v35, s42, -v94
    v_cvt_pk_bf16_f32 v44, v32, v33
    v_exp_f32 v34, v34
    v_exp_f32 v35, v35
    v_fma_f32 v40, v40, s42, -v94
    v_cvt_pk_bf16_f32 v45, v34, v35
    v_mov_b32_dpp v46, v44 row_ror:8 row_mask:0xf bank_mask:0xf
    v_exp_f32 v40, v40
    v_mov_b32_dpp v47, v45 row_ror:8 row_mask:0xf bank_mask:0xf
    v_cvt_pk_bf16_f32 v52, v54, v52
    v_mov_b32_dpp v41, v40 row_ror:8 row_mask:0xf bank_mask:0xf
    v_mov_b32 v53, 0
    v_cvt_pk_bf16_f32 v42, v40, v41
    s_waitcnt lgkmcnt(2)
    v_mfma_f32_16x16x32_bf16 v[56:59], v[76:79], v[44:47], 0
    s_add_u32 m0, s87, 142336
    ds_read_b128 v[104:107], v86 offset:18432
    v_mov_b32 v43, 0
    v_mfma_f32_16x16x32_bf16 v[60:63], v[80:83], v[44:47], 0
    v_add_f32 v32, v32, v33
    v_add_f32 v34, v34, v35
    v_mfma_f32_16x16x16_bf16 v[56:59], v[48:49], v[42:43], v[56:59]
    v_add_f32 v32, v32, v40
    v_add_f32 v94, v32, v34
    v_mfma_f32_16x16x16_bf16 v[60:63], v[52:53], v[42:43], v[60:63]
    s_nop 0
    ds_read_b128 v[108:111], v86 offset:19456
    ds_read_b128 v[112:115], v86 offset:20480
    v_add_f32_dpp v94, v94, v94 row_ror:8 row_mask:0xf bank_mask:0xf
    v_mov_b32 v95, v94
    v_mov_b32 v4, 0
    v_mov_b32 v5, 0
    v_permlane32_swap_b32 v94, v95
    v_add_f32 v94, v94, v95
    v_mov_b32 v95, v94
    v_cndmask_b32 v56, v56, v60, s[40:41]
    v_cndmask_b32 v57, v57, v61, s[40:41]
    v_permlane16_swap_b32 v94, v95
    v_add_f32 v94, v94, v95
    v_rcp_f32 v94, v94
    v_cndmask_b32 v58, v58, v62, s[40:41]
    v_cndmask_b32 v59, v59, v63, s[40:41]
    v_mul_f32 v56, v56, v94
    v_mul_f32 v57, v57, v94
    v_mul_f32 v58, v58, v94
    v_mul_f32 v59, v59, v94
    v_cvt_pk_bf16_f32 v32, v56, v57
    v_cvt_pk_bf16_f32 v33, v58, v59
    v_mfma_f32_16x16x4_f32 v[40:43], v84, v84, 0
    s_nop 0
    ds_write_b64 v90, v[32:33]
    ds_read_b128 v[116:119], v86 offset:21504
    ds_read_b128 v[120:123], v86 offset:22528
    buffer_load_dwordx4 v87, s[8:11], s22 offen offset:1024 sc1 lds
    v_mov_b32 v6, 0
    v_mov_b32 v7, 0
    v_mov_b32 v8, 0
    v_mov_b32 v9, 0
    v_mov_b32 v10, 0
    v_mov_b32 v11, 0
    v_mov_b32 v12, 0
    v_mov_b32 v13, 0
    v_mov_b32 v14, 0
    v_mov_b32 v15, 0
    v_mfma_f32_16x16x4_f32 v[44:47], v84, v84, 0
    ds_read_b128 v[124:127], v86 offset:23552
    s_waitcnt lgkmcnt(3)
    s_barrier
    ds_read_b128 v[56:59], v87 offset:16384
    ds_read_b128 v[60:63], v87 offset:17408
    v_mov_b32 v16, 0
    v_mov_b32 v17, 0
    v_mov_b32 v18, 0
    v_mov_b32 v19, 0
    v_mov_b32 v20, 0
    v_mov_b32 v21, 0
    v_mov_b32 v22, 0
    v_mov_b32 v23, 0
    v_mov_b32 v24, 0
    v_mov_b32 v25, 0
    v_mov_b32 v26, 0
    v_mov_b32 v27, 0
    v_mov_b32 v82, v48
    v_alignbit_b32 v83, v52, v52, 16
    s_waitcnt lgkmcnt(0)
    v_smfmac_f32_16x16x64_bf16 v[16:19], v[56:59], v[96:103], v84
    v_mov_b32 v28, 0
    v_smfmac_f32_16x16x64_bf16 v[20:23], v[56:59], v[112:119], v84
    ds_read_b128 v[96:99], v86 offset:24576
    v_mov_b32 v29, 0
    v_smfmac_f32_16x16x64_bf16 v[16:19], v[60:63], v[104:111], v84
    ds_read_b128 v[100:103], v86 offset:25600
    v_mov_b32 v30, 0
    v_smfmac_f32_16x16x64_bf16 v[20:23], v[60:63], v[120:127], v84
    ds_read_b128 v[104:107], v86 offset:26624
    v_mov_b32 v31, 0
    v_smfmac_f32_16x16x64_bf16 v[0:3], v[56:59], v[192:199], v84
    ds_read_b128 v[108:111], v86 offset:27648
    v_add_f32 v16, v16, v17
    v_smfmac_f32_16x16x64_bf16 v[4:7], v[56:59], v[208:215], v84
    ds_read_b128 v[112:115], v86 offset:28672
    v_add_f32 v18, v18, v19
    v_smfmac_f32_16x16x64_bf16 v[0:3], v[60:63], v[200:207], v84
    ds_read_b128 v[116:119], v86 offset:29696
    v_add_f32 v20, v20, v21
    v_add_f32 v22, v22, v23
    v_smfmac_f32_16x16x64_bf16 v[4:7], v[60:63], v[216:223], v84
    ds_read_b128 v[120:123], v86 offset:30720
    v_cvt_pk_bf16_f32 v36, v16, v18
    v_and_b32 v36, -2, v36
    v_smfmac_f32_16x16x64_bf16 v[8:11], v[56:59], v[224:231], v84
    ds_read_b128 v[124:127], v86 offset:31744
    v_cvt_pk_bf16_f32 v37, v20, v22
    v_add_f32 v0, v0, v1
    v_smfmac_f32_16x16x64_bf16 v[12:15], v[56:59], v[240:247], v84
    s_nop 0
    buffer_store_dwordx2 v[36:37], v92, s[8:11], s74 offen
    v_add_f32 v2, v2, v3
    v_smfmac_f32_16x16x64_bf16 v[8:11], v[60:63], v[232:239], v84
    v_add_f32 v4, v4, v5
    v_add_f32 v6, v6, v7
    v_smfmac_f32_16x16x64_bf16 v[12:15], v[60:63], v[248:255], v84
    s_waitcnt lgkmcnt(4)
    v_cvt_pk_bf16_f32 v32, v0, v2
    v_and_b32 v32, -2, v32
    v_smfmac_f32_16x16x64_bf16 v[24:27], v[56:59], v[96:103], v84
    v_cvt_pk_bf16_f32 v33, v4, v6
    v_add_f32 v8, v8, v9
    v_smfmac_f32_16x16x64_bf16 v[24:27], v[60:63], v[104:111], v84
    s_waitcnt lgkmcnt(0)
    buffer_store_dwordx2 v[32:33], v92, s[8:11], s72 offen
    v_add_f32 v10, v10, v11
    v_smfmac_f32_16x16x64_bf16 v[28:31], v[56:59], v[112:119], v84
    v_add_f32 v12, v12, v13
    v_add_f32 v14, v14, v15
    v_smfmac_f32_16x16x64_bf16 v[28:31], v[60:63], v[120:127], v84
    v_cvt_pk_bf16_f32 v34, v8, v10
    v_and_b32 v34, -2, v34
    v_cvt_pk_bf16_f32 v35, v12, v14
    v_add_f32 v24, v24, v25
    v_add_f32 v26, v26, v27
    v_cvt_pk_bf16_f32 v38, v24, v26
    v_and_b32 v38, -2, v38
    buffer_store_dwordx2 v[34:35], v92, s[8:11], s73 offen
    v_add_f32 v28, v28, v29
    v_add_f32 v30, v30, v31
    v_cvt_pk_bf16_f32 v39, v28, v30
    buffer_store_dwordx2 v[38:39], v92, s[8:11], s75 offen
    s_mov_b64 exec, 1
    buffer_store_dword v38, off, s[8:11], s47
    s_mov_b64 exec, -1
    s_add_u32 s5, s5, 1
    s_cmp_eq_u32 s3, 0
    s_cbranch_scc1 Lw0_15
    ds_read_b128 v[96:99], v86 offset:0
    ds_read_b128 v[100:103], v86 offset:1024
    ds_read_b128 v[104:107], v86 offset:2048
    ds_read_b128 v[108:111], v86 offset:3072
    ds_read_b128 v[112:115], v86 offset:4096
    ds_read_b128 v[116:119], v86 offset:5120
    ds_read_b128 v[120:123], v86 offset:6144
    ds_read_b128 v[124:127], v86 offset:7168
    v_mov_b32 v32, 0
    v_mov_b32 v33, 0
    v_mov_b32 v34, 0
    v_mov_b32 v35, 0
    v_mov_b32 v36, 0
    v_mov_b32 v37, 0
    v_mov_b32 v38, 0
    v_mov_b32 v39, 0
    v_mov_b32 v40, 0
    v_mov_b32 v41, 0
    v_mov_b32 v42, 0
    v_mov_b32 v43, 0
    v_mov_b32 v44, 0
    v_mov_b32 v45, 0
    v_mov_b32 v46, 0
    v_mov_b32 v47, 0
    v_mov_b32 v48, 0
    v_mov_b32 v49, 0
    v_mov_b32 v50, 0
    v_mov_b32 v51, 0
    v_mov_b32 v52, 0
    v_mov_b32 v53, 0
    v_mov_b32 v54, 0
    v_mov_b32 v55, 0
    v_mov_b32 v78, s90
    v_cndmask_b32 v76, v89, v78, s[76:77]
    v_cndmask_b32 v77, v78, v89, s[76:77]
    v_lshlrev_b32 v78, 1, v88
    v_add_u32 v78, -145408, v78
    v_lshrrev_b32 v79, 1, v87
    v_mov_b32 v56, v79
    v_add_u32 v79, s88, v79
    s_max_i32 s20, s5, 1
    s_sub_u32 s20, s20, 1
    v_mov_b32 v57, s20
    s_waitcnt vmcnt(0)
    s_nop 0
    s_branch Ltop1_7
Lw0_15:
    s_nop 15
    s_nop 15
    s_nop 15
    s_nop 15
    v_lshrrev_b32 v77, 2, v87
    s_mov_b32 exec_hi, 0
    buffer_load_dword v76, v77, s[8:11], s46 offen sc1
    s_mov_b32 exec_hi, -1
    buffer_load_dwordx4 v[0:3], v87, s[8:11], s85 offen offset:0 sc1
    buffer_load_dwordx4 v[4:7], v87, s[8:11], s85 offen offset:1024 sc1
    buffer_load_dwordx4 v[8:11], v87, s[8:11], s85 offen offset:2048 sc1
    buffer_load_dwordx4 v[12:15], v87, s[8:11], s85 offen offset:3072 sc1
    buffer_load_dwordx4 v[16:19], v87, s[8:11], s86 offen offset:0 sc1
    buffer_load_dwordx4 v[20:23], v87, s[8:11], s86 offen offset:1024 sc1
    buffer_load_dwordx4 v[24:27], v87, s[8:11], s86 offen offset:2048 sc1
    buffer_load_dwordx4 v[28:31], v87, s[8:11], s86 offen offset:3072 sc1
    ds_read_b128 v[96:99], v86 offset:0
    ds_read_b128 v[100:103], v86 offset:1024
    ds_read_b128 v[104:107], v86 offset:2048
    ds_read_b128 v[108:111], v86 offset:3072
    ds_read_b128 v[112:115], v86 offset:4096
    ds_read_b128 v[116:119], v86 offset:5120
    ds_read_b128 v[120:123], v86 offset:6144
    ds_read_b128 v[124:127], v86 offset:7168
    v_and_b32 v94, 16, v87
    v_mov_b32 v95, 0x3f80
    v_lshlrev_b32 v94, v94, v95
    v_cndmask_b32 v56, 0, v94, s[32:33]
    v_cndmask_b32 v57, 0, v94, s[34:35]
    v_cndmask_b32 v58, 0, v94, s[36:37]
    v_cndmask_b32 v59, 0, v94, s[38:39]
    v_mov_b32 v32, 0
    v_mov_b32 v33, 0
    v_mov_b32 v34, 0
    v_mov_b32 v35, 0
    v_mov_b32 v36, 0
    v_mov_b32 v37, 0
    v_mov_b32 v38, 0
    v_mov_b32 v39, 0
    v_mov_b32 v40, 0
    v_mov_b32 v41, 0
    v_mov_b32 v42, 0
    v_mov_b32 v43, 0
    v_mov_b32 v44, 0
    v_mov_b32 v45, 0
    v_mov_b32 v46, 0
    v_mov_b32 v47, 0
    v_mov_b32 v48, 0
    v_mov_b32 v49, 0
    v_mov_b32 v50, 0
    v_mov_b32 v51, 0
    v_mov_b32 v52, 0
    v_mov_b32 v53, 0
    v_mov_b32 v54, 0
    v_mov_b32 v55, 0
Lg0_19:
    s_mov_b32 exec_hi, 0
    s_waitcnt vmcnt(8)
    v_and_b32 v76, 1, v76
    v_cmp_ne_u32 vcc, 0, v76
    s_mov_b32 exec_hi, -1
    s_cbranch_vccnz Lgr_20
    s_waitcnt vmcnt(7)
    v_mfma_f32_16x16x32_bf16 v[60:63], v[0:3], v[56:59], 0
    v_or_b32 v94, v0, v2
    s_waitcnt vmcnt(6)
    v_mfma_f32_16x16x32_bf16 v[60:63], v[4:7], v[56:59], v[60:63]
    v_or3_b32 v94, v94, v4, v6
    s_waitcnt vmcnt(5)
    v_mfma_f32_16x16x32_bf16 v[60:63], v[8:11], v[56:59], v[60:63]
    v_or3_b32 v94, v94, v8, v10
    s_waitcnt vmcnt(4)
    v_mfma_f32_16x16x32_bf16 v[60:63], v[12:15], v[56:59], v[60:63]
    v_or3_b32 v94, v94, v12, v14
    s_waitcnt vmcnt(3)
    v_mfma_f32_16x16x32_bf16 v[60:63], v[16:19], v[56:59], v[60:63]
    v_or3_b32 v94, v94, v16, v18
    s_waitcnt vmcnt(2)
    v_mfma_f32_16x16x32_bf16 v[60:63], v[20:23], v[56:59], v[60:63]
    v_or3_b32 v94, v94, v20, v22
    s_waitcnt vmcnt(1)
    v_mfma_f32_16x16x32_bf16 v[60:63], v[24:27], v[56:59], v[60:63]
    v_or3_b32 v94, v94, v24, v26
    s_waitcnt vmcnt(0)
    v_mfma_f32_16x16x32_bf16 v[60:63], v[28:31], v[56:59], v[60:63]
    v_or3_b32 v94, v94, v28, v30
    v_and_b32 v94, 1, v94
    v_cmp_ne_u32 vcc, 0, v94
    s_cbranch_vccnz Lgr_20
Lgo_21:
    s_nop 3
    v_cvt_pk_bf16_f32 v80, v60, v61
    v_cvt_pk_bf16_f32 v81, v62, v63
    v_or_b32 v80, 1, v80
    buffer_store_dwordx2 v[80:81], v93, s[8:11], s26 offen
    s_mov_b64 exec, 1
    buffer_store_dword v80, off, s[8:11], s82
    s_mov_b64 exec, -1
Lmd1_9:
    s_nop 15
    s_nop 15
    s_nop 15
    v_lshrrev_b32 v95, 2, v87
    s_mov_b32 exec_hi, 0
    buffer_load_dword v94, v95, s[8:11], s43 offen offset:0 sc1
    s_mov_b32 exec_hi, -1
    s_mov_b32 m0, 131072
    s_nop 0
    buffer_load_dwordx4 v87, s[8:11], s27 offen offset:0 sc1 lds
    buffer_load_dwordx4 v87, s[8:11], s27 offen offset:1024 sc1 lds
    buffer_load_dwordx4 v87, s[8:11], s27 offen offset:2048 sc1 lds
    buffer_load_dwordx4 v87, s[8:11], s27 offen offset:3072 sc1 lds
    s_mov_b32 m0, 135168
    s_nop 0
    buffer_load_dwordx4 v87, s[8:11], s28 offen offset:0 sc1 lds
    buffer_load_dwordx4 v87, s[8:11], s28 offen offset:1024 sc1 lds
    buffer_load_dwordx4 v87, s[8:11], s28 offen offset:2048 sc1 lds
    buffer_load_dwordx4 v87, s[8:11], s28 offen offset:3072 sc1 lds
    v_mov_b32 v78, s90
    v_cndmask_b32 v76, v89, v78, s[76:77]
    v_cndmask_b32 v77, v78, v89, s[76:77]
    v_lshlrev_b32 v78, 1, v88
    v_add_u32 v78, -145408, v78
    v_lshrrev_b32 v79, 1, v87
    v_mov_b32 v56, v79
    v_add_u32 v79, s88, v79
    s_max_i32 s20, s5, 1
    s_sub_u32 s20, s20, 1
    v_mov_b32 v57, s20
    s_mov_b32 exec_hi, 0
    s_waitcnt vmcnt(8)
    v_and_b32 v94, 1, v94
    v_cmp_ne_u32 vcc, 1, v94
    s_mov_b32 exec_hi, -1
    s_cbranch_vccnz Lpr_26
    s_waitcnt vmcnt(0)
Ltop1_7:
    s_waitcnt lgkmcnt(0)
    s_barrier
Lq_23:
    ds_read_b128 v[0:3], v87 offset:0
    ds_read_b128 v[4:7], v87 offset:1024
    ds_read_b128 v[8:11], v87 offset:2048
    ds_read_b128 v[12:15], v87 offset:3072
    ds_read_b128 v[16:19], v87 offset:4096
    s_waitcnt lgkmcnt(4)
    v_smfmac_f32_16x16x64_bf16 v[32:35], v[0:3], a[0:7], v84
    ds_read_b128 v[20:23], v87 offset:5120
    v_smfmac_f32_16x16x64_bf16 v[36:39], v[0:3], a[64:71], v84
    ds_read_b128 v[24:27], v87 offset:6144
    s_waitcnt lgkmcnt(5)
    v_smfmac_f32_16x16x64_bf16 v[32:35], v[4:7], a[8:15], v84
    ds_read_b128 v[28:31], v87 offset:7168
    v_smfmac_f32_16x16x64_bf16 v[36:39], v[4:7], a[72:79], v84
    s_waitcnt lgkmcnt(5)
    v_smfmac_f32_16x16x64_bf16 v[32:35], v[8:11], a[16:23], v84
    v_smfmac_f32_16x16x64_bf16 v[36:39], v[8:11], a[80:87], v84
    s_waitcnt lgkmcnt(4)
    v_smfmac_f32_16x16x64_bf16 v[32:35], v[12:15], a[24:31], v84
    v_smfmac_f32_16x16x64_bf16 v[36:39], v[12:15], a[88:95], v84
    s_waitcnt lgkmcnt(0)
    v_smfmac_f32_16x16x64_bf16 v[32:35], v[16:19], a[32:39], v84
    v_and_b32 v94, v0, v2
    v_smfmac_f32_16x16x64_bf16 v[36:39], v[16:19], a[96:103], v84
    v_bitop3_b32 v94, v94, v4, v6 bitop3:0x80
    v_smfmac_f32_16x16x64_bf16 v[32:35], v[20:23], a[40:47], v84
    v_bitop3_b32 v94, v94, v8, v10 bitop3:0x80
    v_smfmac_f32_16x16x64_bf16 v[36:39], v[20:23], a[104:111], v84
    v_bitop3_b32 v94, v94, v12, v14 bitop3:0x80
    v_smfmac_f32_16x16x64_bf16 v[32:35], v[24:27], a[48:55], v84
    v_bitop3_b32 v94, v94, v16, v18 bitop3:0x80
    v_smfmac_f32_16x16x64_bf16 v[36:39], v[24:27], a[112:119], v84
    v_bitop3_b32 v94, v94, v20, v22 bitop3:0x80
    v_smfmac_f32_16x16x64_bf16 v[32:35], v[28:31], a[56:63], v84
    v_bitop3_b32 v94, v94, v24, v26 bitop3:0x80
    v_smfmac_f32_16x16x64_bf16 v[36:39], v[28:31], a[120:127], v84
    v_bitop3_b32 v94, v94, v28, v30 bitop3:0x80
    v_smfmac_f32_16x16x64_bf16 v[40:43], v[0:3], a[128:135], v84
    s_add_u32 s23, s30, 66977792
    buffer_store_dwordx4 v[72:75], v87, s[8:11], s23 offen sc1
    v_and_b32 v94, 1, v94
    v_smfmac_f32_16x16x64_bf16 v[44:47], v[0:3], a[192:199], v84
    s_lshr_b32 s23, s30, 1
    s_add_u32 s23, s23, 75431936
    v_cmp_ne_u32 vcc, 1, v94
    v_smfmac_f32_16x16x64_bf16 v[40:43], v[4:7], a[136:143], v84
    s_lshr_b32 s30, s29, 1
    buffer_store_dwordx2 v[82:83], v56, s[8:11], s23 offen sc1
    v_add_f32 v32, v32, v33
    v_smfmac_f32_16x16x64_bf16 v[44:47], v[4:7], a[200:207], v84
    s_add_u32 s29, s29, 262144
    s_cbranch_vccnz Lfail_22
Lqok_24:
    v_add_f32 v34, v34, v35
    v_smfmac_f32_16x16x64_bf16 v[40:43], v[8:11], a[144:151], v84
    s_add_u32 s20, s29, 33423360
    v_add_f32 v36, v36, v37
    v_smfmac_f32_16x16x64_bf16 v[44:47], v[8:11], a[208:215], v84
    s_add_u32 s21, s5, 2
    s_min_u32 s21, s21, 63
    v_add_f32 v38, v38, v39
    v_smfmac_f32_16x16x64_bf16 v[40:43], v[12:15], a[152:159], v84
    s_lshr_b32 s21, s21, 2
    s_lshl_b32 s21, s21, 7
    v_cvt_pk_bf16_f32 v32, v32, v34
    v_smfmac_f32_16x16x64_bf16 v[44:47], v[12:15], a[216:223], v84
    v_cvt_pk_bf16_f32 v36, v36, v38
    v_smfmac_f32_16x16x64_bf16 v[40:43], v[16:19], a[160:167], v84
    s_nop 0
    ds_write2_b32 v88, v32, v36 offset0:0 offset1:64
    ds_read_b64_tr_b16 v[56:57], v76
    v_smfmac_f32_16x16x64_bf16 v[44:47], v[16:19], a[224:231], v84
    ds_read_b64_tr_b16 v[58:59], v76 offset:256
    ds_read_b64_tr_b16 v[60:61], v77
    ds_read_b64_tr_b16 v[62:63], v77 offset:256
    v_smfmac_f32_16x16x64_bf16 v[40:43], v[20:23], a[168:175], v84
    v_add_u32 v76, s87, v87
    v_smfmac_f32_16x16x64_bf16 v[44:47], v[20:23], a[232:239], v84
    v_cmp_gt_u32 vcc, 3, v85
    v_smfmac_f32_16x16x64_bf16 v[40:43], v[24:27], a[176:183], v84
    v_smfmac_f32_16x16x64_bf16 v[44:47], v[24:27], a[240:247], v84
    s_cbranch_vccnz Lfl_27
Lflb_28:
    s_add_u32 s91, s21, s93
    v_smfmac_f32_16x16x64_bf16 v[40:43], v[28:31], a[184:191], v84
    buffer_load_dword v85, off, s[8:11], s91 sc1
    v_smfmac_f32_16x16x64_bf16 v[44:47], v[28:31], a[248:255], v84
    s_waitcnt lgkmcnt(0)
    v_mfma_f32_16x16x32_bf16 v[32:35], v[64:67], v[56:59], 0
    v_add_f32 v40, v40, v41
    v_add_f32 v42, v42, v43
    v_mfma_f32_16x16x32_bf16 v[32:35], v[68:71], v[60:63], v[32:35]
    v_cvt_pk_bf16_f32 v40, v40, v42
    v_add_f32 v44, v44, v45
    v_add_f32 v46, v46, v47
    v_cvt_pk_bf16_f32 v44, v44, v46
    v_smfmac_f32_16x16x64_bf16 v[52:55], v[0:3], v[96:103], v84
    s_nop 0
    ds_write2_b32 v78, v40, v44 offset0:0 offset1:128
    ds_read_b64_tr_b16 v[72:73], v79
    v_smfmac_f32_16x16x64_bf16 v[48:51], v[0:3], v[128:135], v84
    ds_read_b64_tr_b16 v[74:75], v79 offset:512
    v_smfmac_f32_16x16x64_bf16 v[52:55], v[4:7], v[104:111], v84
    ds_write_b128 v76, v[32:35] offset:22528
    v_smfmac_f32_16x16x64_bf16 v[48:51], v[4:7], v[136:143], v84
    ds_read_b128 v[96:99], v86 offset:8192
    v_mov_b32 v0, 0
    v_smfmac_f32_16x16x64_bf16 v[52:55], v[8:11], v[112:119], v84
    s_waitcnt lgkmcnt(2)
    ds_read_b128 v[100:103], v86 offset:9216
    v_mfma_f32_16x16x32_bf16 v[40:43], v[72:75], v[56:59], 0
    ds_read_b128 v[104:107], v86 offset:10240
    v_mov_b32 v1, 0
    v_mfma_f32_16x16x32_bf16 v[40:43], v[72:75], v[60:63], v[40:43]
    v_mov_b32 v2, 0
    v_mov_b32 v3, 0
    v_smfmac_f32_16x16x64_bf16 v[48:51], v[8:11], v[144:151], v84
    s_waitcnt lgkmcnt(3)
    s_barrier
    ds_read_b128 v[32:35], v87 offset:22528
    ds_read_b128 v[36:39], v87 offset:23552
    v_smfmac_f32_16x16x64_bf16 v[52:55], v[12:15], v[120:127], v84
    ds_read_b128 v[44:47], v87 offset:24576
    ds_read_b128 v[80:83], v87 offset:25600
    v_cndmask_b32 v40, v40, v41, s[40:41]
    v_smfmac_f32_16x16x64_bf16 v[48:51], v[12:15], v[152:159], v84
    s_add_u32 m0, s87, 131072
    ds_write_b32 v91, v40 offset:29696
    ds_read_b128 v[108:111], v86 offset:11264
    v_smfmac_f32_16x16x64_bf16 v[48:51], v[16:19], v[160:167], v84
    ds_read_b128 v[112:115], v86 offset:12288
    ds_read_b128 v[116:119], v86 offset:13312
    v_smfmac_f32_16x16x64_bf16 v[48:51], v[20:23], v[168:175], v84
    buffer_load_dwordx4 v[64:67], v87, s[8:11], s20 offen sc1
    ds_read_b128 v[120:123], v86 offset:14336
    v_smfmac_f32_16x16x64_bf16 v[48:51], v[24:27], v[176:183], v84
    ds_read_b128 v[124:127], v86 offset:15360
    s_waitcnt lgkmcnt(8)
    v_add_f32 v32, v32, v36
    v_add_f32 v33, v33, v37
    v_add_f32 v34, v34, v38
    v_add_f32 v35, v35, v39
    v_smfmac_f32_16x16x64_bf16 v[48:51], v[28:31], v[184:191], v84
    s_waitcnt lgkmcnt(6)
    v_add_f32 v44, v44, v80
    v_add_f32 v45, v45, v81
    v_add_f32 v46, v46, v82
    v_add_f32 v47, v47, v83
    v_smfmac_f32_16x16x64_bf16 v[52:55], v[16:19], v[96:103], v84
    s_waitcnt lgkmcnt(5)
    s_barrier
    ds_read_b128 v[40:43], v87 offset:29696
    s_waitcnt lgkmcnt(5)
    v_smfmac_f32_16x16x64_bf16 v[52:55], v[20:23], v[104:111], v84
    ds_read_b64 v[82:83], v76 offset:12288
    ds_read_b64 v[80:81], v76 offset:12296
    v_add_f32 v32, v32, v44
    s_waitcnt lgkmcnt(5)
    v_smfmac_f32_16x16x64_bf16 v[52:55], v[24:27], v[112:119], v84
    buffer_load_dwordx4 v[68:71], v87, s[8:11], s20 offen offset:1024 sc1
    ds_read_b128 v[76:79], v76 offset:8192
    v_add_f32 v33, v33, v45
    v_add_f32 v34, v34, v46
    s_waitcnt lgkmcnt(4)
    v_smfmac_f32_16x16x64_bf16 v[52:55], v[28:31], v[120:127], v84
    s_add_u32 s22, s29, 50200576
    buffer_load_dwordx4 v87, s[8:11], s22 offen sc1 lds
    ds_read_b128 v[96:99], v86 offset:16384
    ds_read_b128 v[100:103], v86 offset:17408
    v_add_f32 v35, v35, v47
    v_max3_f32 v94, v32, v33, v34
    s_waitcnt lgkmcnt(5)
    v_add_f32 v40, v40, v41
    v_add_f32 v42, v42, v43
    v_add_f32 v40, v40, v42
    v_max3_f32 v94, v94, v35, v40
    v_add_f32 v48, v48, v49
    v_add_f32 v50, v50, v51
    v_max_f32_dpp v94, v94, v94 row_ror:8 row_mask:0xf bank_mask:0xf
    v_mov_b32 v95, v94
    v_cvt_pk_bf16_f32 v48, v48, v50
    v_mov_b32 v49, 0
    v_permlane32_swap_b32 v94, v95
    v_max_f32 v94, v94, v95
    v_mov_b32 v95, v94
    v_add_f32 v52, v52, v53
    v_add_f32 v54, v54, v55
    v_permlane16_swap_b32 v94, v95
    v_max_f32 v94, v94, v95
    v_mul_f32 v94, s42, v94
    v_fma_f32 v32, v32, s42, -v94
    v_fma_f32 v33, v33, s42, -v94
    v_exp_f32 v32, v32
    v_exp_f32 v33, v33
    v_fma_f32 v34, v34, s42, -v94
    v_fma_f32 v35, v35, s42, -v94
    v_cvt_pk_bf16_f32 v44, v32, v33
    v_exp_f32 v34, v34
    v_exp_f32 v35, v35
    v_fma_f32 v40, v40, s42, -v94
    v_cvt_pk_bf16_f32 v45, v34, v35
    v_mov_b32_dpp v46, v44 row_ror:8 row_mask:0xf bank_mask:0xf
    v_exp_f32 v40, v40
    v_mov_b32_dpp v47, v45 row_ror:8 row_mask:0xf bank_mask:0xf
    v_cvt_pk_bf16_f32 v52, v54, v52
    v_mov_b32_dpp v41, v40 row_ror:8 row_mask:0xf bank_mask:0xf
    v_mov_b32 v53, 0
    v_cvt_pk_bf16_f32 v42, v40, v41
    s_waitcnt lgkmcnt(2)
    v_mfma_f32_16x16x32_bf16 v[56:59], v[76:79], v[44:47], 0
    s_add_u32 m0, s87, 134144
    ds_read_b128 v[104:107], v86 offset:18432
    v_mov_b32 v43, 0
    v_mfma_f32_16x16x32_bf16 v[60:63], v[80:83], v[44:47], 0
    v_add_f32 v32, v32, v33
    v_add_f32 v34, v34, v35
    v_mfma_f32_16x16x16_bf16 v[56:59], v[48:49], v[42:43], v[56:59]
    v_add_f32 v32, v32, v40
    v_add_f32 v94, v32, v34
    v_mfma_f32_16x16x16_bf16 v[60:63], v[52:53], v[42:43], v[60:63]
    s_cmp_eq_u32 s5, 63
    ds_read_b128 v[108:111], v86 offset:19456
    ds_read_b128 v[112:115], v86 offset:20480
    v_add_f32_dpp v94, v94, v94 row_ror:8 row_mask:0xf bank_mask:0xf
    v_mov_b32 v95, v94
    v_mov_b32 v4, 0
    v_mov_b32 v5, 0
    v_permlane32_swap_b32 v94, v95
    v_add_f32 v94, v94, v95
    v_mov_b32 v95, v94
    v_cndmask_b32 v56, v56, v60, s[40:41]
    v_cndmask_b32 v57, v57, v61, s[40:41]
    v_permlane16_swap_b32 v94, v95
    v_add_f32 v94, v94, v95
    v_rcp_f32 v94, v94
    v_cndmask_b32 v58, v58, v62, s[40:41]
    v_cndmask_b32 v59, v59, v63, s[40:41]
    v_mul_f32 v56, v56, v94
    v_mul_f32 v57, v57, v94
    v_mul_f32 v58, v58, v94
    v_mul_f32 v59, v59, v94
    v_cvt_pk_bf16_f32 v32, v56, v57
    v_cvt_pk_bf16_f32 v33, v58, v59
    v_mfma_f32_16x16x4_f32 v[40:43], v84, v84, 0
    s_cbranch_scc1 Lend_4
    ds_write_b64 v90, v[32:33]
    ds_read_b128 v[116:119], v86 offset:21504
    ds_read_b128 v[120:123], v86 offset:22528
    buffer_load_dwordx4 v87, s[8:11], s22 offen offset:1024 sc1 lds
    v_mov_b32 v6, 0
    v_mov_b32 v7, 0
    v_mov_b32 v8, 0
    v_mov_b32 v9, 0
    v_mov_b32 v10, 0
    v_mov_b32 v11, 0
    v_mov_b32 v12, 0
    v_mov_b32 v13, 0
    v_mov_b32 v14, 0
    v_mov_b32 v15, 0
    v_mfma_f32_16x16x4_f32 v[44:47], v84, v84, 0
    ds_read_b128 v[124:127], v86 offset:23552
    s_waitcnt lgkmcnt(3)
    s_barrier
    ds_read_b128 v[56:59], v87 offset:16384
    ds_read_b128 v[60:63], v87 offset:17408
    v_mov_b32 v16, 0
    v_mov_b32 v17, 0
    v_mov_b32 v18, 0
    v_mov_b32 v19, 0
    v_mov_b32 v20, 0
    v_mov_b32 v21, 0
    v_mov_b32 v22, 0
    v_mov_b32 v23, 0
    v_mov_b32 v24, 0
    v_mov_b32 v25, 0
    v_mov_b32 v26, 0
    v_mov_b32 v27, 0
    v_mov_b32 v82, v48
    v_alignbit_b32 v83, v52, v52, 16
    s_waitcnt lgkmcnt(0)
    v_smfmac_f32_16x16x64_bf16 v[16:19], v[56:59], v[96:103], v84
    v_mov_b32 v28, 0
    v_smfmac_f32_16x16x64_bf16 v[20:23], v[56:59], v[112:119], v84
    ds_read_b128 v[96:99], v86 offset:24576
    v_mov_b32 v29, 0
    v_smfmac_f32_16x16x64_bf16 v[16:19], v[60:63], v[104:111], v84
    ds_read_b128 v[100:103], v86 offset:25600
    v_mov_b32 v30, 0
    v_smfmac_f32_16x16x64_bf16 v[20:23], v[60:63], v[120:127], v84
    ds_read_b128 v[104:107], v86 offset:26624
    v_mov_b32 v31, 0
    v_smfmac_f32_16x16x64_bf16 v[0:3], v[56:59], v[192:199], v84
    ds_read_b128 v[108:111], v86 offset:27648
    v_add_f32 v16, v16, v17
    v_smfmac_f32_16x16x64_bf16 v[4:7], v[56:59], v[208:215], v84
    ds_read_b128 v[112:115], v86 offset:28672
    v_add_f32 v18, v18, v19
    v_smfmac_f32_16x16x64_bf16 v[0:3], v[60:63], v[200:207], v84
    ds_read_b128 v[116:119], v86 offset:29696
    v_add_f32 v20, v20, v21
    v_add_f32 v22, v22, v23
    v_smfmac_f32_16x16x64_bf16 v[4:7], v[60:63], v[216:223], v84
    ds_read_b128 v[120:123], v86 offset:30720
    v_cvt_pk_bf16_f32 v36, v16, v18
    v_or_b32 v36, 1, v36
    v_smfmac_f32_16x16x64_bf16 v[8:11], v[56:59], v[224:231], v84
    ds_read_b128 v[124:127], v86 offset:31744
    v_cvt_pk_bf16_f32 v37, v20, v22
    v_add_f32 v0, v0, v1
    v_smfmac_f32_16x16x64_bf16 v[12:15], v[56:59], v[240:247], v84
    s_nop 0
    buffer_store_dwordx2 v[36:37], v92, s[8:11], s74 offen
    v_add_f32 v2, v2, v3
    v_smfmac_f32_16x16x64_bf16 v[8:11], v[60:63], v[232:239], v84
    v_add_f32 v4, v4, v5
    v_add_f32 v6, v6, v7
    v_smfmac_f32_16x16x64_bf16 v[12:15], v[60:63], v[248:255], v84
    s_waitcnt lgkmcnt(4)
    v_cvt_pk_bf16_f32 v32, v0, v2
    v_or_b32 v32, 1, v32
    v_smfmac_f32_16x16x64_bf16 v[24:27], v[56:59], v[96:103], v84
    v_cvt_pk_bf16_f32 v33, v4, v6
    v_add_f32 v8, v8, v9
    v_smfmac_f32_16x16x64_bf16 v[24:27], v[60:63], v[104:111], v84
    s_waitcnt lgkmcnt(0)
    buffer_store_dwordx2 v[32:33], v92, s[8:11], s72 offen
    v_add_f32 v10, v10, v11
    v_smfmac_f32_16x16x64_bf16 v[28:31], v[56:59], v[112:119], v84
    v_add_f32 v12, v12, v13
    v_add_f32 v14, v14, v15
    v_smfmac_f32_16x16x64_bf16 v[28:31], v[60:63], v[120:127], v84
    v_cvt_pk_bf16_f32 v34, v8, v10
    v_or_b32 v34, 1, v34
    v_cvt_pk_bf16_f32 v35, v12, v14
    v_add_f32 v24, v24, v25
    v_add_f32 v26, v26, v27
    v_cvt_pk_bf16_f32 v38, v24, v26
    v_or_b32 v38, 1, v38
    buffer_store_dwordx2 v[34:35], v92, s[8:11], s73 offen
    v_add_f32 v28, v28, v29
    v_add_f32 v30, v30, v31
    v_cvt_pk_bf16_f32 v39, v28, v30
    buffer_store_dwordx2 v[38:39], v92, s[8:11], s75 offen
    s_mov_b64 exec, 1
    buffer_store_dword v38, off, s[8:11], s47
    s_mov_b64 exec, -1
    s_add_u32 s5, s5, 1
    s_cmp_eq_u32 s3, 0
    s_cbranch_scc1 Lw0_25
    ds_read_b128 v[96:99], v86 offset:0
    ds_read_b128 v[100:103], v86 offset:1024
    ds_read_b128 v[104:107], v86 offset:2048
    ds_read_b128 v[108:111], v86 offset:3072
    ds_read_b128 v[112:115], v86 offset:4096
    ds_read_b128 v[116:119], v86 offset:5120
    ds_read_b128 v[120:123], v86 offset:6144
    ds_read_b128 v[124:127], v86 offset:7168
    v_mov_b32 v32, 0
    v_mov_b32 v33, 0
    v_mov_b32 v34, 0
    v_mov_b32 v35, 0
    v_mov_b32 v36, 0
    v_mov_b32 v37, 0
    v_mov_b32 v38, 0
    v_mov_b32 v39, 0
    v_mov_b32 v40, 0
    v_mov_b32 v41, 0
    v_mov_b32 v42, 0
    v_mov_b32 v43, 0
    v_mov_b32 v44, 0
    v_mov_b32 v45, 0
    v_mov_b32 v46, 0
    v_mov_b32 v47, 0
    v_mov_b32 v48, 0
    v_mov_b32 v49, 0
    v_mov_b32 v50, 0
    v_mov_b32 v51, 0
    v_mov_b32 v52, 0
    v_mov_b32 v53, 0
    v_mov_b32 v54, 0
    v_mov_b32 v55, 0
    v_mov_b32 v78, s90
    v_cndmask_b32 v76, v89, v78, s[76:77]
    v_cndmask_b32 v77, v78, v89, s[76:77]
    v_lshlrev_b32 v78, 1, v88
    v_add_u32 v78, -145408, v78
    v_lshrrev_b32 v79, 1, v87
    v_mov_b32 v56, v79
    v_add_u32 v79, s88, v79
    s_max_i32 s20, s5, 1
    s_sub_u32 s20, s20, 1
    v_mov_b32 v57, s20
    s_waitcnt vmcnt(0)
    s_nop 0
    s_branch Ltop0_6
Lw0_25:
    s_nop 15
    s_nop 15
    s_nop 15
    s_nop 15
    v_lshrrev_b32 v77, 2, v87
    s_mov_b32 exec_hi, 0
    buffer_load_dword v76, v77, s[8:11], s46 offen sc1
    s_mov_b32 exec_hi, -1
    buffer_load_dwordx4 v[0:3], v87, s[8:11], s85 offen offset:0 sc1
    buffer_load_dwordx4 v[4:7], v87, s[8:11], s85 offen offset:1024 sc1
    buffer_load_dwordx4 v[8:11], v87, s[8:11], s85 offen offset:2048 sc1
    buffer_load_dwordx4 v[12:15], v87, s[8:11], s85 offen offset:3072 sc1
    buffer_load_dwordx4 v[16:19], v87, s[8:11], s86 offen offset:0 sc1
    buffer_load_dwordx4 v[20:23], v87, s[8:11], s86 offen offset:1024 sc1
    buffer_load_dwordx4 v[24:27], v87, s[8:11], s86 offen offset:2048 sc1
    buffer_load_dwordx4 v[28:31], v87, s[8:11], s86 offen offset:3072 sc1
    ds_read_b128 v[96:99], v86 offset:0
    ds_read_b128 v[100:103], v86 offset:1024
    ds_read_b128 v[104:107], v86 offset:2048
    ds_read_b128 v[108:111], v86 offset:3072
    ds_read_b128 v[112:115], v86 offset:4096
    ds_read_b128 v[116:119], v86 offset:5120
    ds_read_b128 v[120:123], v86 offset:6144
    ds_read_b128 v[124:127], v86 offset:7168
    v_and_b32 v94, 16, v87
    v_mov_b32 v95, 0x3f80
    v_lshlrev_b32 v94, v94, v95
    v_cndmask_b32 v56, 0, v94, s[32:33]
    v_cndmask_b32 v57, 0, v94, s[34:35]
    v_cndmask_b32 v58, 0, v94, s[36:37]
    v_cndmask_b32 v59, 0, v94, s[38:39]
    v_mov_b32 v32, 0
    v_mov_b32 v33, 0
    v_mov_b32 v34, 0
    v_mov_b32 v35, 0
    v_mov_b32 v36, 0
    v_mov_b32 v37, 0
    v_mov_b32 v38, 0
    v_mov_b32 v39, 0
    v_mov_b32 v40, 0
    v_mov_b32 v41, 0
    v_mov_b32 v42, 0
    v_mov_b32 v43, 0
    v_mov_b32 v44, 0
    v_mov_b32 v45, 0
    v_mov_b32 v46, 0
    v_mov_b32 v47, 0
    v_mov_b32 v48, 0
    v_mov_b32 v49, 0
    v_mov_b32 v50, 0
    v_mov_b32 v51, 0
    v_mov_b32 v52, 0
    v_mov_b32 v53, 0
    v_mov_b32 v54, 0
    v_mov_b32 v55, 0
Lg0_29:
    s_mov_b32 exec_hi, 0
    s_waitcnt vmcnt(8)
    v_and_b32 v76, 1, v76
    v_cmp_ne_u32 vcc, 1, v76
    s_mov_b32 exec_hi, -1
    s_cbranch_vccnz Lgr_30
    s_waitcnt vmcnt(7)
    v_mfma_f32_16x16x32_bf16 v[60:63], v[0:3], v[56:59], 0
    v_and_b32 v94, v0, v2
    s_waitcnt vmcnt(6)
    v_mfma_f32_16x16x32_bf16 v[60:63], v[4:7], v[56:59], v[60:63]
    v_bitop3_b32 v94, v94, v4, v6 bitop3:0x80
    s_waitcnt vmcnt(5)
    v_mfma_f32_16x16x32_bf16 v[60:63], v[8:11], v[56:59], v[60:63]
    v_bitop3_b32 v94, v94, v8, v10 bitop3:0x80
    s_waitcnt vmcnt(4)
    v_mfma_f32_16x16x32_bf16 v[60:63], v[12:15], v[56:59], v[60:63]
    v_bitop3_b32 v94, v94, v12, v14 bitop3:0x80
    s_waitcnt vmcnt(3)
    v_mfma_f32_16x16x32_bf16 v[60:63], v[16:19], v[56:59], v[60:63]
    v_bitop3_b32 v94, v94, v16, v18 bitop3:0x80
    s_waitcnt vmcnt(2)
    v_mfma_f32_16x16x32_bf16 v[60:63], v[20:23], v[56:59], v[60:63]
    v_bitop3_b32 v94, v94, v20, v22 bitop3:0x80
    s_waitcnt vmcnt(1)
    v_mfma_f32_16x16x32_bf16 v[60:63], v[24:27], v[56:59], v[60:63]
    v_bitop3_b32 v94, v94, v24, v26 bitop3:0x80
    s_waitcnt vmcnt(0)
    v_mfma_f32_16x16x32_bf16 v[60:63], v[28:31], v[56:59], v[60:63]
    v_bitop3_b32 v94, v94, v28, v30 bitop3:0x80
    v_and_b32 v94, 1, v94
    v_cmp_ne_u32 vcc, 1, v94
    s_cbranch_vccnz Lgr_30
Lgo_31:
    s_nop 3
    v_cvt_pk_bf16_f32 v80, v60, v61
    v_cvt_pk_bf16_f32 v81, v62, v63
    v_and_b32 v80, -2, v80
    buffer_store_dwordx2 v[80:81], v93, s[8:11], s26 offen
    s_mov_b64 exec, 1
    buffer_store_dword v80, off, s[8:11], s82
    s_mov_b64 exec, -1
    s_branch Lmd0_8
Lgr_20:
    s_add_u32 s45, s45, 1
    s_cmp_gt_u32 s45, 200000000
    s_cbranch_scc1 Lgo_21
    s_mov_b32 exec_hi, 0
    buffer_load_dword v76, v77, s[8:11], s46 offen sc1
    s_mov_b32 exec_hi, -1
    buffer_load_dwordx4 v[0:3], v87, s[8:11], s85 offen offset:0 sc1
    buffer_load_dwordx4 v[4:7], v87, s[8:11], s85 offen offset:1024 sc1
    buffer_load_dwordx4 v[8:11], v87, s[8:11], s85 offen offset:2048 sc1
    buffer_load_dwordx4 v[12:15], v87, s[8:11], s85 offen offset:3072 sc1
    buffer_load_dwordx4 v[16:19], v87, s[8:11], s86 offen offset:0 sc1
    buffer_load_dwordx4 v[20:23], v87, s[8:11], s86 offen offset:1024 sc1
    buffer_load_dwordx4 v[24:27], v87, s[8:11], s86 offen offset:2048 sc1
    buffer_load_dwordx4 v[28:31], v87, s[8:11], s86 offen offset:3072 sc1
    s_branch Lg0_19
Lpr_16:
    s_add_u32 s45, s45, 0x100
    s_cmp_gt_u32 s45, 200000000
    s_cbranch_scc1 Lp2_32
    v_lshrrev_b32 v95, 2, v87
    s_mov_b32 exec_hi, 0
    buffer_load_dword v94, v95, s[8:11], s43 offen offset:0 sc1
    s_mov_b32 exec_hi, -1
    s_mov_b32 m0, 139264
    s_nop 0
    buffer_load_dwordx4 v87, s[8:11], s27 offen offset:0 sc1 lds
    buffer_load_dwordx4 v87, s[8:11], s27 offen offset:1024 sc1 lds
    buffer_load_dwordx4 v87, s[8:11], s27 offen offset:2048 sc1 lds
    buffer_load_dwordx4 v87, s[8:11], s27 offen offset:3072 sc1 lds
    s_mov_b32 m0, 143360
    s_nop 0
    buffer_load_dwordx4 v87, s[8:11], s28 offen offset:0 sc1 lds
    buffer_load_dwordx4 v87, s[8:11], s28 offen offset:1024 sc1 lds
    buffer_load_dwordx4 v87, s[8:11], s28 offen offset:2048 sc1 lds
    buffer_load_dwordx4 v87, s[8:11], s28 offen offset:3072 sc1 lds
    s_mov_b32 exec_hi, 0
    s_waitcnt vmcnt(8)
    v_and_b32 v94, 1, v94
    v_cmp_ne_u32 vcc, 0, v94
    s_mov_b32 exec_hi, -1
    s_cbranch_vccnz Lpr_16
    s_nop 2
Lp2_32:
    s_waitcnt vmcnt(0)
    s_branch Ltop0_6
Lfail_12:
    s_cmp_eq_u32 s5, s6
    s_cbranch_scc1 Lqok_14
    s_add_u32 s45, s45, 0x10000
    s_add_u32 s44, s44, 1
    s_cmp_gt_u32 s44, 2000000
    s_cbranch_scc1 Lqok_14
    s_waitcnt lgkmcnt(0)
    s_barrier
    s_sub_u32 s29, s29, 262144
    s_mov_b32 s30, 134217728
    v_mov_b32 v78, s90
    v_cndmask_b32 v76, v89, v78, s[76:77]
    v_cndmask_b32 v77, v78, v89, s[76:77]
    v_lshlrev_b32 v78, 1, v88
    v_add_u32 v78, -145408, v78
    v_lshrrev_b32 v79, 1, v87
    v_mov_b32 v56, v79
    v_add_u32 v79, s88, v79
    s_max_i32 s20, s5, 1
    s_sub_u32 s20, s20, 1
    v_mov_b32 v57, s20
    s_cmp_lg_u32 s3, 0
    s_nop 0
    s_cbranch_scc1 Lf2_33
    v_lshrrev_b32 v95, 2, v87
    s_mov_b32 exec_hi, 0
    buffer_load_dword v94, v95, s[8:11], s43 offen offset:0 sc1
    s_mov_b32 exec_hi, -1
    s_mov_b32 m0, 139264
    s_nop 0
    buffer_load_dwordx4 v87, s[8:11], s27 offen offset:0 sc1 lds
    buffer_load_dwordx4 v87, s[8:11], s27 offen offset:1024 sc1 lds
    buffer_load_dwordx4 v87, s[8:11], s27 offen offset:2048 sc1 lds
    buffer_load_dwordx4 v87, s[8:11], s27 offen offset:3072 sc1 lds
    s_mov_b32 m0, 143360
    s_nop 0
    buffer_load_dwordx4 v87, s[8:11], s28 offen offset:0 sc1 lds
    buffer_load_dwordx4 v87, s[8:11], s28 offen offset:1024 sc1 lds
    buffer_load_dwordx4 v87, s[8:11], s28 offen offset:2048 sc1 lds
    buffer_load_dwordx4 v87, s[8:11], s28 offen offset:3072 sc1 lds
Lf2_33:
    v_mov_b32 v32, 0
    v_mov_b32 v33, 0
    v_mov_b32 v34, 0
    v_mov_b32 v35, 0
    v_mov_b32 v36, 0
    v_mov_b32 v37, 0
    v_mov_b32 v38, 0
    v_mov_b32 v39, 0
    v_mov_b32 v40, 0
    v_mov_b32 v41, 0
    v_mov_b32 v42, 0
    v_mov_b32 v43, 0
    v_mov_b32 v44, 0
    v_mov_b32 v45, 0
    v_mov_b32 v46, 0
    v_mov_b32 v47, 0
    s_waitcnt vmcnt(0)
    s_barrier
    s_branch Lq_13
Lgr_30:
    s_add_u32 s45, s45, 1
    s_cmp_gt_u32 s45, 200000000
    s_cbranch_scc1 Lgo_31
    s_mov_b32 exec_hi, 0
    buffer_load_dword v76, v77, s[8:11], s46 offen sc1
    s_mov_b32 exec_hi, -1
    buffer_load_dwordx4 v[0:3], v87, s[8:11], s85 offen offset:0 sc1
    buffer_load_dwordx4 v[4:7], v87, s[8:11], s85 offen offset:1024 sc1
    buffer_load_dwordx4 v[8:11], v87, s[8:11], s85 offen offset:2048 sc1
    buffer_load_dwordx4 v[12:15], v87, s[8:11], s85 offen offset:3072 sc1
    buffer_load_dwordx4 v[16:19], v87, s[8:11], s86 offen offset:0 sc1
    buffer_load_dwordx4 v[20:23], v87, s[8:11], s86 offen offset:1024 sc1
    buffer_load_dwordx4 v[24:27], v87, s[8:11], s86 offen offset:2048 sc1
    buffer_load_dwordx4 v[28:31], v87, s[8:11], s86 offen offset:3072 sc1
    s_branch Lg0_29
Lpr_26:
    s_add_u32 s45, s45, 0x100
    s_cmp_gt_u32 s45, 200000000
    s_cbranch_scc1 Lp2_34
    v_lshrrev_b32 v95, 2, v87
    s_mov_b32 exec_hi, 0
    buffer_load_dword v94, v95, s[8:11], s43 offen offset:0 sc1
    s_mov_b32 exec_hi, -1
    s_mov_b32 m0, 131072
    s_nop 0
    buffer_load_dwordx4 v87, s[8:11], s27 offen offset:0 sc1 lds
    buffer_load_dwordx4 v87, s[8:11], s27 offen offset:1024 sc1 lds
    buffer_load_dwordx4 v87, s[8:11], s27 offen offset:2048 sc1 lds
    buffer_load_dwordx4 v87, s[8:11], s27 offen offset:3072 sc1 lds
    s_mov_b32 m0, 135168
    s_nop 0
    buffer_load_dwordx4 v87, s[8:11], s28 offen offset:0 sc1 lds
    buffer_load_dwordx4 v87, s[8:11], s28 offen offset:1024 sc1 lds
    buffer_load_dwordx4 v87, s[8:11], s28 offen offset:2048 sc1 lds
    buffer_load_dwordx4 v87, s[8:11], s28 offen offset:3072 sc1 lds
    s_mov_b32 exec_hi, 0
    s_waitcnt vmcnt(8)
    v_and_b32 v94, 1, v94
    v_cmp_ne_u32 vcc, 1, v94
    s_mov_b32 exec_hi, -1
    s_cbranch_vccnz Lpr_26
    s_nop 2
Lp2_34:
    s_waitcnt vmcnt(0)
    s_branch Ltop1_7
Lfail_22:
    s_cmp_eq_u32 s5, s6
    s_cbranch_scc1 Lqok_24
    s_add_u32 s45, s45, 0x10000
    s_add_u32 s44, s44, 1
    s_cmp_gt_u32 s44, 2000000
    s_cbranch_scc1 Lqok_24
    s_waitcnt lgkmcnt(0)
    s_barrier
    s_sub_u32 s29, s29, 262144
    s_mov_b32 s30, 134217728
    v_mov_b32 v78, s90
    v_cndmask_b32 v76, v89, v78, s[76:77]
    v_cndmask_b32 v77, v78, v89, s[76:77]
    v_lshlrev_b32 v78, 1, v88
    v_add_u32 v78, -145408, v78
    v_lshrrev_b32 v79, 1, v87
    v_mov_b32 v56, v79
    v_add_u32 v79, s88, v79
    s_max_i32 s20, s5, 1
    s_sub_u32 s20, s20, 1
    v_mov_b32 v57, s20
    s_cmp_lg_u32 s3, 0
    s_nop 0
    s_cbranch_scc1 Lf2_35
    v_lshrrev_b32 v95, 2, v87
    s_mov_b32 exec_hi, 0
    buffer_load_dword v94, v95, s[8:11], s43 offen offset:0 sc1
    s_mov_b32 exec_hi, -1
    s_mov_b32 m0, 131072
    s_nop 0
    buffer_load_dwordx4 v87, s[8:11], s27 offen offset:0 sc1 lds
    buffer_load_dwordx4 v87, s[8:11], s27 offen offset:1024 sc1 lds
    buffer_load_dwordx4 v87, s[8:11], s27 offen offset:2048 sc1 lds
    buffer_load_dwordx4 v87, s[8:11], s27 offen offset:3072 sc1 lds
    s_mov_b32 m0, 135168
    s_nop 0
    buffer_load_dwordx4 v87, s[8:11], s28 offen offset:0 sc1 lds
    buffer_load_dwordx4 v87, s[8:11], s28 offen offset:1024 sc1 lds
    buffer_load_dwordx4 v87, s[8:11], s28 offen offset:2048 sc1 lds
    buffer_load_dwordx4 v87, s[8:11], s28 offen offset:3072 sc1 lds
Lf2_35:
    v_mov_b32 v32, 0
    v_mov_b32 v33, 0
    v_mov_b32 v34, 0
    v_mov_b32 v35, 0
    v_mov_b32 v36, 0
    v_mov_b32 v37, 0
    v_mov_b32 v38, 0
    v_mov_b32 v39, 0
    v_mov_b32 v40, 0
    v_mov_b32 v41, 0
    v_mov_b32 v42, 0
    v_mov_b32 v43, 0
    v_mov_b32 v44, 0
    v_mov_b32 v45, 0
    v_mov_b32 v46, 0
    v_mov_b32 v47, 0
    s_waitcnt vmcnt(0)
    s_barrier
    s_branch Lq_23
Lfl_17:
Lfw_36:
    buffer_load_dword v85, off, s[8:11], s91 sc1
    s_waitcnt vmcnt(0)
    v_cmp_gt_u32 vcc, 3, v85
    s_add_u32 s45, s45, 1
    s_cmp_gt_u32 s45, 200000000
    s_cbranch_scc1 Lfw2_37
    s_sleep 2
    s_cbranch_vccnz Lfw_36
Lfw2_37:
    s_branch Lflb_18
Lfl_27:
Lfw_38:
    buffer_load_dword v85, off, s[8:11], s91 sc1
    s_waitcnt vmcnt(0)
    v_cmp_gt_u32 vcc, 3, v85
    s_add_u32 s45, s45, 1
    s_cmp_gt_u32 s45, 200000000
    s_cbranch_scc1 Lfw2_39
    s_sleep 2
    s_cbranch_vccnz Lfw_38
Lfw2_39:
    s_branch Lflb_28
Lend_4:
    s_waitcnt lgkmcnt(0)
    v_mov_b32 v82, v48
    v_alignbit_b32 v83, v52, v52, 16
    s_nop 1
Lstop_5:
    s_waitcnt lgkmcnt(0)
    v_lshrrev_b32 v95, 1, v87
    s_add_u32 s23, s30, 66977792
    buffer_store_dwordx4 v[72:75], v87, s[8:11], s23 offen sc1
    s_lshr_b32 s23, s30, 1
    s_add_u32 s23, s23, 75431936
    buffer_store_dwordx2 v[82:83], v95, s[8:11], s23 offen sc1
    s_branch Lm_exit
Lm_chs:
    s_mov_b32 s5, s6
    s_lshr_b32 s46, s4, 3
    s_lshl_b32 s46, s46, 7
    s_add_u32 s46, s46, s43
    s_add_u32 s46, s46, 1024
    s_lshl_b32 s47, s3, 7
    s_add_u32 s47, s47, s82
    s_add_u32 s47, s47, 1024
    s_lshl_b32 s29, s4, 13
    s_add_u32 s29, s29, s31
    s_lshl_b32 s20, s6, 18
    s_add_u32 s29, s29, s20
    s_mov_b32 s30, 134217728
    s_lshl_b32 s91, s4, 2
    s_add_u32 s91, s91, 131072000
    s_mov_b32 s93, s91
    s_lshl_b32 s92, s4, 7
    s_add_u32 s92, s92, 131080192
Lfw_46:
    buffer_load_dword v85, off, s[8:11], s91 sc1
    s_waitcnt vmcnt(0)
    v_cmp_gt_u32 vcc, 3, v85
    s_add_u32 s45, s45, 1
    s_cmp_gt_u32 s45, 200000000
    s_cbranch_scc1 Lfw2_47
    s_sleep 2
    s_cbranch_vccnz Lfw_46
Lfw2_47:
    s_add_u32 s20, s29, 33423360
    buffer_load_dwordx4 v[64:67], v87, s[8:11], s20 offen sc1
    buffer_load_dwordx4 v[68:71], v87, s[8:11], s20 offen offset:1024 sc1
    s_add_u32 m0, s87, 131072
    s_add_u32 s20, s29, 50200576
    buffer_load_dwordx4 v87, s[8:11], s20 offen sc1 lds
    s_add_u32 m0, s87, 134144
    s_nop 0
    buffer_load_dwordx4 v87, s[8:11], s20 offen offset:1024 sc1 lds
    ds_read_b128 v[96:99], v86 offset:0
    ds_read_b128 v[100:103], v86 offset:1024
    ds_read_b128 v[104:107], v86 offset:2048
    ds_read_b128 v[108:111], v86 offset:3072
    ds_read_b128 v[112:115], v86 offset:4096
    ds_read_b128 v[116:119], v86 offset:5120
    ds_read_b128 v[120:123], v86 offset:6144
    ds_read_b128 v[124:127], v86 offset:7168
    v_mov_b32 v32, 0
    v_mov_b32 v33, 0
    v_mov_b32 v34, 0
    v_mov_b32 v35, 0
    v_mov_b32 v36, 0
    v_mov_b32 v37, 0
    v_mov_b32 v38, 0
    v_mov_b32 v39, 0
    v_mov_b32 v40, 0
    v_mov_b32 v41, 0
    v_mov_b32 v42, 0
    v_mov_b32 v43, 0
    v_mov_b32 v44, 0
    v_mov_b32 v45, 0
    v_mov_b32 v46, 0
    v_mov_b32 v47, 0
    v_mov_b32 v48, 0
    v_mov_b32 v49, 0
    v_mov_b32 v50, 0
    v_mov_b32 v51, 0
    v_mov_b32 v52, 0
    v_mov_b32 v53, 0
    v_mov_b32 v54, 0
    v_mov_b32 v55, 0
    v_mov_b32 v78, s90
    v_cndmask_b32 v76, v89, v78, s[76:77]
    v_cndmask_b32 v77, v78, v89, s[76:77]
    v_lshlrev_b32 v78, 1, v88
    v_add_u32 v78, -145408, v78
    v_lshrrev_b32 v79, 1, v87
    v_mov_b32 v56, v79
    v_add_u32 v79, s88, v79
    s_max_i32 s20, s5, 1
    s_sub_u32 s20, s20, 1
    v_mov_b32 v57, s20
    s_waitcnt vmcnt(0) lgkmcnt(0)
    s_nop 0
    s_branch Ltop0_42
Lmd0_44:
    s_nop 15
    s_nop 15
    s_nop 15
    v_lshrrev_b32 v95, 2, v87
    s_mov_b32 exec_hi, 0
    buffer_load_dword v94, v95, s[8:11], s43 offen offset:0 sc1
    s_mov_b32 exec_hi, -1
    s_mov_b32 m0, 139264
    s_nop 0
    buffer_load_dwordx4 v87, s[8:11], s27 offen offset:0 sc1 lds
    buffer_load_dwordx4 v87, s[8:11], s27 offen offset:1024 sc1 lds
    buffer_load_dwordx4 v87, s[8:11], s27 offen offset:2048 sc1 lds
    buffer_load_dwordx4 v87, s[8:11], s27 offen offset:3072 sc1 lds
    s_mov_b32 m0, 143360
    s_nop 0
    buffer_load_dwordx4 v87, s[8:11], s28 offen offset:0 sc1 lds
    buffer_load_dwordx4 v87, s[8:11], s28 offen offset:1024 sc1 lds
    buffer_load_dwordx4 v87, s[8:11], s28 offen offset:2048 sc1 lds
    buffer_load_dwordx4 v87, s[8:11], s28 offen offset:3072 sc1 lds
    v_mov_b32 v78, s90
    v_cndmask_b32 v76, v89, v78, s[76:77]
    v_cndmask_b32 v77, v78, v89, s[76:77]
    v_lshlrev_b32 v78, 1, v88
    v_add_u32 v78, -145408, v78
    v_lshrrev_b32 v79, 1, v87
    v_mov_b32 v56, v79
    v_add_u32 v79, s88, v79
    s_max_i32 s20, s5, 1
    s_sub_u32 s20, s20, 1
    v_mov_b32 v57, s20
    s_mov_b32 exec_hi, 0
    s_waitcnt vmcnt(8)
    v_and_b32 v94, 1, v94
    v_cmp_ne_u32 vcc, 0, v94
    s_mov_b32 exec_hi, -1
    s_cbranch_vccnz Lpr_52
    s_waitcnt vmcnt(0)
Ltop0_42:
    s_waitcnt lgkmcnt(0)
    s_barrier
Lq_49:
    ds_read_b128 v[0:3], v87 offset:8192
    ds_read_b128 v[4:7], v87 offset:9216
    ds_read_b128 v[8:11], v87 offset:10240
    ds_read_b128 v[12:15], v87 offset:11264
    ds_read_b128 v[16:19], v87 offset:12288
    s_waitcnt lgkmcnt(4)
    v_smfmac_f32_16x16x64_bf16 v[32:35], v[0:3], a[0:7], v84
    ds_read_b128 v[20:23], v87 offset:13312
    v_smfmac_f32_16x16x64_bf16 v[36:39], v[0:3], a[64:71], v84
    ds_read_b128 v[24:27], v87 offset:14336
    s_waitcnt lgkmcnt(5)
    v_smfmac_f32_16x16x64_bf16 v[32:35], v[4:7], a[8:15], v84
    ds_read_b128 v[28:31], v87 offset:15360
    v_smfmac_f32_16x16x64_bf16 v[36:39], v[4:7], a[72:79], v84
    s_waitcnt lgkmcnt(5)
    v_smfmac_f32_16x16x64_bf16 v[32:35], v[8:11], a[16:23], v84
    v_smfmac_f32_16x16x64_bf16 v[36:39], v[8:11], a[80:87], v84
    s_waitcnt lgkmcnt(4)
    v_smfmac_f32_16x16x64_bf16 v[32:35], v[12:15], a[24:31], v84
    v_smfmac_f32_16x16x64_bf16 v[36:39], v[12:15], a[88:95], v84
    s_waitcnt lgkmcnt(0)
    v_smfmac_f32_16x16x64_bf16 v[32:35], v[16:19], a[32:39], v84
    v_or_b32 v94, v0, v2
    v_smfmac_f32_16x16x64_bf16 v[36:39], v[16:19], a[96:103], v84
    v_or3_b32 v94, v94, v4, v6
    v_smfmac_f32_16x16x64_bf16 v[32:35], v[20:23], a[40:47], v84
    v_or3_b32 v94, v94, v8, v10
    v_smfmac_f32_16x16x64_bf16 v[36:39], v[20:23], a[104:111], v84
    v_or3_b32 v94, v94, v12, v14
    v_smfmac_f32_16x16x64_bf16 v[32:35], v[24:27], a[48:55], v84
    v_or3_b32 v94, v94, v16, v18
    v_smfmac_f32_16x16x64_bf16 v[36:39], v[24:27], a[112:119], v84
    v_or3_b32 v94, v94, v20, v22
    v_smfmac_f32_16x16x64_bf16 v[32:35], v[28:31], a[56:63], v84
    v_or3_b32 v94, v94, v24, v26
    v_smfmac_f32_16x16x64_bf16 v[36:39], v[28:31], a[120:127], v84
    v_or3_b32 v94, v94, v28, v30
    v_smfmac_f32_16x16x64_bf16 v[40:43], v[0:3], a[128:135], v84
    s_add_u32 s23, s30, 66977792
    buffer_store_dwordx4 v[72:75], v87, s[8:11], s23 offen sc1
    v_and_b32 v94, 1, v94
    v_smfmac_f32_16x16x64_bf16 v[44:47], v[0:3], a[192:199], v84
    s_lshr_b32 s23, s30, 1
    s_add_u32 s23, s23, 75431936
    v_cmp_ne_u32 vcc, 0, v94
    v_smfmac_f32_16x16x64_bf16 v[40:43], v[4:7], a[136:143], v84
    s_lshr_b32 s30, s29, 1
    buffer_store_dwordx2 v[82:83], v56, s[8:11], s23 offen sc1
    v_add_f32 v32, v32, v33
    v_smfmac_f32_16x16x64_bf16 v[44:47], v[4:7], a[200:207], v84
    s_add_u32 s29, s29, 262144
    s_cbranch_vccnz Lfail_48
Lqok_50:
    v_add_f32 v34, v34, v35
    v_smfmac_f32_16x16x64_bf16 v[40:43], v[8:11], a[144:151], v84
    s_add_u32 s20, s29, 33423360
    v_add_f32 v36, v36, v37
    v_smfmac_f32_16x16x64_bf16 v[44:47], v[8:11], a[208:215], v84
    s_add_u32 s21, s5, 2
    s_min_u32 s21, s21, 63
    v_add_f32 v38, v38, v39
    v_smfmac_f32_16x16x64_bf16 v[40:43], v[12:15], a[152:159], v84
    s_lshr_b32 s21, s21, 2
    s_lshl_b32 s21, s21, 7
    v_cvt_pk_bf16_f32 v32, v32, v34
    v_smfmac_f32_16x16x64_bf16 v[44:47], v[12:15], a[216:223], v84
    v_cvt_pk_bf16_f32 v36, v36, v38
    v_smfmac_f32_16x16x64_bf16 v[40:43], v[16:19], a[160:167], v84
    s_nop 0
    ds_write2_b32 v88, v32, v36 offset0:0 offset1:64
    ds_read_b64_tr_b16 v[56:57], v76
    v_smfmac_f32_16x16x64_bf16 v[44:47], v[16:19], a[224:231], v84
    ds_read_b64_tr_b16 v[58:59], v76 offset:256
    ds_read_b64_tr_b16 v[60:61], v77
    ds_read_b64_tr_b16 v[62:63], v77 offset:256
    v_smfmac_f32_16x16x64_bf16 v[40:43], v[20:23], a[168:175], v84
    v_add_u32 v76, s87, v87
    v_smfmac_f32_16x16x64_bf16 v[44:47], v[20:23], a[232:239], v84
    v_cmp_gt_u32 vcc, 3, v85
    v_smfmac_f32_16x16x64_bf16 v[40:43], v[24:27], a[176:183], v84
    v_smfmac_f32_16x16x64_bf16 v[44:47], v[24:27], a[240:247], v84
    s_cbranch_vccnz Lfl_53
Lflb_54:
    s_add_u32 s91, s21, s93
    v_smfmac_f32_16x16x64_bf16 v[40:43], v[28:31], a[184:191], v84
    buffer_load_dword v85, off, s[8:11], s91 sc1
    v_smfmac_f32_16x16x64_bf16 v[44:47], v[28:31], a[248:255], v84
    s_waitcnt lgkmcnt(0)
    v_mfma_f32_16x16x32_bf16 v[32:35], v[64:67], v[56:59], 0
    v_add_f32 v40, v40, v41
    v_add_f32 v42, v42, v43
    v_mfma_f32_16x16x32_bf16 v[32:35], v[68:71], v[60:63], v[32:35]
    v_cvt_pk_bf16_f32 v40, v40, v42
    v_add_f32 v44, v44, v45
    v_add_f32 v46, v46, v47
    v_cvt_pk_bf16_f32 v44, v44, v46
    v_smfmac_f32_16x16x64_bf16 v[52:55], v[0:3], v[96:103], v84
    s_nop 0
    ds_write2_b32 v78, v40, v44 offset0:0 offset1:128
    ds_read_b64_tr_b16 v[72:73], v79
    v_smfmac_f32_16x16x64_bf16 v[48:51], v[0:3], v[128:135], v84
    ds_read_b64_tr_b16 v[74:75], v79 offset:512
    v_smfmac_f32_16x16x64_bf16 v[52:55], v[4:7], v[104:111], v84
    ds_write_b128 v76, v[32:35] offset:22528
    v_smfmac_f32_16x16x64_bf16 v[48:51], v[4:7], v[136:143], v84
    ds_read_b128 v[96:99], v86 offset:8192
    v_mov_b32 v0, 0
    v_smfmac_f32_16x16x64_bf16 v[52:55], v[8:11], v[112:119], v84
    s_waitcnt lgkmcnt(2)
    ds_read_b128 v[100:103], v86 offset:9216
    v_mfma_f32_16x16x32_bf16 v[40:43], v[72:75], v[56:59], 0
    ds_read_b128 v[104:107], v86 offset:10240
    v_mov_b32 v1, 0
    v_mfma_f32_16x16x32_bf16 v[40:43], v[72:75], v[60:63], v[40:43]
    v_mov_b32 v2, 0
    v_mov_b32 v3, 0
    v_smfmac_f32_16x16x64_bf16 v[48:51], v[8:11], v[144:151], v84
    s_waitcnt lgkmcnt(3)
    s_barrier
    ds_read_b128 v[32:35], v87 offset:22528
    ds_read_b128 v[36:39], v87 offset:23552
    v_smfmac_f32_16x16x64_bf16 v[52:55], v[12:15], v[120:127], v84
    ds_read_b128 v[44:47], v87 offset:24576
    ds_read_b128 v[80:83], v87 offset:25600
    v_cndmask_b32 v40, v40, v41, s[40:41]
    v_smfmac_f32_16x16x64_bf16 v[48:51], v[12:15], v[152:159], v84
    s_add_u32 m0, s87, 139264
    ds_write_b32 v91, v40 offset:29696
    ds_read_b128 v[108:111], v86 offset:11264
    v_smfmac_f32_16x16x64_bf16 v[48:51], v[16:19], v[160:167], v84
    ds_read_b128 v[112:115], v86 offset:12288
    ds_read_b128 v[116:119], v86 offset:13312
    v_smfmac_f32_16x16x64_bf16 v[48:51], v[20:23], v[168:175], v84
    buffer_load_dwordx4 v[64:67], v87, s[8:11], s20 offen sc1
    ds_read_b128 v[120:123], v86 offset:14336
    v_smfmac_f32_16x16x64_bf16 v[48:51], v[24:27], v[176:183], v84
    ds_read_b128 v[124:127], v86 offset:15360
    s_waitcnt lgkmcnt(8)
    v_add_f32 v32, v32, v36
    v_add_f32 v33, v33, v37
    v_add_f32 v34, v34, v38
    v_add_f32 v35, v35, v39
    v_smfmac_f32_16x16x64_bf16 v[48:51], v[28:31], v[184:191], v84
    s_waitcnt lgkmcnt(6)
    v_add_f32 v44, v44, v80
    v_add_f32 v45, v45, v81
    v_add_f32 v46, v46, v82
    v_add_f32 v47, v47, v83
    v_smfmac_f32_16x16x64_bf16 v[52:55], v[16:19], v[96:103], v84
    s_waitcnt lgkmcnt(5)
    s_barrier
    ds_read_b128 v[40:43], v87 offset:29696
    s_waitcnt lgkmcnt(5)
    v_smfmac_f32_16x16x64_bf16 v[52:55], v[20:23], v[104:111], v84
    ds_read_b64 v[82:83], v76 offset:4096
    ds_read_b64 v[80:81], v76 offset:4104
    v_add_f32 v32, v32, v44
    s_waitcnt lgkmcnt(5)
    v_smfmac_f32_16x16x64_bf16 v[52:55], v[24:27], v[112:119], v84
    buffer_load_dwordx4 v[68:71], v87, s[8:11], s20 offen offset:1024 sc1
    ds_read_b128 v[76:79], v76 offset:0
    v_add_f32 v33, v33, v45
    v_add_f32 v34, v34, v46
    s_waitcnt lgkmcnt(4)
    v_smfmac_f32_16x16x64_bf16 v[52:55], v[28:31], v[120:127], v84
    s_add_u32 s22, s29, 50200576
    buffer_load_dwordx4 v87, s[8:11], s22 offen sc1 lds
    ds_read_b128 v[96:99], v86 offset:16384
    ds_read_b128 v[100:103], v86 offset:17408
    v_add_f32 v35, v35, v47
    v_max3_f32 v94, v32, v33, v34
    s_waitcnt lgkmcnt(5)
    v_add_f32 v40, v40, v41
    v_add_f32 v42, v42, v43
    v_add_f32 v40, v40, v42
    v_max3_f32 v94, v94, v35, v40
    v_add_f32 v48, v48, v49
    v_add_f32 v50, v50, v51
    v_max_f32_dpp v94, v94, v94 row_ror:8 row_mask:0xf bank_mask:0xf
    v_mov_b32 v95, v94
    v_cvt_pk_bf16_f32 v48, v48, v50
    v_mov_b32 v49, 0
    v_permlane32_swap_b32 v94, v95
    v_max_f32 v94, v94, v95
    v_mov_b32 v95, v94
    v_add_f32 v52, v52, v53
    v_add_f32 v54, v54, v55
    v_permlane16_swap_b32 v94, v95
    v_max_f32 v94, v94, v95
    v_mul_f32 v94, s42, v94
    v_fma_f32 v32, v32, s42, -v94
    v_fma_f32 v33, v33, s42, -v94
    v_exp_f32 v32, v32
    v_exp_f32 v33, v33
    v_fma_f32 v34, v34, s42, -v94
    v_fma_f32 v35, v35, s42, -v94
    v_cvt_pk_bf16_f32 v44, v32, v33
    v_exp_f32 v34, v34
    v_exp_f32 v35, v35
    v_fma_f32 v40, v40, s42, -v94
    v_cvt_pk_bf16_f32 v45, v34, v35
    v_mov_b32_dpp v46, v44 row_ror:8 row_mask:0xf bank_mask:0xf
    v_exp_f32 v40, v40
    v_mov_b32_dpp v47, v45 row_ror:8 row_mask:0xf bank_mask:0xf
    v_cvt_pk_bf16_f32 v52, v54, v52
    v_mov_b32_dpp v41, v40 row_ror:8 row_mask:0xf bank_mask:0xf
    v_mov_b32 v53, 0
    v_cvt_pk_bf16_f32 v42, v40, v41
    s_waitcnt lgkmcnt(2)
    v_mfma_f32_16x16x32_bf16 v[56:59], v[76:79], v[44:47], 0
    s_add_u32 m0, s87, 142336
    ds_read_b128 v[104:107], v86 offset:18432
    v_mov_b32 v43, 0
    v_mfma_f32_16x16x32_bf16 v[60:63], v[80:83], v[44:47], 0
    v_add_f32 v32, v32, v33
    v_add_f32 v34, v34, v35
    v_mfma_f32_16x16x16_bf16 v[56:59], v[48:49], v[42:43], v[56:59]
    v_add_f32 v32, v32, v40
    v_add_f32 v94, v32, v34
    v_mfma_f32_16x16x16_bf16 v[60:63], v[52:53], v[42:43], v[60:63]
    s_nop 0
    ds_read_b128 v[108:111], v86 offset:19456
    ds_read_b128 v[112:115], v86 offset:20480
    v_add_f32_dpp v94, v94, v94 row_ror:8 row_mask:0xf bank_mask:0xf
    v_mov_b32 v95, v94
    v_mov_b32 v4, 0
    v_mov_b32 v5, 0
    v_permlane32_swap_b32 v94, v95
    v_add_f32 v94, v94, v95
    v_mov_b32 v95, v94
    v_cndmask_b32 v56, v56, v60, s[40:41]
    v_cndmask_b32 v57, v57, v61, s[40:41]
    v_permlane16_swap_b32 v94, v95
    v_add_f32 v94, v94, v95
    v_rcp_f32 v94, v94
    v_cndmask_b32 v58, v58, v62, s[40:41]
    v_cndmask_b32 v59, v59, v63, s[40:41]
    v_mul_f32 v56, v56, v94
    v_mul_f32 v57, v57, v94
    v_mul_f32 v58, v58, v94
    v_mul_f32 v59, v59, v94
    v_cvt_pk_bf16_f32 v32, v56, v57
    v_cvt_pk_bf16_f32 v33, v58, v59
    v_mfma_f32_16x16x4_f32 v[40:43], v84, v84, 0
    s_nop 0
    ds_write_b64 v90, v[32:33]
    ds_read_b128 v[116:119], v86 offset:21504
    ds_read_b128 v[120:123], v86 offset:22528
    buffer_load_dwordx4 v87, s[8:11], s22 offen offset:1024 sc1 lds
    v_mov_b32 v6, 0
    v_mov_b32 v7, 0
    v_mov_b32 v8, 0
    v_mov_b32 v9, 0
    v_mov_b32 v10, 0
    v_mov_b32 v11, 0
    v_mov_b32 v12, 0
    v_mov_b32 v13, 0
    v_mov_b32 v14, 0
    v_mov_b32 v15, 0
    v_mfma_f32_16x16x4_f32 v[44:47], v84, v84, 0
    ds_read_b128 v[124:127], v86 offset:23552
    s_waitcnt lgkmcnt(3)
    s_barrier
    ds_read_b128 v[56:59], v87 offset:16384
    ds_read_b128 v[60:63], v87 offset:17408
    v_mov_b32 v16, 0
    v_mov_b32 v17, 0
    v_mov_b32 v18, 0
    v_mov_b32 v19, 0
    v_mov_b32 v20, 0
    v_mov_b32 v21, 0
    v_mov_b32 v22, 0
    v_mov_b32 v23, 0
    v_mov_b32 v24, 0
    v_mov_b32 v25, 0
    v_mov_b32 v26, 0
    v_mov_b32 v27, 0
    v_mov_b32 v82, v48
    v_alignbit_b32 v83, v52, v52, 16
    s_waitcnt lgkmcnt(0)
    v_smfmac_f32_16x16x64_bf16 v[16:19], v[56:59], v[96:103], v84
    v_mov_b32 v28, 0
    v_smfmac_f32_16x16x64_bf16 v[20:23], v[56:59], v[112:119], v84
    ds_read_b128 v[96:99], v86 offset:24576
    v_mov_b32 v29, 0
    v_smfmac_f32_16x16x64_bf16 v[16:19], v[60:63], v[104:111], v84
    ds_read_b128 v[100:103], v86 offset:25600
    v_mov_b32 v30, 0
    v_smfmac_f32_16x16x64_bf16 v[20:23], v[60:63], v[120:127], v84
    ds_read_b128 v[104:107], v86 offset:26624
    v_mov_b32 v31, 0
    v_smfmac_f32_16x16x64_bf16 v[0:3], v[56:59], v[192:199], v84
    ds_read_b128 v[108:111], v86 offset:27648
    v_add_f32 v16, v16, v17
    v_smfmac_f32_16x16x64_bf16 v[4:7], v[56:59], v[208:215], v84
    ds_read_b128 v[112:115], v86 offset:28672
    v_add_f32 v18, v18, v19
    v_smfmac_f32_16x16x64_bf16 v[0:3], v[60:63], v[200:207], v84
    ds_read_b128 v[116:119], v86 offset:29696
    v_add_f32 v20, v20, v21
    v_add_f32 v22, v22, v23
    v_smfmac_f32_16x16x64_bf16 v[4:7], v[60:63], v[216:223], v84
    ds_read_b128 v[120:123], v86 offset:30720
    v_cvt_pk_bf16_f32 v36, v16, v18
    v_and_b32 v36, -2, v36
    v_smfmac_f32_16x16x64_bf16 v[8:11], v[56:59], v[224:231], v84
    ds_read_b128 v[124:127], v86 offset:31744
    v_cvt_pk_bf16_f32 v37, v20, v22
    v_add_f32 v0, v0, v1
    v_smfmac_f32_16x16x64_bf16 v[12:15], v[56:59], v[240:247], v84
    s_nop 0
    buffer_store_dwordx2 v[36:37], v92, s[8:11], s74 offen sc1
    v_add_f32 v2, v2, v3
    v_smfmac_f32_16x16x64_bf16 v[8:11], v[60:63], v[232:239], v84
    v_add_f32 v4, v4, v5
    v_add_f32 v6, v6, v7
    v_smfmac_f32_16x16x64_bf16 v[12:15], v[60:63], v[248:255], v84
    s_waitcnt lgkmcnt(4)
    v_cvt_pk_bf16_f32 v32, v0, v2
    v_and_b32 v32, -2, v32
    v_smfmac_f32_16x16x64_bf16 v[24:27], v[56:59], v[96:103], v84
    v_cvt_pk_bf16_f32 v33, v4, v6
    v_add_f32 v8, v8, v9
    v_smfmac_f32_16x16x64_bf16 v[24:27], v[60:63], v[104:111], v84
    s_waitcnt lgkmcnt(0)
    buffer_store_dwordx2 v[32:33], v92, s[8:11], s72 offen sc1
    v_add_f32 v10, v10, v11
    v_smfmac_f32_16x16x64_bf16 v[28:31], v[56:59], v[112:119], v84
    v_add_f32 v12, v12, v13
    v_add_f32 v14, v14, v15
    v_smfmac_f32_16x16x64_bf16 v[28:31], v[60:63], v[120:127], v84
    v_cvt_pk_bf16_f32 v34, v8, v10
    v_and_b32 v34, -2, v34
    v_cvt_pk_bf16_f32 v35, v12, v14
    v_add_f32 v24, v24, v25
    v_add_f32 v26, v26, v27
    v_cvt_pk_bf16_f32 v38, v24, v26
    v_and_b32 v38, -2, v38
    buffer_store_dwordx2 v[34:35], v92, s[8:11], s73 offen sc1
    v_add_f32 v28, v28, v29
    v_add_f32 v30, v30, v31
    v_cvt_pk_bf16_f32 v39, v28, v30
    buffer_store_dwordx2 v[38:39], v92, s[8:11], s75 offen sc1
    s_mov_b64 exec, 1
    buffer_store_dword v38, off, s[8:11], s47 sc1
    s_mov_b64 exec, -1
    s_add_u32 s5, s5, 1
    s_cmp_eq_u32 s3, 0
    s_cbranch_scc1 Lw0_51
    ds_read_b128 v[96:99], v86 offset:0
    ds_read_b128 v[100:103], v86 offset:1024
    ds_read_b128 v[104:107], v86 offset:2048
    ds_read_b128 v[108:111], v86 offset:3072
    ds_read_b128 v[112:115], v86 offset:4096
    ds_read_b128 v[116:119], v86 offset:5120
    ds_read_b128 v[120:123], v86 offset:6144
    ds_read_b128 v[124:127], v86 offset:7168
    v_mov_b32 v32, 0
    v_mov_b32 v33, 0
    v_mov_b32 v34, 0
    v_mov_b32 v35, 0
    v_mov_b32 v36, 0
    v_mov_b32 v37, 0
    v_mov_b32 v38, 0
    v_mov_b32 v39, 0
    v_mov_b32 v40, 0
    v_mov_b32 v41, 0
    v_mov_b32 v42, 0
    v_mov_b32 v43, 0
    v_mov_b32 v44, 0
    v_mov_b32 v45, 0
    v_mov_b32 v46, 0
    v_mov_b32 v47, 0
    v_mov_b32 v48, 0
    v_mov_b32 v49, 0
    v_mov_b32 v50, 0
    v_mov_b32 v51, 0
    v_mov_b32 v52, 0
    v_mov_b32 v53, 0
    v_mov_b32 v54, 0
    v_mov_b32 v55, 0
    v_mov_b32 v78, s90
    v_cndmask_b32 v76, v89, v78, s[76:77]
    v_cndmask_b32 v77, v78, v89, s[76:77]
    v_lshlrev_b32 v78, 1, v88
    v_add_u32 v78, -145408, v78
    v_lshrrev_b32 v79, 1, v87
    v_mov_b32 v56, v79
    v_add_u32 v79, s88, v79
    s_max_i32 s20, s5, 1
    s_sub_u32 s20, s20, 1
    v_mov_b32 v57, s20
    s_waitcnt vmcnt(0)
    s_nop 0
    s_branch Ltop1_43
Lw0_51:
    s_nop 15
    s_nop 15
    s_nop 15
    s_nop 15
    v_lshrrev_b32 v77, 2, v87
    s_mov_b32 exec_hi, 0
    buffer_load_dword v76, v77, s[8:11], s46 offen sc1
    s_mov_b32 exec_hi, -1
    buffer_load_dwordx4 v[0:3], v87, s[8:11], s85 offen offset:0 sc1
    buffer_load_dwordx4 v[4:7], v87, s[8:11], s85 offen offset:1024 sc1
    buffer_load_dwordx4 v[8:11], v87, s[8:11], s85 offen offset:2048 sc1
    buffer_load_dwordx4 v[12:15], v87, s[8:11], s85 offen offset:3072 sc1
    buffer_load_dwordx4 v[16:19], v87, s[8:11], s86 offen offset:0 sc1
    buffer_load_dwordx4 v[20:23], v87, s[8:11], s86 offen offset:1024 sc1
    buffer_load_dwordx4 v[24:27], v87, s[8:11], s86 offen offset:2048 sc1
    buffer_load_dwordx4 v[28:31], v87, s[8:11], s86 offen offset:3072 sc1
    ds_read_b128 v[96:99], v86 offset:0
    ds_read_b128 v[100:103], v86 offset:1024
    ds_read_b128 v[104:107], v86 offset:2048
    ds_read_b128 v[108:111], v86 offset:3072
    ds_read_b128 v[112:115], v86 offset:4096
    ds_read_b128 v[116:119], v86 offset:5120
    ds_read_b128 v[120:123], v86 offset:6144
    ds_read_b128 v[124:127], v86 offset:7168
    v_and_b32 v94, 16, v87
    v_mov_b32 v95, 0x3f80
    v_lshlrev_b32 v94, v94, v95
    v_cndmask_b32 v56, 0, v94, s[32:33]
    v_cndmask_b32 v57, 0, v94, s[34:35]
    v_cndmask_b32 v58, 0, v94, s[36:37]
    v_cndmask_b32 v59, 0, v94, s[38:39]
    v_mov_b32 v32, 0
    v_mov_b32 v33, 0
    v_mov_b32 v34, 0
    v_mov_b32 v35, 0
    v_mov_b32 v36, 0
    v_mov_b32 v37, 0
    v_mov_b32 v38, 0
    v_mov_b32 v39, 0
    v_mov_b32 v40, 0
    v_mov_b32 v41, 0
    v_mov_b32 v42, 0
    v_mov_b32 v43, 0
    v_mov_b32 v44, 0
    v_mov_b32 v45, 0
    v_mov_b32 v46, 0
    v_mov_b32 v47, 0
    v_mov_b32 v48, 0
    v_mov_b32 v49, 0
    v_mov_b32 v50, 0
    v_mov_b32 v51, 0
    v_mov_b32 v52, 0
    v_mov_b32 v53, 0
    v_mov_b32 v54, 0
    v_mov_b32 v55, 0
Lg0_55:
    s_mov_b32 exec_hi, 0
    s_waitcnt vmcnt(8)
    v_and_b32 v76, 1, v76
    v_cmp_ne_u32 vcc, 0, v76
    s_mov_b32 exec_hi, -1
    s_cbranch_vccnz Lgr_56
    s_waitcnt vmcnt(7)
    v_mfma_f32_16x16x32_bf16 v[60:63], v[0:3], v[56:59], 0
    v_or_b32 v94, v0, v2
    s_waitcnt vmcnt(6)
    v_mfma_f32_16x16x32_bf16 v[60:63], v[4:7], v[56:59], v[60:63]
    v_or3_b32 v94, v94, v4, v6
    s_waitcnt vmcnt(5)
    v_mfma_f32_16x16x32_bf16 v[60:63], v[8:11], v[56:59], v[60:63]
    v_or3_b32 v94, v94, v8, v10
    s_waitcnt vmcnt(4)
    v_mfma_f32_16x16x32_bf16 v[60:63], v[12:15], v[56:59], v[60:63]
    v_or3_b32 v94, v94, v12, v14
    s_waitcnt vmcnt(3)
    v_mfma_f32_16x16x32_bf16 v[60:63], v[16:19], v[56:59], v[60:63]
    v_or3_b32 v94, v94, v16, v18
    s_waitcnt vmcnt(2)
    v_mfma_f32_16x16x32_bf16 v[60:63], v[20:23], v[56:59], v[60:63]
    v_or3_b32 v94, v94, v20, v22
    s_waitcnt vmcnt(1)
    v_mfma_f32_16x16x32_bf16 v[60:63], v[24:27], v[56:59], v[60:63]
    v_or3_b32 v94, v94, v24, v26
    s_waitcnt vmcnt(0)
    v_mfma_f32_16x16x32_bf16 v[60:63], v[28:31], v[56:59], v[60:63]
    v_or3_b32 v94, v94, v28, v30
    v_and_b32 v94, 1, v94
    v_cmp_ne_u32 vcc, 0, v94
    s_cbranch_vccnz Lgr_56
Lgo_57:
    s_nop 3
    v_cvt_pk_bf16_f32 v80, v60, v61
    v_cvt_pk_bf16_f32 v81, v62, v63
    v_or_b32 v80, 1, v80
    buffer_store_dwordx2 v[80:81], v93, s[8:11], s26 offen sc1
    s_mov_b64 exec, 1
    buffer_store_dword v80, off, s[8:11], s82 sc1
    s_mov_b64 exec, -1
Lmd1_45:
    s_nop 15
    s_nop 15
    s_nop 15
    v_lshrrev_b32 v95, 2, v87
    s_mov_b32 exec_hi, 0
    buffer_load_dword v94, v95, s[8:11], s43 offen offset:0 sc1
    s_mov_b32 exec_hi, -1
    s_mov_b32 m0, 131072
    s_nop 0
    buffer_load_dwordx4 v87, s[8:11], s27 offen offset:0 sc1 lds
    buffer_load_dwordx4 v87, s[8:11], s27 offen offset:1024 sc1 lds
    buffer_load_dwordx4 v87, s[8:11], s27 offen offset:2048 sc1 lds
    buffer_load_dwordx4 v87, s[8:11], s27 offen offset:3072 sc1 lds
    s_mov_b32 m0, 135168
    s_nop 0
    buffer_load_dwordx4 v87, s[8:11], s28 offen offset:0 sc1 lds
    buffer_load_dwordx4 v87, s[8:11], s28 offen offset:1024 sc1 lds
    buffer_load_dwordx4 v87, s[8:11], s28 offen offset:2048 sc1 lds
    buffer_load_dwordx4 v87, s[8:11], s28 offen offset:3072 sc1 lds
    v_mov_b32 v78, s90
    v_cndmask_b32 v76, v89, v78, s[76:77]
    v_cndmask_b32 v77, v78, v89, s[76:77]
    v_lshlrev_b32 v78, 1, v88
    v_add_u32 v78, -145408, v78
    v_lshrrev_b32 v79, 1, v87
    v_mov_b32 v56, v79
    v_add_u32 v79, s88, v79
    s_max_i32 s20, s5, 1
    s_sub_u32 s20, s20, 1
    v_mov_b32 v57, s20
    s_mov_b32 exec_hi, 0
    s_waitcnt vmcnt(8)
    v_and_b32 v94, 1, v94
    v_cmp_ne_u32 vcc, 1, v94
    s_mov_b32 exec_hi, -1
    s_cbranch_vccnz Lpr_62
    s_waitcnt vmcnt(0)
Ltop1_43:
    s_waitcnt lgkmcnt(0)
    s_barrier
Lq_59:
    ds_read_b128 v[0:3], v87 offset:0
    ds_read_b128 v[4:7], v87 offset:1024
    ds_read_b128 v[8:11], v87 offset:2048
    ds_read_b128 v[12:15], v87 offset:3072
    ds_read_b128 v[16:19], v87 offset:4096
    s_waitcnt lgkmcnt(4)
    v_smfmac_f32_16x16x64_bf16 v[32:35], v[0:3], a[0:7], v84
    ds_read_b128 v[20:23], v87 offset:5120
    v_smfmac_f32_16x16x64_bf16 v[36:39], v[0:3], a[64:71], v84
    ds_read_b128 v[24:27], v87 offset:6144
    s_waitcnt lgkmcnt(5)
    v_smfmac_f32_16x16x64_bf16 v[32:35], v[4:7], a[8:15], v84
    ds_read_b128 v[28:31], v87 offset:7168
    v_smfmac_f32_16x16x64_bf16 v[36:39], v[4:7], a[72:79], v84
    s_waitcnt lgkmcnt(5)
    v_smfmac_f32_16x16x64_bf16 v[32:35], v[8:11], a[16:23], v84
    v_smfmac_f32_16x16x64_bf16 v[36:39], v[8:11], a[80:87], v84
    s_waitcnt lgkmcnt(4)
    v_smfmac_f32_16x16x64_bf16 v[32:35], v[12:15], a[24:31], v84
    v_smfmac_f32_16x16x64_bf16 v[36:39], v[12:15], a[88:95], v84
    s_waitcnt lgkmcnt(0)
    v_smfmac_f32_16x16x64_bf16 v[32:35], v[16:19], a[32:39], v84
    v_and_b32 v94, v0, v2
    v_smfmac_f32_16x16x64_bf16 v[36:39], v[16:19], a[96:103], v84
    v_bitop3_b32 v94, v94, v4, v6 bitop3:0x80
    v_smfmac_f32_16x16x64_bf16 v[32:35], v[20:23], a[40:47], v84
    v_bitop3_b32 v94, v94, v8, v10 bitop3:0x80
    v_smfmac_f32_16x16x64_bf16 v[36:39], v[20:23], a[104:111], v84
    v_bitop3_b32 v94, v94, v12, v14 bitop3:0x80
    v_smfmac_f32_16x16x64_bf16 v[32:35], v[24:27], a[48:55], v84
    v_bitop3_b32 v94, v94, v16, v18 bitop3:0x80
    v_smfmac_f32_16x16x64_bf16 v[36:39], v[24:27], a[112:119], v84
    v_bitop3_b32 v94, v94, v20, v22 bitop3:0x80
    v_smfmac_f32_16x16x64_bf16 v[32:35], v[28:31], a[56:63], v84
    v_bitop3_b32 v94, v94, v24, v26 bitop3:0x80
    v_smfmac_f32_16x16x64_bf16 v[36:39], v[28:31], a[120:127], v84
    v_bitop3_b32 v94, v94, v28, v30 bitop3:0x80
    v_smfmac_f32_16x16x64_bf16 v[40:43], v[0:3], a[128:135], v84
    s_add_u32 s23, s30, 66977792
    buffer_store_dwordx4 v[72:75], v87, s[8:11], s23 offen sc1
    v_and_b32 v94, 1, v94
    v_smfmac_f32_16x16x64_bf16 v[44:47], v[0:3], a[192:199], v84
    s_lshr_b32 s23, s30, 1
    s_add_u32 s23, s23, 75431936
    v_cmp_ne_u32 vcc, 1, v94
    v_smfmac_f32_16x16x64_bf16 v[40:43], v[4:7], a[136:143], v84
    s_lshr_b32 s30, s29, 1
    buffer_store_dwordx2 v[82:83], v56, s[8:11], s23 offen sc1
    v_add_f32 v32, v32, v33
    v_smfmac_f32_16x16x64_bf16 v[44:47], v[4:7], a[200:207], v84
    s_add_u32 s29, s29, 262144
    s_cbranch_vccnz Lfail_58
Lqok_60:
    v_add_f32 v34, v34, v35
    v_smfmac_f32_16x16x64_bf16 v[40:43], v[8:11], a[144:151], v84
    s_add_u32 s20, s29, 33423360
    v_add_f32 v36, v36, v37
    v_smfmac_f32_16x16x64_bf16 v[44:47], v[8:11], a[208:215], v84
    s_add_u32 s21, s5, 2
    s_min_u32 s21, s21, 63
    v_add_f32 v38, v38, v39
    v_smfmac_f32_16x16x64_bf16 v[40:43], v[12:15], a[152:159], v84
    s_lshr_b32 s21, s21, 2
    s_lshl_b32 s21, s21, 7
    v_cvt_pk_bf16_f32 v32, v32, v34
    v_smfmac_f32_16x16x64_bf16 v[44:47], v[12:15], a[216:223], v84
    v_cvt_pk_bf16_f32 v36, v36, v38
    v_smfmac_f32_16x16x64_bf16 v[40:43], v[16:19], a[160:167], v84
    s_nop 0
    ds_write2_b32 v88, v32, v36 offset0:0 offset1:64
    ds_read_b64_tr_b16 v[56:57], v76
    v_smfmac_f32_16x16x64_bf16 v[44:47], v[16:19], a[224:231], v84
    ds_read_b64_tr_b16 v[58:59], v76 offset:256
    ds_read_b64_tr_b16 v[60:61], v77
    ds_read_b64_tr_b16 v[62:63], v77 offset:256
    v_smfmac_f32_16x16x64_bf16 v[40:43], v[20:23], a[168:175], v84
    v_add_u32 v76, s87, v87
    v_smfmac_f32_16x16x64_bf16 v[44:47], v[20:23], a[232:239], v84
    v_cmp_gt_u32 vcc, 3, v85
    v_smfmac_f32_16x16x64_bf16 v[40:43], v[24:27], a[176:183], v84
    v_smfmac_f32_16x16x64_bf16 v[44:47], v[24:27], a[240:247], v84
    s_cbranch_vccnz Lfl_63
Lflb_64:
    s_add_u32 s91, s21, s93
    v_smfmac_f32_16x16x64_bf16 v[40:43], v[28:31], a[184:191], v84
    buffer_load_dword v85, off, s[8:11], s91 sc1
    v_smfmac_f32_16x16x64_bf16 v[44:47], v[28:31], a[248:255], v84
    s_waitcnt lgkmcnt(0)
    v_mfma_f32_16x16x32_bf16 v[32:35], v[64:67], v[56:59], 0
    v_add_f32 v40, v40, v41
    v_add_f32 v42, v42, v43
    v_mfma_f32_16x16x32_bf16 v[32:35], v[68:71], v[60:63], v[32:35]
    v_cvt_pk_bf16_f32 v40, v40, v42
    v_add_f32 v44, v44, v45
    v_add_f32 v46, v46, v47
    v_cvt_pk_bf16_f32 v44, v44, v46
    v_smfmac_f32_16x16x64_bf16 v[52:55], v[0:3], v[96:103], v84
    s_nop 0
    ds_write2_b32 v78, v40, v44 offset0:0 offset1:128
    ds_read_b64_tr_b16 v[72:73], v79
    v_smfmac_f32_16x16x64_bf16 v[48:51], v[0:3], v[128:135], v84
    ds_read_b64_tr_b16 v[74:75], v79 offset:512
    v_smfmac_f32_16x16x64_bf16 v[52:55], v[4:7], v[104:111], v84
    ds_write_b128 v76, v[32:35] offset:22528
    v_smfmac_f32_16x16x64_bf16 v[48:51], v[4:7], v[136:143], v84
    ds_read_b128 v[96:99], v86 offset:8192
    v_mov_b32 v0, 0
    v_smfmac_f32_16x16x64_bf16 v[52:55], v[8:11], v[112:119], v84
    s_waitcnt lgkmcnt(2)
    ds_read_b128 v[100:103], v86 offset:9216
    v_mfma_f32_16x16x32_bf16 v[40:43], v[72:75], v[56:59], 0
    ds_read_b128 v[104:107], v86 offset:10240
    v_mov_b32 v1, 0
    v_mfma_f32_16x16x32_bf16 v[40:43], v[72:75], v[60:63], v[40:43]
    v_mov_b32 v2, 0
    v_mov_b32 v3, 0
    v_smfmac_f32_16x16x64_bf16 v[48:51], v[8:11], v[144:151], v84
    s_waitcnt lgkmcnt(3)
    s_barrier
    ds_read_b128 v[32:35], v87 offset:22528
    ds_read_b128 v[36:39], v87 offset:23552
    v_smfmac_f32_16x16x64_bf16 v[52:55], v[12:15], v[120:127], v84
    ds_read_b128 v[44:47], v87 offset:24576
    ds_read_b128 v[80:83], v87 offset:25600
    v_cndmask_b32 v40, v40, v41, s[40:41]
    v_smfmac_f32_16x16x64_bf16 v[48:51], v[12:15], v[152:159], v84
    s_add_u32 m0, s87, 131072
    ds_write_b32 v91, v40 offset:29696
    ds_read_b128 v[108:111], v86 offset:11264
    v_smfmac_f32_16x16x64_bf16 v[48:51], v[16:19], v[160:167], v84
    ds_read_b128 v[112:115], v86 offset:12288
    ds_read_b128 v[116:119], v86 offset:13312
    v_smfmac_f32_16x16x64_bf16 v[48:51], v[20:23], v[168:175], v84
    buffer_load_dwordx4 v[64:67], v87, s[8:11], s20 offen sc1
    ds_read_b128 v[120:123], v86 offset:14336
    v_smfmac_f32_16x16x64_bf16 v[48:51], v[24:27], v[176:183], v84
    ds_read_b128 v[124:127], v86 offset:15360
    s_waitcnt lgkmcnt(8)
    v_add_f32 v32, v32, v36
    v_add_f32 v33, v33, v37
    v_add_f32 v34, v34, v38
    v_add_f32 v35, v35, v39
    v_smfmac_f32_16x16x64_bf16 v[48:51], v[28:31], v[184:191], v84
    s_waitcnt lgkmcnt(6)
    v_add_f32 v44, v44, v80
    v_add_f32 v45, v45, v81
    v_add_f32 v46, v46, v82
    v_add_f32 v47, v47, v83
    v_smfmac_f32_16x16x64_bf16 v[52:55], v[16:19], v[96:103], v84
    s_waitcnt lgkmcnt(5)
    s_barrier
    ds_read_b128 v[40:43], v87 offset:29696
    s_waitcnt lgkmcnt(5)
    v_smfmac_f32_16x16x64_bf16 v[52:55], v[20:23], v[104:111], v84
    ds_read_b64 v[82:83], v76 offset:12288
    ds_read_b64 v[80:81], v76 offset:12296
    v_add_f32 v32, v32, v44
    s_waitcnt lgkmcnt(5)
    v_smfmac_f32_16x16x64_bf16 v[52:55], v[24:27], v[112:119], v84
    buffer_load_dwordx4 v[68:71], v87, s[8:11], s20 offen offset:1024 sc1
    ds_read_b128 v[76:79], v76 offset:8192
    v_add_f32 v33, v33, v45
    v_add_f32 v34, v34, v46
    s_waitcnt lgkmcnt(4)
    v_smfmac_f32_16x16x64_bf16 v[52:55], v[28:31], v[120:127], v84
    s_add_u32 s22, s29, 50200576
    buffer_load_dwordx4 v87, s[8:11], s22 offen sc1 lds
    ds_read_b128 v[96:99], v86 offset:16384
    ds_read_b128 v[100:103], v86 offset:17408
    v_add_f32 v35, v35, v47
    v_max3_f32 v94, v32, v33, v34
    s_waitcnt lgkmcnt(5)
    v_add_f32 v40, v40, v41
    v_add_f32 v42, v42, v43
    v_add_f32 v40, v40, v42
    v_max3_f32 v94, v94, v35, v40
    v_add_f32 v48, v48, v49
    v_add_f32 v50, v50, v51
    v_max_f32_dpp v94, v94, v94 row_ror:8 row_mask:0xf bank_mask:0xf
    v_mov_b32 v95, v94
    v_cvt_pk_bf16_f32 v48, v48, v50
    v_mov_b32 v49, 0
    v_permlane32_swap_b32 v94, v95
    v_max_f32 v94, v94, v95
    v_mov_b32 v95, v94
    v_add_f32 v52, v52, v53
    v_add_f32 v54, v54, v55
    v_permlane16_swap_b32 v94, v95
    v_max_f32 v94, v94, v95
    v_mul_f32 v94, s42, v94
    v_fma_f32 v32, v32, s42, -v94
    v_fma_f32 v33, v33, s42, -v94
    v_exp_f32 v32, v32
    v_exp_f32 v33, v33
    v_fma_f32 v34, v34, s42, -v94
    v_fma_f32 v35, v35, s42, -v94
    v_cvt_pk_bf16_f32 v44, v32, v33
    v_exp_f32 v34, v34
    v_exp_f32 v35, v35
    v_fma_f32 v40, v40, s42, -v94
    v_cvt_pk_bf16_f32 v45, v34, v35
    v_mov_b32_dpp v46, v44 row_ror:8 row_mask:0xf bank_mask:0xf
    v_exp_f32 v40, v40
    v_mov_b32_dpp v47, v45 row_ror:8 row_mask:0xf bank_mask:0xf
    v_cvt_pk_bf16_f32 v52, v54, v52
    v_mov_b32_dpp v41, v40 row_ror:8 row_mask:0xf bank_mask:0xf
    v_mov_b32 v53, 0
    v_cvt_pk_bf16_f32 v42, v40, v41
    s_waitcnt lgkmcnt(2)
    v_mfma_f32_16x16x32_bf16 v[56:59], v[76:79], v[44:47], 0
    s_add_u32 m0, s87, 134144
    ds_read_b128 v[104:107], v86 offset:18432
    v_mov_b32 v43, 0
    v_mfma_f32_16x16x32_bf16 v[60:63], v[80:83], v[44:47], 0
    v_add_f32 v32, v32, v33
    v_add_f32 v34, v34, v35
    v_mfma_f32_16x16x16_bf16 v[56:59], v[48:49], v[42:43], v[56:59]
    v_add_f32 v32, v32, v40
    v_add_f32 v94, v32, v34
    v_mfma_f32_16x16x16_bf16 v[60:63], v[52:53], v[42:43], v[60:63]
    s_cmp_eq_u32 s5, 63
    ds_read_b128 v[108:111], v86 offset:19456
    ds_read_b128 v[112:115], v86 offset:20480
    v_add_f32_dpp v94, v94, v94 row_ror:8 row_mask:0xf bank_mask:0xf
    v_mov_b32 v95, v94
    v_mov_b32 v4, 0
    v_mov_b32 v5, 0
    v_permlane32_swap_b32 v94, v95
    v_add_f32 v94, v94, v95
    v_mov_b32 v95, v94
    v_cndmask_b32 v56, v56, v60, s[40:41]
    v_cndmask_b32 v57, v57, v61, s[40:41]
    v_permlane16_swap_b32 v94, v95
    v_add_f32 v94, v94, v95
    v_rcp_f32 v94, v94
    v_cndmask_b32 v58, v58, v62, s[40:41]
    v_cndmask_b32 v59, v59, v63, s[40:41]
    v_mul_f32 v56, v56, v94
    v_mul_f32 v57, v57, v94
    v_mul_f32 v58, v58, v94
    v_mul_f32 v59, v59, v94
    v_cvt_pk_bf16_f32 v32, v56, v57
    v_cvt_pk_bf16_f32 v33, v58, v59
    v_mfma_f32_16x16x4_f32 v[40:43], v84, v84, 0
    s_cbranch_scc1 Lend_40
    ds_write_b64 v90, v[32:33]
    ds_read_b128 v[116:119], v86 offset:21504
    ds_read_b128 v[120:123], v86 offset:22528
    buffer_load_dwordx4 v87, s[8:11], s22 offen offset:1024 sc1 lds
    v_mov_b32 v6, 0
    v_mov_b32 v7, 0
    v_mov_b32 v8, 0
    v_mov_b32 v9, 0
    v_mov_b32 v10, 0
    v_mov_b32 v11, 0
    v_mov_b32 v12, 0
    v_mov_b32 v13, 0
    v_mov_b32 v14, 0
    v_mov_b32 v15, 0
    v_mfma_f32_16x16x4_f32 v[44:47], v84, v84, 0
    ds_read_b128 v[124:127], v86 offset:23552
    s_waitcnt lgkmcnt(3)
    s_barrier
    ds_read_b128 v[56:59], v87 offset:16384
    ds_read_b128 v[60:63], v87 offset:17408
    v_mov_b32 v16, 0
    v_mov_b32 v17, 0
    v_mov_b32 v18, 0
    v_mov_b32 v19, 0
    v_mov_b32 v20, 0
    v_mov_b32 v21, 0
    v_mov_b32 v22, 0
    v_mov_b32 v23, 0
    v_mov_b32 v24, 0
    v_mov_b32 v25, 0
    v_mov_b32 v26, 0
    v_mov_b32 v27, 0
    v_mov_b32 v82, v48
    v_alignbit_b32 v83, v52, v52, 16
    s_waitcnt lgkmcnt(0)
    v_smfmac_f32_16x16x64_bf16 v[16:19], v[56:59], v[96:103], v84
    v_mov_b32 v28, 0
    v_smfmac_f32_16x16x64_bf16 v[20:23], v[56:59], v[112:119], v84
    ds_read_b128 v[96:99], v86 offset:24576
    v_mov_b32 v29, 0
    v_smfmac_f32_16x16x64_bf16 v[16:19], v[60:63], v[104:111], v84
    ds_read_b128 v[100:103], v86 offset:25600
    v_mov_b32 v30, 0
    v_smfmac_f32_16x16x64_bf16 v[20:23], v[60:63], v[120:127], v84
    ds_read_b128 v[104:107], v86 offset:26624
    v_mov_b32 v31, 0
    v_smfmac_f32_16x16x64_bf16 v[0:3], v[56:59], v[192:199], v84
    ds_read_b128 v[108:111], v86 offset:27648
    v_add_f32 v16, v16, v17
    v_smfmac_f32_16x16x64_bf16 v[4:7], v[56:59], v[208:215], v84
    ds_read_b128 v[112:115], v86 offset:28672
    v_add_f32 v18, v18, v19
    v_smfmac_f32_16x16x64_bf16 v[0:3], v[60:63], v[200:207], v84
    ds_read_b128 v[116:119], v86 offset:29696
    v_add_f32 v20, v20, v21
    v_add_f32 v22, v22, v23
    v_smfmac_f32_16x16x64_bf16 v[4:7], v[60:63], v[216:223], v84
    ds_read_b128 v[120:123], v86 offset:30720
    v_cvt_pk_bf16_f32 v36, v16, v18
    v_or_b32 v36, 1, v36
    v_smfmac_f32_16x16x64_bf16 v[8:11], v[56:59], v[224:231], v84
    ds_read_b128 v[124:127], v86 offset:31744
    v_cvt_pk_bf16_f32 v37, v20, v22
    v_add_f32 v0, v0, v1
    v_smfmac_f32_16x16x64_bf16 v[12:15], v[56:59], v[240:247], v84
    s_nop 0
    buffer_store_dwordx2 v[36:37], v92, s[8:11], s74 offen sc1
    v_add_f32 v2, v2, v3
    v_smfmac_f32_16x16x64_bf16 v[8:11], v[60:63], v[232:239], v84
    v_add_f32 v4, v4, v5
    v_add_f32 v6, v6, v7
    v_smfmac_f32_16x16x64_bf16 v[12:15], v[60:63], v[248:255], v84
    s_waitcnt lgkmcnt(4)
    v_cvt_pk_bf16_f32 v32, v0, v2
    v_or_b32 v32, 1, v32
    v_smfmac_f32_16x16x64_bf16 v[24:27], v[56:59], v[96:103], v84
    v_cvt_pk_bf16_f32 v33, v4, v6
    v_add_f32 v8, v8, v9
    v_smfmac_f32_16x16x64_bf16 v[24:27], v[60:63], v[104:111], v84
    s_waitcnt lgkmcnt(0)
    buffer_store_dwordx2 v[32:33], v92, s[8:11], s72 offen sc1
    v_add_f32 v10, v10, v11
    v_smfmac_f32_16x16x64_bf16 v[28:31], v[56:59], v[112:119], v84
    v_add_f32 v12, v12, v13
    v_add_f32 v14, v14, v15
    v_smfmac_f32_16x16x64_bf16 v[28:31], v[60:63], v[120:127], v84
    v_cvt_pk_bf16_f32 v34, v8, v10
    v_or_b32 v34, 1, v34
    v_cvt_pk_bf16_f32 v35, v12, v14
    v_add_f32 v24, v24, v25
    v_add_f32 v26, v26, v27
    v_cvt_pk_bf16_f32 v38, v24, v26
    v_or_b32 v38, 1, v38
    buffer_store_dwordx2 v[34:35], v92, s[8:11], s73 offen sc1
    v_add_f32 v28, v28, v29
    v_add_f32 v30, v30, v31
    v_cvt_pk_bf16_f32 v39, v28, v30
    buffer_store_dwordx2 v[38:39], v92, s[8:11], s75 offen sc1
    s_mov_b64 exec, 1
    buffer_store_dword v38, off, s[8:11], s47 sc1
    s_mov_b64 exec, -1
    s_add_u32 s5, s5, 1
    s_cmp_eq_u32 s3, 0
    s_cbranch_scc1 Lw0_61
    ds_read_b128 v[96:99], v86 offset:0
    ds_read_b128 v[100:103], v86 offset:1024
    ds_read_b128 v[104:107], v86 offset:2048
    ds_read_b128 v[108:111], v86 offset:3072
    ds_read_b128 v[112:115], v86 offset:4096
    ds_read_b128 v[116:119], v86 offset:5120
    ds_read_b128 v[120:123], v86 offset:6144
    ds_read_b128 v[124:127], v86 offset:7168
    v_mov_b32 v32, 0
    v_mov_b32 v33, 0
    v_mov_b32 v34, 0
    v_mov_b32 v35, 0
    v_mov_b32 v36, 0
    v_mov_b32 v37, 0
    v_mov_b32 v38, 0
    v_mov_b32 v39, 0
    v_mov_b32 v40, 0
    v_mov_b32 v41, 0
    v_mov_b32 v42, 0
    v_mov_b32 v43, 0
    v_mov_b32 v44, 0
    v_mov_b32 v45, 0
    v_mov_b32 v46, 0
    v_mov_b32 v47, 0
    v_mov_b32 v48, 0
    v_mov_b32 v49, 0
    v_mov_b32 v50, 0
    v_mov_b32 v51, 0
    v_mov_b32 v52, 0
    v_mov_b32 v53, 0
    v_mov_b32 v54, 0
    v_mov_b32 v55, 0
    v_mov_b32 v78, s90
    v_cndmask_b32 v76, v89, v78, s[76:77]
    v_cndmask_b32 v77, v78, v89, s[76:77]
    v_lshlrev_b32 v78, 1, v88
    v_add_u32 v78, -145408, v78
    v_lshrrev_b32 v79, 1, v87
    v_mov_b32 v56, v79
    v_add_u32 v79, s88, v79
    s_max_i32 s20, s5, 1
    s_sub_u32 s20, s20, 1
    v_mov_b32 v57, s20
    s_waitcnt vmcnt(0)
    s_nop 0
    s_branch Ltop0_42
Lw0_61:
    s_nop 15
    s_nop 15
    s_nop 15
    s_nop 15
    v_lshrrev_b32 v77, 2, v87
    s_mov_b32 exec_hi, 0
    buffer_load_dword v76, v77, s[8:11], s46 offen sc1
    s_mov_b32 exec_hi, -1
    buffer_load_dwordx4 v[0:3], v87, s[8:11], s85 offen offset:0 sc1
    buffer_load_dwordx4 v[4:7], v87, s[8:11], s85 offen offset:1024 sc1
    buffer_load_dwordx4 v[8:11], v87, s[8:11], s85 offen offset:2048 sc1
    buffer_load_dwordx4 v[12:15], v87, s[8:11], s85 offen offset:3072 sc1
    buffer_load_dwordx4 v[16:19], v87, s[8:11], s86 offen offset:0 sc1
    buffer_load_dwordx4 v[20:23], v87, s[8:11], s86 offen offset:1024 sc1
    buffer_load_dwordx4 v[24:27], v87, s[8:11], s86 offen offset:2048 sc1
    buffer_load_dwordx4 v[28:31], v87, s[8:11], s86 offen offset:3072 sc1
    ds_read_b128 v[96:99], v86 offset:0
    ds_read_b128 v[100:103], v86 offset:1024
    ds_read_b128 v[104:107], v86 offset:2048
    ds_read_b128 v[108:111], v86 offset:3072
    ds_read_b128 v[112:115], v86 offset:4096
    ds_read_b128 v[116:119], v86 offset:5120
    ds_read_b128 v[120:123], v86 offset:6144
    ds_read_b128 v[124:127], v86 offset:7168
    v_and_b32 v94, 16, v87
    v_mov_b32 v95, 0x3f80
    v_lshlrev_b32 v94, v94, v95
    v_cndmask_b32 v56, 0, v94, s[32:33]
    v_cndmask_b32 v57, 0, v94, s[34:35]
    v_cndmask_b32 v58, 0, v94, s[36:37]
    v_cndmask_b32 v59, 0, v94, s[38:39]
    v_mov_b32 v32, 0
    v_mov_b32 v33, 0
    v_mov_b32 v34, 0
    v_mov_b32 v35, 0
    v_mov_b32 v36, 0
    v_mov_b32 v37, 0
    v_mov_b32 v38, 0
    v_mov_b32 v39, 0
    v_mov_b32 v40, 0
    v_mov_b32 v41, 0
    v_mov_b32 v42, 0
    v_mov_b32 v43, 0
    v_mov_b32 v44, 0
    v_mov_b32 v45, 0
    v_mov_b32 v46, 0
    v_mov_b32 v47, 0
    v_mov_b32 v48, 0
    v_mov_b32 v49, 0
    v_mov_b32 v50, 0
    v_mov_b32 v51, 0
    v_mov_b32 v52, 0
    v_mov_b32 v53, 0
    v_mov_b32 v54, 0
    v_mov_b32 v55, 0
Lg0_65:
    s_mov_b32 exec_hi, 0
    s_waitcnt vmcnt(8)
    v_and_b32 v76, 1, v76
    v_cmp_ne_u32 vcc, 1, v76
    s_mov_b32 exec_hi, -1
    s_cbranch_vccnz Lgr_66
    s_waitcnt vmcnt(7)
    v_mfma_f32_16x16x32_bf16 v[60:63], v[0:3], v[56:59], 0
    v_and_b32 v94, v0, v2
    s_waitcnt vmcnt(6)
    v_mfma_f32_16x16x32_bf16 v[60:63], v[4:7], v[56:59], v[60:63]
    v_bitop3_b32 v94, v94, v4, v6 bitop3:0x80
    s_waitcnt vmcnt(5)
    v_mfma_f32_16x16x32_bf16 v[60:63], v[8:11], v[56:59], v[60:63]
    v_bitop3_b32 v94, v94, v8, v10 bitop3:0x80
    s_waitcnt vmcnt(4)
    v_mfma_f32_16x16x32_bf16 v[60:63], v[12:15], v[56:59], v[60:63]
    v_bitop3_b32 v94, v94, v12, v14 bitop3:0x80
    s_waitcnt vmcnt(3)
    v_mfma_f32_16x16x32_bf16 v[60:63], v[16:19], v[56:59], v[60:63]
    v_bitop3_b32 v94, v94, v16, v18 bitop3:0x80
    s_waitcnt vmcnt(2)
    v_mfma_f32_16x16x32_bf16 v[60:63], v[20:23], v[56:59], v[60:63]
    v_bitop3_b32 v94, v94, v20, v22 bitop3:0x80
    s_waitcnt vmcnt(1)
    v_mfma_f32_16x16x32_bf16 v[60:63], v[24:27], v[56:59], v[60:63]
    v_bitop3_b32 v94, v94, v24, v26 bitop3:0x80
    s_waitcnt vmcnt(0)
    v_mfma_f32_16x16x32_bf16 v[60:63], v[28:31], v[56:59], v[60:63]
    v_bitop3_b32 v94, v94, v28, v30 bitop3:0x80
    v_and_b32 v94, 1, v94
    v_cmp_ne_u32 vcc, 1, v94
    s_cbranch_vccnz Lgr_66
Lgo_67:
    s_nop 3
    v_cvt_pk_bf16_f32 v80, v60, v61
    v_cvt_pk_bf16_f32 v81, v62, v63
    v_and_b32 v80, -2, v80
    buffer_store_dwordx2 v[80:81], v93, s[8:11], s26 offen sc1
    s_mov_b64 exec, 1
    buffer_store_dword v80, off, s[8:11], s82 sc1
    s_mov_b64 exec, -1
    s_branch Lmd0_44
Lgr_56:
    s_add_u32 s45, s45, 1
    s_cmp_gt_u32 s45, 200000000
    s_cbranch_scc1 Lgo_57
    s_mov_b32 exec_hi, 0
    buffer_load_dword v76, v77, s[8:11], s46 offen sc1
    s_mov_b32 exec_hi, -1
    buffer_load_dwordx4 v[0:3], v87, s[8:11], s85 offen offset:0 sc1
    buffer_load_dwordx4 v[4:7], v87, s[8:11], s85 offen offset:1024 sc1
    buffer_load_dwordx4 v[8:11], v87, s[8:11], s85 offen offset:2048 sc1
    buffer_load_dwordx4 v[12:15], v87, s[8:11], s85 offen offset:3072 sc1
    buffer_load_dwordx4 v[16:19], v87, s[8:11], s86 offen offset:0 sc1
    buffer_load_dwordx4 v[20:23], v87, s[8:11], s86 offen offset:1024 sc1
    buffer_load_dwordx4 v[24:27], v87, s[8:11], s86 offen offset:2048 sc1
    buffer_load_dwordx4 v[28:31], v87, s[8:11], s86 offen offset:3072 sc1
    s_branch Lg0_55
Lpr_52:
    s_add_u32 s45, s45, 0x100
    s_cmp_gt_u32 s45, 200000000
    s_cbranch_scc1 Lp2_68
    v_lshrrev_b32 v95, 2, v87
    s_mov_b32 exec_hi, 0
    buffer_load_dword v94, v95, s[8:11], s43 offen offset:0 sc1
    s_mov_b32 exec_hi, -1
    s_mov_b32 m0, 139264
    s_nop 0
    buffer_load_dwordx4 v87, s[8:11], s27 offen offset:0 sc1 lds
    buffer_load_dwordx4 v87, s[8:11], s27 offen offset:1024 sc1 lds
    buffer_load_dwordx4 v87, s[8:11], s27 offen offset:2048 sc1 lds
    buffer_load_dwordx4 v87, s[8:11], s27 offen offset:3072 sc1 lds
    s_mov_b32 m0, 143360
    s_nop 0
    buffer_load_dwordx4 v87, s[8:11], s28 offen offset:0 sc1 lds
    buffer_load_dwordx4 v87, s[8:11], s28 offen offset:1024 sc1 lds
    buffer_load_dwordx4 v87, s[8:11], s28 offen offset:2048 sc1 lds
    buffer_load_dwordx4 v87, s[8:11], s28 offen offset:3072 sc1 lds
    s_mov_b32 exec_hi, 0
    s_waitcnt vmcnt(8)
    v_and_b32 v94, 1, v94
    v_cmp_ne_u32 vcc, 0, v94
    s_mov_b32 exec_hi, -1
    s_cbranch_vccnz Lpr_52
    s_nop 2
Lp2_68:
    s_waitcnt vmcnt(0)
    s_branch Ltop0_42
Lfail_48:
    s_cmp_eq_u32 s5, s6
    s_cbranch_scc1 Lqok_50
    s_add_u32 s45, s45, 0x10000
    s_add_u32 s44, s44, 1
    s_cmp_gt_u32 s44, 2000000
    s_cbranch_scc1 Lqok_50
    s_waitcnt lgkmcnt(0)
    s_barrier
    s_sub_u32 s29, s29, 262144
    s_mov_b32 s30, 134217728
    v_mov_b32 v78, s90
    v_cndmask_b32 v76, v89, v78, s[76:77]
    v_cndmask_b32 v77, v78, v89, s[76:77]
    v_lshlrev_b32 v78, 1, v88
    v_add_u32 v78, -145408, v78
    v_lshrrev_b32 v79, 1, v87
    v_mov_b32 v56, v79
    v_add_u32 v79, s88, v79
    s_max_i32 s20, s5, 1
    s_sub_u32 s20, s20, 1
    v_mov_b32 v57, s20
    s_cmp_lg_u32 s3, 0
    s_nop 0
    s_cbranch_scc1 Lf2_69
    v_lshrrev_b32 v95, 2, v87
    s_mov_b32 exec_hi, 0
    buffer_load_dword v94, v95, s[8:11], s43 offen offset:0 sc1
    s_mov_b32 exec_hi, -1
    s_mov_b32 m0, 139264
    s_nop 0
    buffer_load_dwordx4 v87, s[8:11], s27 offen offset:0 sc1 lds
    buffer_load_dwordx4 v87, s[8:11], s27 offen offset:1024 sc1 lds
    buffer_load_dwordx4 v87, s[8:11], s27 offen offset:2048 sc1 lds
    buffer_load_dwordx4 v87, s[8:11], s27 offen offset:3072 sc1 lds
    s_mov_b32 m0, 143360
    s_nop 0
    buffer_load_dwordx4 v87, s[8:11], s28 offen offset:0 sc1 lds
    buffer_load_dwordx4 v87, s[8:11], s28 offen offset:1024 sc1 lds
    buffer_load_dwordx4 v87, s[8:11], s28 offen offset:2048 sc1 lds
    buffer_load_dwordx4 v87, s[8:11], s28 offen offset:3072 sc1 lds
Lf2_69:
    v_mov_b32 v32, 0
    v_mov_b32 v33, 0
    v_mov_b32 v34, 0
    v_mov_b32 v35, 0
    v_mov_b32 v36, 0
    v_mov_b32 v37, 0
    v_mov_b32 v38, 0
    v_mov_b32 v39, 0
    v_mov_b32 v40, 0
    v_mov_b32 v41, 0
    v_mov_b32 v42, 0
    v_mov_b32 v43, 0
    v_mov_b32 v44, 0
    v_mov_b32 v45, 0
    v_mov_b32 v46, 0
    v_mov_b32 v47, 0
    s_waitcnt vmcnt(0)
    s_barrier
    s_branch Lq_49
Lgr_66:
    s_add_u32 s45, s45, 1
    s_cmp_gt_u32 s45, 200000000
    s_cbranch_scc1 Lgo_67
    s_mov_b32 exec_hi, 0
    buffer_load_dword v76, v77, s[8:11], s46 offen sc1
    s_mov_b32 exec_hi, -1
    buffer_load_dwordx4 v[0:3], v87, s[8:11], s85 offen offset:0 sc1
    buffer_load_dwordx4 v[4:7], v87, s[8:11], s85 offen offset:1024 sc1
    buffer_load_dwordx4 v[8:11], v87, s[8:11], s85 offen offset:2048 sc1
    buffer_load_dwordx4 v[12:15], v87, s[8:11], s85 offen offset:3072 sc1
    buffer_load_dwordx4 v[16:19], v87, s[8:11], s86 offen offset:0 sc1
    buffer_load_dwordx4 v[20:23], v87, s[8:11], s86 offen offset:1024 sc1
    buffer_load_dwordx4 v[24:27], v87, s[8:11], s86 offen offset:2048 sc1
    buffer_load_dwordx4 v[28:31], v87, s[8:11], s86 offen offset:3072 sc1
    s_branch Lg0_65
Lpr_62:
    s_add_u32 s45, s45, 0x100
    s_cmp_gt_u32 s45, 200000000
    s_cbranch_scc1 Lp2_70
    v_lshrrev_b32 v95, 2, v87
    s_mov_b32 exec_hi, 0
    buffer_load_dword v94, v95, s[8:11], s43 offen offset:0 sc1
    s_mov_b32 exec_hi, -1
    s_mov_b32 m0, 131072
    s_nop 0
    buffer_load_dwordx4 v87, s[8:11], s27 offen offset:0 sc1 lds
    buffer_load_dwordx4 v87, s[8:11], s27 offen offset:1024 sc1 lds
    buffer_load_dwordx4 v87, s[8:11], s27 offen offset:2048 sc1 lds
    buffer_load_dwordx4 v87, s[8:11], s27 offen offset:3072 sc1 lds
    s_mov_b32 m0, 135168
    s_nop 0
    buffer_load_dwordx4 v87, s[8:11], s28 offen offset:0 sc1 lds
    buffer_load_dwordx4 v87, s[8:11], s28 offen offset:1024 sc1 lds
    buffer_load_dwordx4 v87, s[8:11], s28 offen offset:2048 sc1 lds
    buffer_load_dwordx4 v87, s[8:11], s28 offen offset:3072 sc1 lds
    s_mov_b32 exec_hi, 0
    s_waitcnt vmcnt(8)
    v_and_b32 v94, 1, v94
    v_cmp_ne_u32 vcc, 1, v94
    s_mov_b32 exec_hi, -1
    s_cbranch_vccnz Lpr_62
    s_nop 2
Lp2_70:
    s_waitcnt vmcnt(0)
    s_branch Ltop1_43
Lfail_58:
    s_cmp_eq_u32 s5, s6
    s_cbranch_scc1 Lqok_60
    s_add_u32 s45, s45, 0x10000
    s_add_u32 s44, s44, 1
    s_cmp_gt_u32 s44, 2000000
    s_cbranch_scc1 Lqok_60
    s_waitcnt lgkmcnt(0)
    s_barrier
    s_sub_u32 s29, s29, 262144
    s_mov_b32 s30, 134217728
    v_mov_b32 v78, s90
    v_cndmask_b32 v76, v89, v78, s[76:77]
    v_cndmask_b32 v77, v78, v89, s[76:77]
    v_lshlrev_b32 v78, 1, v88
    v_add_u32 v78, -145408, v78
    v_lshrrev_b32 v79, 1, v87
    v_mov_b32 v56, v79
    v_add_u32 v79, s88, v79
    s_max_i32 s20, s5, 1
    s_sub_u32 s20, s20, 1
    v_mov_b32 v57, s20
    s_cmp_lg_u32 s3, 0
    s_nop 0
    s_cbranch_scc1 Lf2_71
    v_lshrrev_b32 v95, 2, v87
    s_mov_b32 exec_hi, 0
    buffer_load_dword v94, v95, s[8:11], s43 offen offset:0 sc1
    s_mov_b32 exec_hi, -1
    s_mov_b32 m0, 131072
    s_nop 0
    buffer_load_dwordx4 v87, s[8:11], s27 offen offset:0 sc1 lds
    buffer_load_dwordx4 v87, s[8:11], s27 offen offset:1024 sc1 lds
    buffer_load_dwordx4 v87, s[8:11], s27 offen offset:2048 sc1 lds
    buffer_load_dwordx4 v87, s[8:11], s27 offen offset:3072 sc1 lds
    s_mov_b32 m0, 135168
    s_nop 0
    buffer_load_dwordx4 v87, s[8:11], s28 offen offset:0 sc1 lds
    buffer_load_dwordx4 v87, s[8:11], s28 offen offset:1024 sc1 lds
    buffer_load_dwordx4 v87, s[8:11], s28 offen offset:2048 sc1 lds
    buffer_load_dwordx4 v87, s[8:11], s28 offen offset:3072 sc1 lds
Lf2_71:
    v_mov_b32 v32, 0
    v_mov_b32 v33, 0
    v_mov_b32 v34, 0
    v_mov_b32 v35, 0
    v_mov_b32 v36, 0
    v_mov_b32 v37, 0
    v_mov_b32 v38, 0
    v_mov_b32 v39, 0
    v_mov_b32 v40, 0
    v_mov_b32 v41, 0
    v_mov_b32 v42, 0
    v_mov_b32 v43, 0
    v_mov_b32 v44, 0
    v_mov_b32 v45, 0
    v_mov_b32 v46, 0
    v_mov_b32 v47, 0
    s_waitcnt vmcnt(0)
    s_barrier
    s_branch Lq_59
Lfl_53:
Lfw_72:
    buffer_load_dword v85, off, s[8:11], s91 sc1
    s_waitcnt vmcnt(0)
    v_cmp_gt_u32 vcc, 3, v85
    s_add_u32 s45, s45, 1
    s_cmp_gt_u32 s45, 200000000
    s_cbranch_scc1 Lfw2_73
    s_sleep 2
    s_cbranch_vccnz Lfw_72
Lfw2_73:
    s_branch Lflb_54
Lfl_63:
Lfw_74:
    buffer_load_dword v85, off, s[8:11], s91 sc1
    s_waitcnt vmcnt(0)
    v_cmp_gt_u32 vcc, 3, v85
    s_add_u32 s45, s45, 1
    s_cmp_gt_u32 s45, 200000000
    s_cbranch_scc1 Lfw2_75
    s_sleep 2
    s_cbranch_vccnz Lfw_74
Lfw2_75:
    s_branch Lflb_64
Lend_40:
    s_waitcnt lgkmcnt(0)
    v_mov_b32 v82, v48
    v_alignbit_b32 v83, v52, v52, 16
    s_nop 1
Lstop_41:
    s_waitcnt lgkmcnt(0)
    v_lshrrev_b32 v95, 1, v87
    s_add_u32 s23, s30, 66977792
    buffer_store_dwordx4 v[72:75], v87, s[8:11], s23 offen sc1
    s_lshr_b32 s23, s30, 1
    s_add_u32 s23, s23, 75431936
    buffer_store_dwordx2 v[82:83], v95, s[8:11], s23 offen sc1
    s_branch Lm_exit
Lm_s2:
    s_sub_u32 s7, s93, 1
    s_add_u32 s6, s7, 0
    v_mov_b32 v4, -1
    v_mov_b32 v5, -1
    v_mov_b32 v6, -1
    v_mov_b32 v7, -1
    v_lshlrev_b32 v8, 4, v0
    v_and_b32 v9, 0x7f0, v8
    s_nop 1
L2z_76:
    s_lshl_b32 s20, s6, 5
    s_add_u32 s20, s20, s4
    s_lshl_b32 s21, s20, 12
    s_add_u32 s21, s21, 67108864
    s_lshl_b32 s20, s20, 11
    s_add_u32 s20, s20, 75497472
    buffer_store_dwordx4 v[4:7], v8, s[8:11], s21 offen sc1
    s_cmp_ge_u32 s3, 2
    s_cbranch_scc1 L2zs_77
    buffer_store_dwordx4 v[4:7], v9, s[8:11], s20 offen sc1
    s_nop 1
L2zs_77:
    s_add_u32 s6, s6, 2
    s_cmp_lt_u32 s6, 8
    s_cbranch_scc1 L2z_76
    s_load_dwordx2 s[60:61], s[0:1], 40
    s_load_dwordx2 s[62:63], s[0:1], 0
    s_load_dwordx2 s[64:65], s[0:1], 88
    v_and_b32 v1, 63, v0
    v_and_b32 v2, 15, v1
    v_lshrrev_b32 v3, 4, v1
    v_lshlrev_b32 v128, 4, v1
    v_lshlrev_b32 v129, 3, v1
    s_and_b32 s54, s3, 1
    s_lshr_b32 s55, s3, 1
    s_mov_b32 s48, 0x3e0293ee
    s_mov_b32 s51, 0
    v_mov_b32 v146, 0xff800000
    v_mov_b32 v147, 0
    s_lshl_b32 s20, s54, 4
    v_add_u32 v4, s20, v2
    v_lshlrev_b32 v5, 2, v3
    v_add_u32 v6, 0, v5
    v_cmp_gt_u32 s[32:33], v6, v4
    v_add_u32 v6, 1, v5
    v_cmp_gt_u32 s[34:35], v6, v4
    v_add_u32 v6, 2, v5
    v_cmp_gt_u32 s[36:37], v6, v4
    v_add_u32 v6, 3, v5
    v_cmp_gt_u32 s[38:39], v6, v4
    v_add_u32 v6, 16, v5
    v_cmp_gt_u32 s[40:41], v6, v4
    v_add_u32 v6, 17, v5
    v_cmp_gt_u32 s[42:43], v6, v4
    v_add_u32 v6, 18, v5
    v_cmp_gt_u32 s[44:45], v6, v4
    v_add_u32 v6, 19, v5
    v_cmp_gt_u32 s[46:47], v6, v4
    s_lshl_b32 s20, s54, 2
    s_lshl_b32 s21, s55, 1
    s_add_u32 s20, s20, s21
    s_lshl_b32 s20, s20, 10
    s_add_u32 s20, s20, 131072
    v_add_u32 v130, s20, v128
    v_lshlrev_b32 v4, 10, v3
    v_lshl_add_u32 v4, v2, 4, v4
    s_lshl_b32 s20, s3, 8
    v_add_u32 v131, s20, v4
    v_bfe_u32 v4, v2, 2, 1
    v_and_b32 v5, 3, v2
    s_lshl_b32 s20, s3, 2
    v_add_u32 v5, s20, v5
    v_lshl_add_u32 v6, v3, 4, v5
    v_lshlrev_b32 v6, 4, v6
    v_lshl_add_u32 v132, v4, 10, v6
    v_lshl_add_u32 v6, v4, 4, v5
    v_lshlrev_b32 v6, 10, v6
    v_lshl_add_u32 v6, v3, 3, v6
    s_lshl_b32 s20, s4, 5
    v_add_u32 v133, s20, v6
    v_and_b32 v4, 1, v2
    v_lshlrev_b32 v4, 4, v4
    v_mov_b32 v5, 0x3f80
    v_lshlrev_b32 v4, v4, v5
    v_bfe_u32 v5, v2, 1, 2
    v_cmp_eq_u32 vcc, 0, v5
    s_nop 1
    v_cndmask_b32 v136, 0, v4, vcc
    v_cmp_eq_u32 vcc, 1, v5
    s_nop 1
    v_cndmask_b32 v137, 0, v4, vcc
    v_cmp_eq_u32 vcc, 2, v5
    s_nop 1
    v_cndmask_b32 v138, 0, v4, vcc
    v_cmp_eq_u32 vcc, 3, v5
    s_nop 1
    v_cndmask_b32 v139, 0, v4, vcc
    s_waitcnt lgkmcnt(0)
    s_mov_b32 s12, s60
    s_and_b32 s13, s61, 0xffff
    s_mov_b32 s14, 4194304
    s_mov_b32 s15, 0x20000
    s_mov_b32 s24, s62
    s_and_b32 s25, s63, 0xffff
    s_mov_b32 s26, 2097152
    s_mov_b32 s27, 0x20000
    s_mov_b32 s28, s64
    s_and_b32 s29, s65, 0xffff
    s_mov_b32 s30, 2097152
    s_mov_b32 s31, 0x20000
    s_lshl_b32 s50, s7, 21
    s_add_u32 s50, s50, 121634816
    v_mov_b32 v4, -1
    v_mov_b32 v5, -1
    v_mov_b32 v6, -1
    v_mov_b32 v7, -1
    v_lshlrev_b32 v8, 4, v0
    s_lshl_b32 s20, s4, 15
    s_add_u32 s20, s20, s50
    s_add_u32 s21, s20, 0
    buffer_store_dwordx4 v[4:7], v8, s[8:11], s21 offen sc1
    s_add_u32 s21, s20, 4096
    buffer_store_dwordx4 v[4:7], v8, s[8:11], s21 offen sc1
    s_add_u32 s21, s20, 8192
    buffer_store_dwordx4 v[4:7], v8, s[8:11], s21 offen sc1
    s_add_u32 s21, s20, 12288
    buffer_store_dwordx4 v[4:7], v8, s[8:11], s21 offen sc1
    s_add_u32 s21, s20, 16384
    buffer_store_dwordx4 v[4:7], v8, s[8:11], s21 offen sc1
    s_add_u32 s21, s20, 20480
    buffer_store_dwordx4 v[4:7], v8, s[8:11], s21 offen sc1
    s_add_u32 s21, s20, 24576
    buffer_store_dwordx4 v[4:7], v8, s[8:11], s21 offen sc1
    s_add_u32 s21, s20, 28672
    buffer_store_dwordx4 v[4:7], v8, s[8:11], s21 offen sc1
    s_add_u32 s21, s20, 1048576
    buffer_store_dwordx4 v[4:7], v8, s[8:11], s21 offen sc1
    s_add_u32 s21, s20, 1052672
    buffer_store_dwordx4 v[4:7], v8, s[8:11], s21 offen sc1
    s_add_u32 s21, s20, 1056768
    buffer_store_dwordx4 v[4:7], v8, s[8:11], s21 offen sc1
    s_add_u32 s21, s20, 1060864
    buffer_store_dwordx4 v[4:7], v8, s[8:11], s21 offen sc1
    s_add_u32 s21, s20, 1064960
    buffer_store_dwordx4 v[4:7], v8, s[8:11], s21 offen sc1
    s_add_u32 s21, s20, 1069056
    buffer_store_dwordx4 v[4:7], v8, s[8:11], s21 offen sc1
    s_add_u32 s21, s20, 1073152
    buffer_store_dwordx4 v[4:7], v8, s[8:11], s21 offen sc1
    s_add_u32 s21, s20, 1077248
    buffer_store_dwordx4 v[4:7], v8, s[8:11], s21 offen sc1
    v_lshlrev_b32 v9, 1, v3
    v_xor_b32 v9, v9, v2
    v_lshlrev_b32 v9, 4, v9
    v_lshl_add_u32 v9, v3, 10, v9
    s_lshl_b32 s20, s3, 8
    v_add_u32 v9, s20, v9
    v_xor_b32 v10, 128, v9
    s_lshl_b32 s22, s3, 15
    s_lshl_b32 s23, s4, 17
    s_add_u32 m0, s22, 0
    s_add_u32 s20, s23, 0
    buffer_load_dwordx4 v9, s[12:15], s20 offen lds
    s_add_u32 m0, s22, 1024
    s_add_u32 s20, s23, 4096
    buffer_load_dwordx4 v10, s[12:15], s20 offen lds
    s_add_u32 m0, s22, 2048
    s_add_u32 s20, s23, 8192
    buffer_load_dwordx4 v9, s[12:15], s20 offen lds
    s_add_u32 m0, s22, 3072
    s_add_u32 s20, s23, 12288
    buffer_load_dwordx4 v10, s[12:15], s20 offen lds
    s_add_u32 m0, s22, 4096
    s_add_u32 s20, s23, 16384
    buffer_load_dwordx4 v9, s[12:15], s20 offen lds
    s_add_u32 m0, s22, 5120
    s_add_u32 s20, s23, 20480
    buffer_load_dwordx4 v10, s[12:15], s20 offen lds
    s_add_u32 m0, s22, 6144
    s_add_u32 s20, s23, 24576
    buffer_load_dwordx4 v9, s[12:15], s20 offen lds
    s_add_u32 m0, s22, 7168
    s_add_u32 s20, s23, 28672
    buffer_load_dwordx4 v10, s[12:15], s20 offen lds
    s_add_u32 m0, s22, 8192
    s_add_u32 s20, s23, 32768
    buffer_load_dwordx4 v9, s[12:15], s20 offen lds
    s_add_u32 m0, s22, 9216
    s_add_u32 s20, s23, 36864
    buffer_load_dwordx4 v10, s[12:15], s20 offen lds
    s_add_u32 m0, s22, 10240
    s_add_u32 s20, s23, 40960
    buffer_load_dwordx4 v9, s[12:15], s20 offen lds
    s_add_u32 m0, s22, 11264
    s_add_u32 s20, s23, 45056
    buffer_load_dwordx4 v10, s[12:15], s20 offen lds
    s_add_u32 m0, s22, 12288
    s_add_u32 s20, s23, 49152
    buffer_load_dwordx4 v9, s[12:15], s20 offen lds
    s_add_u32 m0, s22, 13312
    s_add_u32 s20, s23, 53248
    buffer_load_dwordx4 v10, s[12:15], s20 offen lds
    s_add_u32 m0, s22, 14336
    s_add_u32 s20, s23, 57344
    buffer_load_dwordx4 v9, s[12:15], s20 offen lds
    s_add_u32 m0, s22, 15360
    s_add_u32 s20, s23, 61440
    buffer_load_dwordx4 v10, s[12:15], s20 offen lds
    s_add_u32 m0, s22, 16384
    s_add_u32 s20, s23, 65536
    buffer_load_dwordx4 v9, s[12:15], s20 offen lds
    s_add_u32 m0, s22, 17408
    s_add_u32 s20, s23, 69632
    buffer_load_dwordx4 v10, s[12:15], s20 offen lds
    s_add_u32 m0, s22, 18432
    s_add_u32 s20, s23, 73728
    buffer_load_dwordx4 v9, s[12:15], s20 offen lds
    s_add_u32 m0, s22, 19456
    s_add_u32 s20, s23, 77824
    buffer_load_dwordx4 v10, s[12:15], s20 offen lds
    s_add_u32 m0, s22, 20480
    s_add_u32 s20, s23, 81920
    buffer_load_dwordx4 v9, s[12:15], s20 offen lds
    s_add_u32 m0, s22, 21504
    s_add_u32 s20, s23, 86016
    buffer_load_dwordx4 v10, s[12:15], s20 offen lds
    s_add_u32 m0, s22, 22528
    s_add_u32 s20, s23, 90112
    buffer_load_dwordx4 v9, s[12:15], s20 offen lds
    s_add_u32 m0, s22, 23552
    s_add_u32 s20, s23, 94208
    buffer_load_dwordx4 v10, s[12:15], s20 offen lds
    s_add_u32 m0, s22, 24576
    s_add_u32 s20, s23, 98304
    buffer_load_dwordx4 v9, s[12:15], s20 offen lds
    s_add_u32 m0, s22, 25600
    s_add_u32 s20, s23, 102400
    buffer_load_dwordx4 v10, s[12:15], s20 offen lds
    s_add_u32 m0, s22, 26624
    s_add_u32 s20, s23, 106496
    buffer_load_dwordx4 v9, s[12:15], s20 offen lds
    s_add_u32 m0, s22, 27648
    s_add_u32 s20, s23, 110592
    buffer_load_dwordx4 v10, s[12:15], s20 offen lds
    s_add_u32 m0, s22, 28672
    s_add_u32 s20, s23, 114688
    buffer_load_dwordx4 v9, s[12:15], s20 offen lds
    s_add_u32 m0, s22, 29696
    s_add_u32 s20, s23, 118784
    buffer_load_dwordx4 v10, s[12:15], s20 offen lds
    s_add_u32 m0, s22, 30720
    s_add_u32 s20, s23, 122880
    buffer_load_dwordx4 v9, s[12:15], s20 offen lds
    s_add_u32 m0, s22, 31744
    s_add_u32 s20, s23, 126976
    buffer_load_dwordx4 v10, s[12:15], s20 offen lds
    v_bfe_u32 v11, v1, 2, 2
    v_lshl_add_u32 v12, v3, 2, v11
    v_lshlrev_b32 v12, 8, v12
    v_and_b32 v13, 3, v1
    v_lshl_add_u32 v12, v13, 3, v12
    v_and_b32 v13, 1, v3
    v_lshl_add_u32 v11, v13, 2, v11
    v_lshl_add_u32 v12, v11, 5, v12
    v_add_u32 v12, s22, v12
    s_waitcnt vmcnt(0)
    v_xor_b32 v13, 0, v12
    ds_read_b64_tr_b16 a[0:1], v13 offset:0
    ds_read_b64_tr_b16 a[2:3], v13 offset:4096
    ds_read_b64_tr_b16 a[4:5], v13 offset:8192
    ds_read_b64_tr_b16 a[6:7], v13 offset:12288
    ds_read_b64_tr_b16 a[8:9], v13 offset:16384
    ds_read_b64_tr_b16 a[10:11], v13 offset:20480
    ds_read_b64_tr_b16 a[12:13], v13 offset:24576
    ds_read_b64_tr_b16 a[14:15], v13 offset:28672
    v_xor_b32 v13, 32, v12
    ds_read_b64_tr_b16 a[16:17], v13 offset:0
    ds_read_b64_tr_b16 a[18:19], v13 offset:4096
    ds_read_b64_tr_b16 a[20:21], v13 offset:8192
    ds_read_b64_tr_b16 a[22:23], v13 offset:12288
    ds_read_b64_tr_b16 a[24:25], v13 offset:16384
    ds_read_b64_tr_b16 a[26:27], v13 offset:20480
    ds_read_b64_tr_b16 a[28:29], v13 offset:24576
    ds_read_b64_tr_b16 a[30:31], v13 offset:28672
    v_xor_b32 v13, 64, v12
    ds_read_b64_tr_b16 a[32:33], v13 offset:0
    ds_read_b64_tr_b16 a[34:35], v13 offset:4096
    ds_read_b64_tr_b16 a[36:37], v13 offset:8192
    ds_read_b64_tr_b16 a[38:39], v13 offset:12288
    ds_read_b64_tr_b16 a[40:41], v13 offset:16384
    ds_read_b64_tr_b16 a[42:43], v13 offset:20480
    ds_read_b64_tr_b16 a[44:45], v13 offset:24576
    ds_read_b64_tr_b16 a[46:47], v13 offset:28672
    v_xor_b32 v13, 96, v12
    ds_read_b64_tr_b16 a[48:49], v13 offset:0
    ds_read_b64_tr_b16 a[50:51], v13 offset:4096
    ds_read_b64_tr_b16 a[52:53], v13 offset:8192
    ds_read_b64_tr_b16 a[54:55], v13 offset:12288
    ds_read_b64_tr_b16 a[56:57], v13 offset:16384
    ds_read_b64_tr_b16 a[58:59], v13 offset:20480
    ds_read_b64_tr_b16 a[60:61], v13 offset:24576
    ds_read_b64_tr_b16 a[62:63], v13 offset:28672
    v_xor_b32 v13, 128, v12
    ds_read_b64_tr_b16 a[64:65], v13 offset:0
    ds_read_b64_tr_b16 a[66:67], v13 offset:4096
    ds_read_b64_tr_b16 a[68:69], v13 offset:8192
    ds_read_b64_tr_b16 a[70:71], v13 offset:12288
    ds_read_b64_tr_b16 a[72:73], v13 offset:16384
    ds_read_b64_tr_b16 a[74:75], v13 offset:20480
    ds_read_b64_tr_b16 a[76:77], v13 offset:24576
    ds_read_b64_tr_b16 a[78:79], v13 offset:28672
    v_xor_b32 v13, 160, v12
    ds_read_b64_tr_b16 a[80:81], v13 offset:0
    ds_read_b64_tr_b16 a[82:83], v13 offset:4096
    ds_read_b64_tr_b16 a[84:85], v13 offset:8192
    ds_read_b64_tr_b16 a[86:87], v13 offset:12288
    ds_read_b64_tr_b16 a[88:89], v13 offset:16384
    ds_read_b64_tr_b16 a[90:91], v13 offset:20480
    ds_read_b64_tr_b16 a[92:93], v13 offset:24576
    ds_read_b64_tr_b16 a[94:95], v13 offset:28672
    v_xor_b32 v13, 192, v12
    ds_read_b64_tr_b16 a[96:97], v13 offset:0
    ds_read_b64_tr_b16 a[98:99], v13 offset:4096
    ds_read_b64_tr_b16 a[100:101], v13 offset:8192
    ds_read_b64_tr_b16 a[102:103], v13 offset:12288
    ds_read_b64_tr_b16 a[104:105], v13 offset:16384
    ds_read_b64_tr_b16 a[106:107], v13 offset:20480
    ds_read_b64_tr_b16 a[108:109], v13 offset:24576
    ds_read_b64_tr_b16 a[110:111], v13 offset:28672
    v_xor_b32 v13, 224, v12
    ds_read_b64_tr_b16 a[112:113], v13 offset:0
    ds_read_b64_tr_b16 a[114:115], v13 offset:4096
    ds_read_b64_tr_b16 a[116:117], v13 offset:8192
    ds_read_b64_tr_b16 a[118:119], v13 offset:12288
    ds_read_b64_tr_b16 a[120:121], v13 offset:16384
    ds_read_b64_tr_b16 a[122:123], v13 offset:20480
    ds_read_b64_tr_b16 a[124:125], v13 offset:24576
    ds_read_b64_tr_b16 a[126:127], v13 offset:28672
    s_waitcnt lgkmcnt(0)
    s_waitcnt vmcnt(0) lgkmcnt(0)
    s_barrier
    s_lshl_b32 s96, s93, 3
    s_add_u32 s96, s96, 64
    s_cmp_lg_u32 s3, 0
    s_cbranch_scc1 Lta_78
    s_and_b32 s97, s101, 7
    s_mul_i32 s97, s97, 6
    s_lshl_b64 s[94:95], 1, s97
    s_or_b32 s95, s95, 0x1000000
    v_mov_b32 v30, s94
    v_mov_b32 v31, s95
    s_mov_b64 exec, 1
    buffer_atomic_add_x2 v[30:31], off, s[16:19], s96
    s_mov_b64 exec, -1
Lta_78:
    v_mbcnt_lo_u32_b32 v1, -1, 0
    v_and_b32 v1, 15, v1
    v_lshlrev_b32 v1, 2, v1
    s_mov_b32 s97, 0
    s_nop 0
Ltw_79_1:
    buffer_load_dwordx2 v[2:3], off, s[16:19], s96 sc1
    buffer_load_dword v4, v1, s[16:19], 0 offen offset:128 sc1
    s_waitcnt vmcnt(0)
    v_lshlrev_b32 v4, 1, v4
    v_lshrrev_b32 v5, 24, v3
    v_min_u32 v4, v4, v5
    v_cmp_gt_u32 vcc, 32, v4
    s_add_u32 s97, s97, 1
    s_cmp_gt_u32 s97, 30000000
    s_cbranch_scc1 Ltw_79_3
    s_cbranch_vccz Ltw_79_3
    s_sleep 24
    s_branch Ltw_79_1
Ltw_79_3:
    v_readfirstlane_b32 s94, v2
    v_readfirstlane_b32 s95, v3
    s_and_b32 s97, s101, 7
    s_mul_i32 s97, s97, 6
    s_lshr_b64 s[94:95], s[94:95], s97
    s_and_b32 s93, s94, 63
    s_waitcnt vmcnt(0)
    s_barrier
    s_cmp_lg_u32 s3, 0
    s_cbranch_scc1 L2ze_80
    v_lshlrev_b32 v9, 7, v0
    v_mov_b32 v4, 1
    s_lshl_b32 s20, s4, 2
    s_add_u32 s20, s20, 131072000
    s_mov_b64 exec, 3
    buffer_atomic_add v4, v9, s[8:11], s20 offen
    s_mov_b64 exec, -1
L2ze_80:
    s_add_u32 s6, s7, 8
    v_mov_b32 v4, -1
    v_mov_b32 v5, -1
    v_mov_b32 v6, -1
    v_mov_b32 v7, -1
    v_lshlrev_b32 v8, 4, v0
    v_and_b32 v9, 0x7f0, v8
    s_nop 1
L2z_81:
    s_lshl_b32 s20, s6, 5
    s_add_u32 s20, s20, s4
    s_lshl_b32 s21, s20, 12
    s_add_u32 s21, s21, 67108864
    s_lshl_b32 s20, s20, 11
    s_add_u32 s20, s20, 75497472
    buffer_store_dwordx4 v[4:7], v8, s[8:11], s21 offen sc1
    s_cmp_ge_u32 s3, 2
    s_cbranch_scc1 L2zs_82
    buffer_store_dwordx4 v[4:7], v9, s[8:11], s20 offen sc1
    s_nop 1
L2zs_82:
    s_add_u32 s6, s6, 2
    s_cmp_lt_u32 s6, 64
    s_cbranch_scc1 L2z_81
    s_waitcnt vmcnt(0)
    s_barrier
    s_cmp_lg_u32 s3, 0
    s_cbranch_scc1 L2ze_83
    v_lshlrev_b32 v9, 7, v0
    v_mov_b32 v4, 1
    s_lshl_b32 s20, s4, 2
    s_add_u32 s20, s20, 131072256
    s_mov_b64 exec, 16383
    buffer_atomic_add v4, v9, s[8:11], s20 offen
    s_mov_b64 exec, -1
L2ze_83:
    s_cmp_lg_u32 s93, 32
    s_cbranch_scc1 Lm_s2s
    s_mov_b32 s5, 0
    s_mov_b32 s6, s7
L2slow_86:
    s_lshr_b32 s20, s6, 2
    s_lshl_b32 s68, s20, 7
    s_add_u32 s68, s68, 131076096
    s_lshl_b32 s20, s20, 5
    s_add_u32 s20, s20, s4
    s_lshl_b32 s20, s20, 2
    s_add_u32 s67, s20, 131074048
Lpl_90:
    buffer_load_dword v144, off, s[8:11], s67 sc1
    s_waitcnt vmcnt(0)
    v_readfirstlane_b32 s59, v144
    s_nop 0
    s_cmp_ge_u32 s59, 1
    s_cbranch_scc1 Lpd_91
    s_add_u32 s51, s51, 1
    s_cmp_gt_u32 s51, 100000000
    s_cbranch_scc1 Lpd_91
    s_sleep 2
    s_branch Lpl_90
Lpd_91:
Lpl_92:
    buffer_load_dword v144, off, s[8:11], s68 sc1
    s_waitcnt vmcnt(0)
    v_readfirstlane_b32 s59, v144
    s_nop 0
    s_cmp_ge_u32 s59, 7
    s_cbranch_scc1 Lpd_93
    s_add_u32 s51, s51, 1
    s_cmp_gt_u32 s51, 100000000
    s_cbranch_scc1 Lpd_93
    s_sleep 2
    s_branch Lpl_92
Lpd_93:
    s_lshl_b32 s20, s6, 5
    s_add_u32 s20, s20, s4
    s_lshl_b32 s58, s20, 13
    s_lshl_b32 s21, s54, 10
    s_add_u32 s21, s21, s58
    s_add_u32 s21, s21, 16777216
    s_add_u32 s23, s21, 4096
    buffer_load_dwordx4 v[160:163], v128, s[8:11], s21 offen offset:0 sc1
    buffer_load_dwordx4 v[164:167], v128, s[8:11], s21 offen offset:2048 sc1
    buffer_load_dwordx4 v[168:171], v128, s[8:11], s23 offen offset:0 sc1
    buffer_load_dwordx4 v[172:175], v128, s[8:11], s23 offen offset:2048 sc1
    s_add_u32 s21, s58, 33554432
    s_add_u32 s23, s21, 4096
    buffer_load_dwordx4 v[176:179], v128, s[8:11], s21 offen offset:0 sc1
    buffer_load_dwordx4 v[192:195], v128, s[8:11], s21 offen offset:1024 sc1
    buffer_load_dwordx4 v[180:183], v128, s[8:11], s21 offen offset:2048 sc1
    buffer_load_dwordx4 v[196:199], v128, s[8:11], s21 offen offset:3072 sc1
    buffer_load_dwordx4 v[184:187], v128, s[8:11], s23 offen offset:0 sc1
    buffer_load_dwordx4 v[200:203], v128, s[8:11], s23 offen offset:1024 sc1
    buffer_load_dwordx4 v[188:191], v128, s[8:11], s23 offen offset:2048 sc1
    buffer_load_dwordx4 v[204:207], v128, s[8:11], s23 offen offset:3072 sc1
    s_lshl_b32 s21, s55, 12
    s_add_u32 s21, s21, s58
    s_add_u32 s21, s21, 50331648
    buffer_load_dwordx4 v[208:211], v128, s[8:11], s21 offen offset:0 sc1
    buffer_load_dwordx4 v[212:215], v128, s[8:11], s21 offen offset:1024 sc1
    buffer_load_dwordx4 v[216:219], v128, s[8:11], s21 offen offset:2048 sc1
    buffer_load_dwordx4 v[220:223], v128, s[8:11], s21 offen offset:3072 sc1
    s_lshr_b32 s23, s58, 1
    s_add_u32 s23, s23, 67108864
    buffer_load_dwordx4 v[224:227], v128, s[8:11], s23 offen offset:0 sc1
    buffer_load_dwordx4 v[228:231], v128, s[8:11], s23 offen offset:1024 sc1
    buffer_load_dwordx4 v[232:235], v128, s[8:11], s23 offen offset:2048 sc1
    buffer_load_dwordx4 v[236:239], v128, s[8:11], s23 offen offset:3072 sc1
    s_lshr_b32 s21, s58, 2
    s_lshl_b32 s23, s55, 10
    s_add_u32 s21, s21, s23
    s_add_u32 s21, s21, 75497472
    buffer_load_dwordx2 v[240:241], v129, s[8:11], s21 offen sc1
    buffer_load_dwordx2 v[242:243], v129, s[8:11], s21 offen offset:512 sc1
L2top_84:
    s_lshr_b32 s53, s58, 1
    s_lshr_b32 s49, s5, 1
    s_and_b32 s49, s49, 1
    s_and_b32 s20, s5, 1
    s_lshl_b32 s57, s20, 13
    s_lshl_b32 s20, s20, 20
    s_add_u32 s56, s20, s50
    s_add_u32 s66, s6, 2
    s_min_u32 s70, s66, 63
    s_lshr_b32 s20, s70, 2
    s_lshl_b32 s68, s20, 7
    s_add_u32 s68, s68, 131076096
    s_lshl_b32 s20, s20, 5
    s_add_u32 s20, s20, s4
    s_lshl_b32 s20, s20, 2
    s_add_u32 s67, s20, 131074048
    s_lshr_b32 s21, s53, 1
    s_add_u32 s21, s21, 83886080
    s_lshl_b32 s22, s6, 15
    buffer_load_dwordx4 v[0:3], v132, s[8:11], s21 offen sc1
    s_add_u32 s21, s21, 4194304
    buffer_load_dwordx4 v[4:7], v132, s[8:11], s21 offen sc1
    s_add_u32 s21, s21, 4194304
    buffer_load_dwordx4 v[8:11], v132, s[8:11], s21 offen sc1
    s_add_u32 s21, s21, 4194304
    buffer_load_dwordx4 v[12:15], v132, s[8:11], s21 offen sc1
    s_add_u32 s21, s21, 4194304
    buffer_load_dwordx4 v[16:19], v132, s[8:11], s21 offen sc1
    s_add_u32 s21, s21, 4194304
    buffer_load_dwordx4 v[20:23], v132, s[8:11], s21 offen sc1
    s_add_u32 s21, s21, 4194304
    buffer_load_dwordx4 v[24:27], v132, s[8:11], s21 offen sc1
    buffer_load_dwordx2 v[28:29], v133, s[24:27], s22 offen
L2mc_88:
    s_waitcnt vmcnt(0)
    v_max3_u32 v144, v224, v225, v226
    v_max3_u32 v144, v144, v227, v228
    v_max3_u32 v144, v144, v229, v230
    v_max3_u32 v144, v144, v231, v232
    v_max3_u32 v144, v144, v233, v234
    v_max3_u32 v144, v144, v235, v236
    v_max3_u32 v144, v144, v237, v238
    v_max3_u32 v144, v144, v239, v240
    v_max3_u32 v144, v144, v241, v242
    v_max_u32 v144, v144, v243
    v_cmp_eq_u32 vcc, -1, v144
    s_cbranch_vccnz L2mr_87
L2mo_89:
    buffer_load_dword v148, off, s[8:11], s67 sc1
    buffer_load_dword v149, off, s[8:11], s68 sc1
    s_cmp_eq_u32 s5, 0
    s_cbranch_scc1 L2ng_94
    s_lshl_b32 s71, s76, 15
    s_add_u32 s72, s73, 0
    buffer_load_dwordx4 v[32:35], v131, s[8:11], s72 offen sc1
    s_add_u32 s72, s73, 4096
    buffer_load_dwordx4 v[36:39], v131, s[8:11], s72 offen sc1
    s_add_u32 s72, s73, 8192
    buffer_load_dwordx4 v[40:43], v131, s[8:11], s72 offen sc1
    s_add_u32 s72, s73, 12288
    buffer_load_dwordx4 v[44:47], v131, s[8:11], s72 offen sc1
    s_add_u32 s72, s73, 16384
    buffer_load_dwordx4 v[48:51], v131, s[8:11], s72 offen sc1
    s_add_u32 s72, s73, 20480
    buffer_load_dwordx4 v[52:55], v131, s[8:11], s72 offen sc1
    s_add_u32 s72, s73, 24576
    buffer_load_dwordx4 v[56:59], v131, s[8:11], s72 offen sc1
    s_add_u32 s72, s73, 28672
    buffer_load_dwordx4 v[60:63], v131, s[8:11], s72 offen sc1
L2ng_94:
    v_mfma_f32_16x16x32_bf16 v[92:95], v[176:179], v[160:163], 0
    v_mfma_f32_16x16x32_bf16 v[96:99], v[192:195], v[160:163], 0
    v_mfma_f32_16x16x32_bf16 v[100:103], v[224:227], v[160:163], 0
    v_mfma_f32_16x16x32_bf16 v[92:95], v[180:183], v[164:167], v[92:95]
    v_mfma_f32_16x16x32_bf16 v[96:99], v[196:199], v[164:167], v[96:99]
    v_mfma_f32_16x16x32_bf16 v[100:103], v[228:231], v[164:167], v[100:103]
    v_mfma_f32_16x16x32_bf16 v[92:95], v[184:187], v[168:171], v[92:95]
    v_mfma_f32_16x16x32_bf16 v[96:99], v[200:203], v[168:171], v[96:99]
    v_mfma_f32_16x16x32_bf16 v[100:103], v[232:235], v[168:171], v[100:103]
    v_mfma_f32_16x16x32_bf16 v[92:95], v[188:191], v[172:175], v[92:95]
    v_mfma_f32_16x16x32_bf16 v[96:99], v[204:207], v[172:175], v[96:99]
    v_mfma_f32_16x16x32_bf16 v[100:103], v[236:239], v[172:175], v[100:103]
    v_cndmask_b32 v92, v92, v146, s[32:33]
    v_cndmask_b32 v93, v93, v146, s[34:35]
    v_cndmask_b32 v94, v94, v146, s[36:37]
    v_cndmask_b32 v95, v95, v146, s[38:39]
    v_cndmask_b32 v96, v96, v146, s[40:41]
    v_cndmask_b32 v97, v97, v146, s[42:43]
    v_cndmask_b32 v98, v98, v146, s[44:45]
    v_cndmask_b32 v99, v99, v146, s[46:47]
    v_max3_f32 v144, v92, v93, v94
    v_max3_f32 v145, v95, v96, v97
    v_max3_f32 v144, v144, v98, v99
    v_max3_f32 v145, v145, v100, v101
    v_max_f32 v144, v144, v145
    v_mov_b32 v145, v144
    s_nop 1
    v_permlane32_swap_b32 v144, v145
    v_max_f32 v144, v144, v145
    v_mov_b32 v145, v144
    s_nop 1
    v_permlane16_swap_b32 v144, v145
    v_max_f32 v144, v144, v145
    v_mul_f32 v144, s48, v144
    v_fma_f32 v92, v92, s48, -v144
    v_fma_f32 v93, v93, s48, -v144
    v_fma_f32 v94, v94, s48, -v144
    v_fma_f32 v95, v95, s48, -v144
    v_fma_f32 v96, v96, s48, -v144
    v_fma_f32 v97, v97, s48, -v144
    v_fma_f32 v98, v98, s48, -v144
    v_fma_f32 v99, v99, s48, -v144
    v_fma_f32 v100, v100, s48, -v144
    v_fma_f32 v101, v101, s48, -v144
    v_exp_f32 v92, v92
    v_exp_f32 v93, v93
    v_exp_f32 v94, v94
    v_exp_f32 v95, v95
    v_exp_f32 v96, v96
    v_exp_f32 v97, v97
    v_exp_f32 v98, v98
    v_exp_f32 v99, v99
    v_exp_f32 v100, v100
    v_exp_f32 v101, v101
    v_cvt_pk_bf16_f32 v104, v92, v93
    v_cvt_pk_bf16_f32 v105, v94, v95
    v_cvt_pk_bf16_f32 v106, v96, v97
    v_cvt_pk_bf16_f32 v107, v98, v99
    v_cvt_pk_bf16_f32 v108, v100, v101
    v_mov_b32 v109, 0
    v_mov_b32 v84, v240
    v_mov_b32 v85, 0
    v_mov_b32 v86, v241
    v_mov_b32 v87, 0
    v_mov_b32 v88, v242
    v_mov_b32 v89, 0
    v_mov_b32 v90, v243
    v_mov_b32 v91, 0
    v_mfma_f32_16x16x32_bf16 v[112:115], v[208:211], v[104:107], 0
    v_mfma_f32_16x16x32_bf16 v[116:119], v[212:215], v[104:107], 0
    v_mfma_f32_16x16x32_bf16 v[120:123], v[216:219], v[104:107], 0
    v_mfma_f32_16x16x32_bf16 v[124:127], v[220:223], v[104:107], 0
    v_mfma_f32_16x16x16_bf16 v[112:115], v[84:85], v[108:109], v[112:115]
    v_mfma_f32_16x16x16_bf16 v[116:119], v[86:87], v[108:109], v[116:119]
    v_mfma_f32_16x16x16_bf16 v[120:123], v[88:89], v[108:109], v[120:123]
    v_mfma_f32_16x16x16_bf16 v[124:127], v[90:91], v[108:109], v[124:127]
    v_add_f32 v144, v92, v93
    v_add_f32 v144, v144, v94
    v_add_f32 v144, v144, v95
    v_add_f32 v144, v144, v96
    v_add_f32 v144, v144, v97
    v_add_f32 v144, v144, v98
    v_add_f32 v144, v144, v99
    v_add_f32 v144, v144, v100
    v_add_f32 v144, v144, v101
    v_mov_b32 v145, v144
    s_nop 1
    v_permlane32_swap_b32 v144, v145
    v_add_f32 v144, v144, v145
    v_mov_b32 v145, v144
    s_nop 1
    v_permlane16_swap_b32 v144, v145
    v_add_f32 v144, v144, v145
    v_rcp_f32 v144, v144
    v_add_u32 v145, s57, v130
    v_mul_f32 v112, v112, v144
    v_mul_f32 v113, v113, v144
    v_mul_f32 v114, v114, v144
    v_mul_f32 v115, v115, v144
    v_mul_f32 v116, v116, v144
    v_mul_f32 v117, v117, v144
    v_mul_f32 v118, v118, v144
    v_mul_f32 v119, v119, v144
    v_mul_f32 v120, v120, v144
    v_mul_f32 v121, v121, v144
    v_mul_f32 v122, v122, v144
    v_mul_f32 v123, v123, v144
    v_mul_f32 v124, v124, v144
    v_mul_f32 v125, v125, v144
    v_mul_f32 v126, v126, v144
    v_mul_f32 v127, v127, v144
    v_cvt_pk_bf16_f32 v92, v112, v113
    v_cvt_pk_bf16_f32 v93, v114, v115
    v_cvt_pk_bf16_f32 v94, v116, v117
    v_cvt_pk_bf16_f32 v95, v118, v119
    v_cvt_pk_bf16_f32 v96, v120, v121
    v_cvt_pk_bf16_f32 v97, v122, v123
    v_cvt_pk_bf16_f32 v98, v124, v125
    v_cvt_pk_bf16_f32 v99, v126, v127
    ds_write_b128 v145, v[92:95]
    ds_write_b128 v145, v[96:99] offset:1024
    s_add_u32 s20, s57, 131072
    v_add_u32 v145, s20, v128
    s_cmp_eq_u32 s5, 0
    s_cbranch_scc1 L2ng2_95
L2g0_96:
    v_mov_b32 v144, 0
    s_waitcnt vmcnt(7)
    v_mfma_f32_16x16x32_bf16 v[64:67], v[32:35], v[136:139], v[140:143]
    v_bitop3_b32 v144, v144, v32, s74 bitop3:0xf6
    v_bitop3_b32 v144, v144, v34, s74 bitop3:0xf6
    s_waitcnt vmcnt(6)
    v_mfma_f32_16x16x32_bf16 v[64:67], v[36:39], v[136:139], v[64:67]
    v_bitop3_b32 v144, v144, v36, s74 bitop3:0xf6
    v_bitop3_b32 v144, v144, v38, s74 bitop3:0xf6
    s_waitcnt vmcnt(5)
    v_mfma_f32_16x16x32_bf16 v[64:67], v[40:43], v[136:139], v[64:67]
    v_bitop3_b32 v144, v144, v40, s74 bitop3:0xf6
    v_bitop3_b32 v144, v144, v42, s74 bitop3:0xf6
    s_waitcnt vmcnt(4)
    v_mfma_f32_16x16x32_bf16 v[64:67], v[44:47], v[136:139], v[64:67]
    v_bitop3_b32 v144, v144, v44, s74 bitop3:0xf6
    v_bitop3_b32 v144, v144, v46, s74 bitop3:0xf6
    s_waitcnt vmcnt(3)
    v_mfma_f32_16x16x32_bf16 v[64:67], v[48:51], v[136:139], v[64:67]
    v_bitop3_b32 v144, v144, v48, s74 bitop3:0xf6
    v_bitop3_b32 v144, v144, v50, s74 bitop3:0xf6
    s_waitcnt vmcnt(2)
    v_mfma_f32_16x16x32_bf16 v[64:67], v[52:55], v[136:139], v[64:67]
    v_bitop3_b32 v144, v144, v52, s74 bitop3:0xf6
    v_bitop3_b32 v144, v144, v54, s74 bitop3:0xf6
    s_waitcnt vmcnt(1)
    v_mfma_f32_16x16x32_bf16 v[64:67], v[56:59], v[136:139], v[64:67]
    v_bitop3_b32 v144, v144, v56, s74 bitop3:0xf6
    v_bitop3_b32 v144, v144, v58, s74 bitop3:0xf6
    s_waitcnt vmcnt(0)
    v_mfma_f32_16x16x32_bf16 v[64:67], v[60:63], v[136:139], v[64:67]
    v_bitop3_b32 v144, v144, v60, s74 bitop3:0xf6
    v_bitop3_b32 v144, v144, v62, s74 bitop3:0xf6
    v_and_b32 v144, 1, v144
    v_cmp_ne_u32 vcc, 0, v144
    s_cbranch_vccnz L2gr_97
L2go_98:
    s_nop 2
    v_cvt_pk_bf16_f32 v68, v64, v65
    v_cvt_pk_bf16_f32 v69, v66, v67
    buffer_store_dwordx2 v[68:69], v133, s[28:31], s71 offen
    s_nop 0
L2ng2_95:
    v_lshlrev_b32 v140, 16, v28
    v_and_b32 v141, 0xffff0000, v28
    v_lshlrev_b32 v142, 16, v29
    v_and_b32 v143, 0xffff0000, v29
    v_add_f32 v140, v140, v0
    v_add_f32 v141, v141, v1
    v_add_f32 v142, v142, v2
    v_add_f32 v143, v143, v3
    v_add_f32 v140, v140, v4
    v_add_f32 v141, v141, v5
    v_add_f32 v142, v142, v6
    v_add_f32 v143, v143, v7
    v_add_f32 v140, v140, v8
    v_add_f32 v141, v141, v9
    v_add_f32 v142, v142, v10
    v_add_f32 v143, v143, v11
    v_add_f32 v140, v140, v12
    v_add_f32 v141, v141, v13
    v_add_f32 v142, v142, v14
    v_add_f32 v143, v143, v15
    v_add_f32 v140, v140, v16
    v_add_f32 v141, v141, v17
    v_add_f32 v142, v142, v18
    v_add_f32 v143, v143, v19
    v_add_f32 v140, v140, v20
    v_add_f32 v141, v141, v21
    v_add_f32 v142, v142, v22
    v_add_f32 v143, v143, v23
    v_add_f32 v140, v140, v24
    v_add_f32 v141, v141, v25
    v_add_f32 v142, v142, v26
    v_add_f32 v143, v143, v27
    s_waitcnt vmcnt(1) lgkmcnt(0)
    s_cmp_lg_u32 s5, 0
    s_cbranch_scc1 L2w_99
    s_waitcnt vmcnt(0)
L2w_99:
    s_barrier
    ds_read_b128 v[0:3], v145 offset:0
    ds_read_b128 v[4:7], v145 offset:1024
    ds_read_b128 v[8:11], v145 offset:2048
    ds_read_b128 v[12:15], v145 offset:3072
    ds_read_b128 v[16:19], v145 offset:4096
    ds_read_b128 v[20:23], v145 offset:5120
    ds_read_b128 v[24:27], v145 offset:6144
    ds_read_b128 v[28:31], v145 offset:7168
    v_readfirstlane_b32 s67, v148
    v_readfirstlane_b32 s68, v149
    s_lshl_b32 s73, s4, 15
    s_add_u32 s73, s73, s56
    s_mov_b32 s74, s49
    s_mov_b32 s75, s53
    s_mov_b32 s76, s6
    s_cmp_ge_u32 s67, 1
    s_cselect_b32 s70, 1, 0
    s_cmp_ge_u32 s68, 7
    s_cselect_b32 s70, s70, 0
    s_cmp_lt_u32 s66, 64
    s_cselect_b32 s70, s70, 0
    s_cmp_eq_u32 s70, 0
    s_cbranch_scc1 L2nl_100
    s_lshl_b32 s20, s66, 5
    s_add_u32 s20, s20, s4
    s_lshl_b32 s58, s20, 13
    s_lshl_b32 s21, s54, 10
    s_add_u32 s21, s21, s58
    s_add_u32 s21, s21, 16777216
    s_add_u32 s23, s21, 4096
    buffer_load_dwordx4 v[160:163], v128, s[8:11], s21 offen offset:0 sc1
    buffer_load_dwordx4 v[164:167], v128, s[8:11], s21 offen offset:2048 sc1
    buffer_load_dwordx4 v[168:171], v128, s[8:11], s23 offen offset:0 sc1
    buffer_load_dwordx4 v[172:175], v128, s[8:11], s23 offen offset:2048 sc1
    s_add_u32 s21, s58, 33554432
    s_add_u32 s23, s21, 4096
    buffer_load_dwordx4 v[176:179], v128, s[8:11], s21 offen offset:0 sc1
    buffer_load_dwordx4 v[192:195], v128, s[8:11], s21 offen offset:1024 sc1
    buffer_load_dwordx4 v[180:183], v128, s[8:11], s21 offen offset:2048 sc1
    buffer_load_dwordx4 v[196:199], v128, s[8:11], s21 offen offset:3072 sc1
    buffer_load_dwordx4 v[184:187], v128, s[8:11], s23 offen offset:0 sc1
    buffer_load_dwordx4 v[200:203], v128, s[8:11], s23 offen offset:1024 sc1
    buffer_load_dwordx4 v[188:191], v128, s[8:11], s23 offen offset:2048 sc1
    buffer_load_dwordx4 v[204:207], v128, s[8:11], s23 offen offset:3072 sc1
    s_lshl_b32 s21, s55, 12
    s_add_u32 s21, s21, s58
    s_add_u32 s21, s21, 50331648
    buffer_load_dwordx4 v[208:211], v128, s[8:11], s21 offen offset:0 sc1
    buffer_load_dwordx4 v[212:215], v128, s[8:11], s21 offen offset:1024 sc1
    buffer_load_dwordx4 v[216:219], v128, s[8:11], s21 offen offset:2048 sc1
    buffer_load_dwordx4 v[220:223], v128, s[8:11], s21 offen offset:3072 sc1
L2nl_100:
    s_lshl_b32 s20, s3, 18
    s_add_u32 s20, s20, s56
    s_lshl_b32 s21, s4, 10
    s_add_u32 s20, s20, s21
    s_waitcnt lgkmcnt(7)
    v_mfma_f32_16x16x32_bf16 v[32:35], v[0:3], a[0:3], 0
    s_waitcnt lgkmcnt(3)
    v_mfma_f32_16x16x32_bf16 v[36:39], v[16:19], a[0:3], 0
    v_mfma_f32_16x16x32_bf16 v[32:35], v[4:7], a[4:7], v[32:35]
    s_waitcnt lgkmcnt(2)
    v_mfma_f32_16x16x32_bf16 v[36:39], v[20:23], a[4:7], v[36:39]
    v_mfma_f32_16x16x32_bf16 v[32:35], v[8:11], a[8:11], v[32:35]
    s_waitcnt lgkmcnt(1)
    v_mfma_f32_16x16x32_bf16 v[36:39], v[24:27], a[8:11], v[36:39]
    v_mfma_f32_16x16x32_bf16 v[32:35], v[12:15], a[12:15], v[32:35]
    s_waitcnt lgkmcnt(0)
    v_mfma_f32_16x16x32_bf16 v[36:39], v[28:31], a[12:15], v[36:39]
    v_mfma_f32_16x16x32_bf16 v[40:43], v[0:3], a[16:19], 0
    v_mfma_f32_16x16x32_bf16 v[44:47], v[16:19], a[16:19], 0
    v_mfma_f32_16x16x32_bf16 v[40:43], v[4:7], a[20:23], v[40:43]
    v_cvt_pk_bf16_f32 v48, v32, v33
    v_cvt_pk_bf16_f32 v49, v34, v35
    v_mfma_f32_16x16x32_bf16 v[44:47], v[20:23], a[20:23], v[44:47]
    v_cvt_pk_bf16_f32 v50, v36, v37
    v_cvt_pk_bf16_f32 v51, v38, v39
    v_mfma_f32_16x16x32_bf16 v[40:43], v[8:11], a[24:27], v[40:43]
    v_and_or_b32 v48, v48, -2, s49
    v_and_or_b32 v50, v50, -2, s49
    v_mfma_f32_16x16x32_bf16 v[44:47], v[24:27], a[24:27], v[44:47]
    buffer_store_dwordx4 v[48:51], v128, s[8:11], s20 offen
    s_add_u32 s20, s20, 32768
    v_mfma_f32_16x16x32_bf16 v[40:43], v[12:15], a[28:31], v[40:43]
    v_mfma_f32_16x16x32_bf16 v[44:47], v[28:31], a[28:31], v[44:47]
    v_mfma_f32_16x16x32_bf16 v[32:35], v[0:3], a[32:35], 0
    v_mfma_f32_16x16x32_bf16 v[36:39], v[16:19], a[32:35], 0
    v_mfma_f32_16x16x32_bf16 v[32:35], v[4:7], a[36:39], v[32:35]
    v_cvt_pk_bf16_f32 v52, v40, v41
    v_cvt_pk_bf16_f32 v53, v42, v43
    v_mfma_f32_16x16x32_bf16 v[36:39], v[20:23], a[36:39], v[36:39]
    v_cvt_pk_bf16_f32 v54, v44, v45
    v_cvt_pk_bf16_f32 v55, v46, v47
    v_mfma_f32_16x16x32_bf16 v[32:35], v[8:11], a[40:43], v[32:35]
    v_and_or_b32 v52, v52, -2, s49
    v_and_or_b32 v54, v54, -2, s49
    v_mfma_f32_16x16x32_bf16 v[36:39], v[24:27], a[40:43], v[36:39]
    buffer_store_dwordx4 v[52:55], v128, s[8:11], s20 offen
    s_add_u32 s20, s20, 32768
    v_mfma_f32_16x16x32_bf16 v[32:35], v[12:15], a[44:47], v[32:35]
    v_mfma_f32_16x16x32_bf16 v[36:39], v[28:31], a[44:47], v[36:39]
    v_mfma_f32_16x16x32_bf16 v[40:43], v[0:3], a[48:51], 0
    v_mfma_f32_16x16x32_bf16 v[44:47], v[16:19], a[48:51], 0
    v_mfma_f32_16x16x32_bf16 v[40:43], v[4:7], a[52:55], v[40:43]
    v_cvt_pk_bf16_f32 v48, v32, v33
    v_cvt_pk_bf16_f32 v49, v34, v35
    v_mfma_f32_16x16x32_bf16 v[44:47], v[20:23], a[52:55], v[44:47]
    v_cvt_pk_bf16_f32 v50, v36, v37
    v_cvt_pk_bf16_f32 v51, v38, v39
    v_mfma_f32_16x16x32_bf16 v[40:43], v[8:11], a[56:59], v[40:43]
    v_and_or_b32 v48, v48, -2, s49
    v_and_or_b32 v50, v50, -2, s49
    v_mfma_f32_16x16x32_bf16 v[44:47], v[24:27], a[56:59], v[44:47]
    buffer_store_dwordx4 v[48:51], v128, s[8:11], s20 offen
    s_add_u32 s20, s20, 32768
    v_mfma_f32_16x16x32_bf16 v[40:43], v[12:15], a[60:63], v[40:43]
    v_mfma_f32_16x16x32_bf16 v[44:47], v[28:31], a[60:63], v[44:47]
    v_mfma_f32_16x16x32_bf16 v[32:35], v[0:3], a[64:67], 0
    v_mfma_f32_16x16x32_bf16 v[36:39], v[16:19], a[64:67], 0
    v_mfma_f32_16x16x32_bf16 v[32:35], v[4:7], a[68:71], v[32:35]
    v_cvt_pk_bf16_f32 v52, v40, v41
    v_cvt_pk_bf16_f32 v53, v42, v43
    v_mfma_f32_16x16x32_bf16 v[36:39], v[20:23], a[68:71], v[36:39]
    v_cvt_pk_bf16_f32 v54, v44, v45
    v_cvt_pk_bf16_f32 v55, v46, v47
    v_mfma_f32_16x16x32_bf16 v[32:35], v[8:11], a[72:75], v[32:35]
    v_and_or_b32 v52, v52, -2, s49
    v_and_or_b32 v54, v54, -2, s49
    v_mfma_f32_16x16x32_bf16 v[36:39], v[24:27], a[72:75], v[36:39]
    buffer_store_dwordx4 v[52:55], v128, s[8:11], s20 offen
    s_add_u32 s20, s20, 32768
    v_mfma_f32_16x16x32_bf16 v[32:35], v[12:15], a[76:79], v[32:35]
    v_mfma_f32_16x16x32_bf16 v[36:39], v[28:31], a[76:79], v[36:39]
    v_mfma_f32_16x16x32_bf16 v[40:43], v[0:3], a[80:83], 0
    v_mfma_f32_16x16x32_bf16 v[44:47], v[16:19], a[80:83], 0
    v_mfma_f32_16x16x32_bf16 v[40:43], v[4:7], a[84:87], v[40:43]
    v_cvt_pk_bf16_f32 v48, v32, v33
    v_cvt_pk_bf16_f32 v49, v34, v35
    v_mfma_f32_16x16x32_bf16 v[44:47], v[20:23], a[84:87], v[44:47]
    v_cvt_pk_bf16_f32 v50, v36, v37
    v_cvt_pk_bf16_f32 v51, v38, v39
    v_mfma_f32_16x16x32_bf16 v[40:43], v[8:11], a[88:91], v[40:43]
    v_and_or_b32 v48, v48, -2, s49
    v_and_or_b32 v50, v50, -2, s49
    v_mfma_f32_16x16x32_bf16 v[44:47], v[24:27], a[88:91], v[44:47]
    buffer_store_dwordx4 v[48:51], v128, s[8:11], s20 offen
    s_add_u32 s20, s20, 32768
    v_mfma_f32_16x16x32_bf16 v[40:43], v[12:15], a[92:95], v[40:43]
    v_mfma_f32_16x16x32_bf16 v[44:47], v[28:31], a[92:95], v[44:47]
    v_mfma_f32_16x16x32_bf16 v[32:35], v[0:3], a[96:99], 0
    v_mfma_f32_16x16x32_bf16 v[36:39], v[16:19], a[96:99], 0
    v_mfma_f32_16x16x32_bf16 v[32:35], v[4:7], a[100:103], v[32:35]
    v_cvt_pk_bf16_f32 v52, v40, v41
    v_cvt_pk_bf16_f32 v53, v42, v43
    v_mfma_f32_16x16x32_bf16 v[36:39], v[20:23], a[100:103], v[36:39]
    v_cvt_pk_bf16_f32 v54, v44, v45
    v_cvt_pk_bf16_f32 v55, v46, v47
    v_mfma_f32_16x16x32_bf16 v[32:35], v[8:11], a[104:107], v[32:35]
    v_and_or_b32 v52, v52, -2, s49
    v_and_or_b32 v54, v54, -2, s49
    v_mfma_f32_16x16x32_bf16 v[36:39], v[24:27], a[104:107], v[36:39]
    buffer_store_dwordx4 v[52:55], v128, s[8:11], s20 offen
    s_add_u32 s20, s20, 32768
    v_mfma_f32_16x16x32_bf16 v[32:35], v[12:15], a[108:111], v[32:35]
    v_mfma_f32_16x16x32_bf16 v[36:39], v[28:31], a[108:111], v[36:39]
    v_mfma_f32_16x16x32_bf16 v[40:43], v[0:3], a[112:115], 0
    v_mfma_f32_16x16x32_bf16 v[44:47], v[16:19], a[112:115], 0
    v_mfma_f32_16x16x32_bf16 v[40:43], v[4:7], a[116:119], v[40:43]
    v_cvt_pk_bf16_f32 v48, v32, v33
    v_cvt_pk_bf16_f32 v49, v34, v35
    v_mfma_f32_16x16x32_bf16 v[44:47], v[20:23], a[116:119], v[44:47]
    v_cvt_pk_bf16_f32 v50, v36, v37
    v_cvt_pk_bf16_f32 v51, v38, v39
    v_mfma_f32_16x16x32_bf16 v[40:43], v[8:11], a[120:123], v[40:43]
    v_and_or_b32 v48, v48, -2, s49
    v_and_or_b32 v50, v50, -2, s49
    v_mfma_f32_16x16x32_bf16 v[44:47], v[24:27], a[120:123], v[44:47]
    buffer_store_dwordx4 v[48:51], v128, s[8:11], s20 offen
    s_add_u32 s20, s20, 32768
    v_mfma_f32_16x16x32_bf16 v[40:43], v[12:15], a[124:127], v[40:43]
    v_mfma_f32_16x16x32_bf16 v[44:47], v[28:31], a[124:127], v[44:47]
    s_nop 3
    v_cvt_pk_bf16_f32 v52, v40, v41
    v_cvt_pk_bf16_f32 v53, v42, v43
    s_nop 1
    v_cvt_pk_bf16_f32 v54, v44, v45
    v_cvt_pk_bf16_f32 v55, v46, v47
    v_and_or_b32 v52, v52, -2, s49
    v_and_or_b32 v54, v54, -2, s49
    buffer_store_dwordx4 v[52:55], v128, s[8:11], s20 offen
    s_add_u32 s20, s20, 32768
    s_add_u32 s5, s5, 1
    s_mov_b32 s6, s66
    s_cmp_lt_u32 s6, 64
    s_cbranch_scc0 L2fin_101
    s_cmp_eq_u32 s70, 0
    s_cbranch_scc1 L2slow_86
    s_lshr_b32 s23, s58, 1
    s_add_u32 s23, s23, 67108864
    buffer_load_dwordx4 v[224:227], v128, s[8:11], s23 offen offset:0 sc1
    buffer_load_dwordx4 v[228:231], v128, s[8:11], s23 offen offset:1024 sc1
    buffer_load_dwordx4 v[232:235], v128, s[8:11], s23 offen offset:2048 sc1
    buffer_load_dwordx4 v[236:239], v128, s[8:11], s23 offen offset:3072 sc1
    s_lshr_b32 s21, s58, 2
    s_lshl_b32 s23, s55, 10
    s_add_u32 s21, s21, s23
    s_add_u32 s21, s21, 75497472
    buffer_load_dwordx2 v[240:241], v129, s[8:11], s21 offen sc1
    buffer_load_dwordx2 v[242:243], v129, s[8:11], s21 offen offset:512 sc1
    s_branch L2top_84
L2fin_101:
    s_lshl_b32 s71, s76, 15
    s_add_u32 s72, s73, 0
    buffer_load_dwordx4 v[32:35], v131, s[8:11], s72 offen sc1
    s_add_u32 s72, s73, 4096
    buffer_load_dwordx4 v[36:39], v131, s[8:11], s72 offen sc1
    s_add_u32 s72, s73, 8192
    buffer_load_dwordx4 v[40:43], v131, s[8:11], s72 offen sc1
    s_add_u32 s72, s73, 12288
    buffer_load_dwordx4 v[44:47], v131, s[8:11], s72 offen sc1
    s_add_u32 s72, s73, 16384
    buffer_load_dwordx4 v[48:51], v131, s[8:11], s72 offen sc1
    s_add_u32 s72, s73, 20480
    buffer_load_dwordx4 v[52:55], v131, s[8:11], s72 offen sc1
    s_add_u32 s72, s73, 24576
    buffer_load_dwordx4 v[56:59], v131, s[8:11], s72 offen sc1
    s_add_u32 s72, s73, 28672
    buffer_load_dwordx4 v[60:63], v131, s[8:11], s72 offen sc1
L2g0_102:
    v_mov_b32 v144, 0
    s_waitcnt vmcnt(7)
    v_mfma_f32_16x16x32_bf16 v[64:67], v[32:35], v[136:139], v[140:143]
    v_bitop3_b32 v144, v144, v32, s74 bitop3:0xf6
    v_bitop3_b32 v144, v144, v34, s74 bitop3:0xf6
    s_waitcnt vmcnt(6)
    v_mfma_f32_16x16x32_bf16 v[64:67], v[36:39], v[136:139], v[64:67]
    v_bitop3_b32 v144, v144, v36, s74 bitop3:0xf6
    v_bitop3_b32 v144, v144, v38, s74 bitop3:0xf6
    s_waitcnt vmcnt(5)
    v_mfma_f32_16x16x32_bf16 v[64:67], v[40:43], v[136:139], v[64:67]
    v_bitop3_b32 v144, v144, v40, s74 bitop3:0xf6
    v_bitop3_b32 v144, v144, v42, s74 bitop3:0xf6
    s_waitcnt vmcnt(4)
    v_mfma_f32_16x16x32_bf16 v[64:67], v[44:47], v[136:139], v[64:67]
    v_bitop3_b32 v144, v144, v44, s74 bitop3:0xf6
    v_bitop3_b32 v144, v144, v46, s74 bitop3:0xf6
    s_waitcnt vmcnt(3)
    v_mfma_f32_16x16x32_bf16 v[64:67], v[48:51], v[136:139], v[64:67]
    v_bitop3_b32 v144, v144, v48, s74 bitop3:0xf6
    v_bitop3_b32 v144, v144, v50, s74 bitop3:0xf6
    s_waitcnt vmcnt(2)
    v_mfma_f32_16x16x32_bf16 v[64:67], v[52:55], v[136:139], v[64:67]
    v_bitop3_b32 v144, v144, v52, s74 bitop3:0xf6
    v_bitop3_b32 v144, v144, v54, s74 bitop3:0xf6
    s_waitcnt vmcnt(1)
    v_mfma_f32_16x16x32_bf16 v[64:67], v[56:59], v[136:139], v[64:67]
    v_bitop3_b32 v144, v144, v56, s74 bitop3:0xf6
    v_bitop3_b32 v144, v144, v58, s74 bitop3:0xf6
    s_waitcnt vmcnt(0)
    v_mfma_f32_16x16x32_bf16 v[64:67], v[60:63], v[136:139], v[64:67]
    v_bitop3_b32 v144, v144, v60, s74 bitop3:0xf6
    v_bitop3_b32 v144, v144, v62, s74 bitop3:0xf6
    v_and_b32 v144, 1, v144
    v_cmp_ne_u32 vcc, 0, v144
    s_cbranch_vccnz L2gr_103
L2go_104:
    s_nop 2
    v_cvt_pk_bf16_f32 v68, v64, v65
    v_cvt_pk_bf16_f32 v69, v66, v67
    buffer_store_dwordx2 v[68:69], v133, s[28:31], s71 offen
    s_nop 0
    s_branch L2end_85
L2gr_97:
    s_add_u32 s51, s51, 1
    s_cmp_gt_u32 s51, 100000000
    s_cbranch_scc1 L2go_98
    s_add_u32 s72, s73, 0
    buffer_load_dwordx4 v[32:35], v131, s[8:11], s72 offen sc1
    s_add_u32 s72, s73, 4096
    buffer_load_dwordx4 v[36:39], v131, s[8:11], s72 offen sc1
    s_add_u32 s72, s73, 8192
    buffer_load_dwordx4 v[40:43], v131, s[8:11], s72 offen sc1
    s_add_u32 s72, s73, 12288
    buffer_load_dwordx4 v[44:47], v131, s[8:11], s72 offen sc1
    s_add_u32 s72, s73, 16384
    buffer_load_dwordx4 v[48:51], v131, s[8:11], s72 offen sc1
    s_add_u32 s72, s73, 20480
    buffer_load_dwordx4 v[52:55], v131, s[8:11], s72 offen sc1
    s_add_u32 s72, s73, 24576
    buffer_load_dwordx4 v[56:59], v131, s[8:11], s72 offen sc1
    s_add_u32 s72, s73, 28672
    buffer_load_dwordx4 v[60:63], v131, s[8:11], s72 offen sc1
    s_waitcnt vmcnt(0)
    s_branch L2g0_96
L2gr_103:
    s_add_u32 s51, s51, 1
    s_cmp_gt_u32 s51, 100000000
    s_cbranch_scc1 L2go_104
    s_add_u32 s72, s73, 0
    buffer_load_dwordx4 v[32:35], v131, s[8:11], s72 offen sc1
    s_add_u32 s72, s73, 4096
    buffer_load_dwordx4 v[36:39], v131, s[8:11], s72 offen sc1
    s_add_u32 s72, s73, 8192
    buffer_load_dwordx4 v[40:43], v131, s[8:11], s72 offen sc1
    s_add_u32 s72, s73, 12288
    buffer_load_dwordx4 v[44:47], v131, s[8:11], s72 offen sc1
    s_add_u32 s72, s73, 16384
    buffer_load_dwordx4 v[48:51], v131, s[8:11], s72 offen sc1
    s_add_u32 s72, s73, 20480
    buffer_load_dwordx4 v[52:55], v131, s[8:11], s72 offen sc1
    s_add_u32 s72, s73, 24576
    buffer_load_dwordx4 v[56:59], v131, s[8:11], s72 offen sc1
    s_add_u32 s72, s73, 28672
    buffer_load_dwordx4 v[60:63], v131, s[8:11], s72 offen sc1
    s_waitcnt vmcnt(0)
    s_branch L2g0_102
L2mr_87:
    s_add_u32 s51, s51, 1
    s_cmp_gt_u32 s51, 100000000
    s_cbranch_scc1 L2mo_89
    s_sleep 2
    s_lshr_b32 s23, s58, 1
    s_add_u32 s23, s23, 67108864
    buffer_load_dwordx4 v[224:227], v128, s[8:11], s23 offen offset:0 sc1
    buffer_load_dwordx4 v[228:231], v128, s[8:11], s23 offen offset:1024 sc1
    buffer_load_dwordx4 v[232:235], v128, s[8:11], s23 offen offset:2048 sc1
    buffer_load_dwordx4 v[236:239], v128, s[8:11], s23 offen offset:3072 sc1
    s_lshr_b32 s21, s58, 2
    s_lshl_b32 s23, s55, 10
    s_add_u32 s21, s21, s23
    s_add_u32 s21, s21, 75497472
    buffer_load_dwordx2 v[240:241], v129, s[8:11], s21 offen sc1
    buffer_load_dwordx2 v[242:243], v129, s[8:11], s21 offen offset:512 sc1
    s_branch L2mc_88
L2end_85:
    s_branch Lm_exit
Lm_s2s:
    s_mov_b32 s5, 0
    s_mov_b32 s6, s7
L2slow_107:
    s_lshr_b32 s20, s6, 2
    s_lshl_b32 s68, s20, 7
    s_add_u32 s68, s68, 131076096
    s_lshl_b32 s20, s20, 5
    s_add_u32 s20, s20, s4
    s_lshl_b32 s20, s20, 2
    s_add_u32 s67, s20, 131074048
Lpl_111:
    buffer_load_dword v144, off, s[8:11], s67 sc1
    s_waitcnt vmcnt(0)
    v_readfirstlane_b32 s59, v144
    s_nop 0
    s_cmp_ge_u32 s59, 1
    s_cbranch_scc1 Lpd_112
    s_add_u32 s51, s51, 1
    s_cmp_gt_u32 s51, 100000000
    s_cbranch_scc1 Lpd_112
    s_sleep 2
    s_branch Lpl_111
Lpd_112:
Lpl_113:
    buffer_load_dword v144, off, s[8:11], s68 sc1
    s_waitcnt vmcnt(0)
    v_readfirstlane_b32 s59, v144
    s_nop 0
    s_cmp_ge_u32 s59, 7
    s_cbranch_scc1 Lpd_114
    s_add_u32 s51, s51, 1
    s_cmp_gt_u32 s51, 100000000
    s_cbranch_scc1 Lpd_114
    s_sleep 2
    s_branch Lpl_113
Lpd_114:
    s_lshl_b32 s20, s6, 5
    s_add_u32 s20, s20, s4
    s_lshl_b32 s58, s20, 13
    s_lshl_b32 s21, s54, 10
    s_add_u32 s21, s21, s58
    s_add_u32 s21, s21, 16777216
    s_add_u32 s23, s21, 4096
    buffer_load_dwordx4 v[160:163], v128, s[8:11], s21 offen offset:0 sc1
    buffer_load_dwordx4 v[164:167], v128, s[8:11], s21 offen offset:2048 sc1
    buffer_load_dwordx4 v[168:171], v128, s[8:11], s23 offen offset:0 sc1
    buffer_load_dwordx4 v[172:175], v128, s[8:11], s23 offen offset:2048 sc1
    s_add_u32 s21, s58, 33554432
    s_add_u32 s23, s21, 4096
    buffer_load_dwordx4 v[176:179], v128, s[8:11], s21 offen offset:0 sc1
    buffer_load_dwordx4 v[192:195], v128, s[8:11], s21 offen offset:1024 sc1
    buffer_load_dwordx4 v[180:183], v128, s[8:11], s21 offen offset:2048 sc1
    buffer_load_dwordx4 v[196:199], v128, s[8:11], s21 offen offset:3072 sc1
    buffer_load_dwordx4 v[184:187], v128, s[8:11], s23 offen offset:0 sc1
    buffer_load_dwordx4 v[200:203], v128, s[8:11], s23 offen offset:1024 sc1
    buffer_load_dwordx4 v[188:191], v128, s[8:11], s23 offen offset:2048 sc1
    buffer_load_dwordx4 v[204:207], v128, s[8:11], s23 offen offset:3072 sc1
    s_lshl_b32 s21, s55, 12
    s_add_u32 s21, s21, s58
    s_add_u32 s21, s21, 50331648
    buffer_load_dwordx4 v[208:211], v128, s[8:11], s21 offen offset:0 sc1
    buffer_load_dwordx4 v[212:215], v128, s[8:11], s21 offen offset:1024 sc1
    buffer_load_dwordx4 v[216:219], v128, s[8:11], s21 offen offset:2048 sc1
    buffer_load_dwordx4 v[220:223], v128, s[8:11], s21 offen offset:3072 sc1
    s_lshr_b32 s23, s58, 1
    s_add_u32 s23, s23, 67108864
    buffer_load_dwordx4 v[224:227], v128, s[8:11], s23 offen offset:0 sc1
    buffer_load_dwordx4 v[228:231], v128, s[8:11], s23 offen offset:1024 sc1
    buffer_load_dwordx4 v[232:235], v128, s[8:11], s23 offen offset:2048 sc1
    buffer_load_dwordx4 v[236:239], v128, s[8:11], s23 offen offset:3072 sc1
    s_lshr_b32 s21, s58, 2
    s_lshl_b32 s23, s55, 10
    s_add_u32 s21, s21, s23
    s_add_u32 s21, s21, 75497472
    buffer_load_dwordx2 v[240:241], v129, s[8:11], s21 offen sc1
    buffer_load_dwordx2 v[242:243], v129, s[8:11], s21 offen offset:512 sc1
L2top_105:
    s_lshr_b32 s53, s58, 1
    s_lshr_b32 s49, s5, 1
    s_and_b32 s49, s49, 1
    s_and_b32 s20, s5, 1
    s_lshl_b32 s57, s20, 13
    s_lshl_b32 s20, s20, 20
    s_add_u32 s56, s20, s50
    s_add_u32 s66, s6, 2
    s_min_u32 s70, s66, 63
    s_lshr_b32 s20, s70, 2
    s_lshl_b32 s68, s20, 7
    s_add_u32 s68, s68, 131076096
    s_lshl_b32 s20, s20, 5
    s_add_u32 s20, s20, s4
    s_lshl_b32 s20, s20, 2
    s_add_u32 s67, s20, 131074048
    s_lshr_b32 s21, s53, 1
    s_add_u32 s21, s21, 83886080
    s_lshl_b32 s22, s6, 15
    buffer_load_dwordx4 v[0:3], v132, s[8:11], s21 offen sc1
    s_add_u32 s21, s21, 4194304
    buffer_load_dwordx4 v[4:7], v132, s[8:11], s21 offen sc1
    s_add_u32 s21, s21, 4194304
    buffer_load_dwordx4 v[8:11], v132, s[8:11], s21 offen sc1
    s_add_u32 s21, s21, 4194304
    buffer_load_dwordx4 v[12:15], v132, s[8:11], s21 offen sc1
    s_add_u32 s21, s21, 4194304
    buffer_load_dwordx4 v[16:19], v132, s[8:11], s21 offen sc1
    s_add_u32 s21, s21, 4194304
    buffer_load_dwordx4 v[20:23], v132, s[8:11], s21 offen sc1
    s_add_u32 s21, s21, 4194304
    buffer_load_dwordx4 v[24:27], v132, s[8:11], s21 offen sc1
    buffer_load_dwordx2 v[28:29], v133, s[24:27], s22 offen
L2mc_109:
    s_waitcnt vmcnt(0)
    v_max3_u32 v144, v224, v225, v226
    v_max3_u32 v144, v144, v227, v228
    v_max3_u32 v144, v144, v229, v230
    v_max3_u32 v144, v144, v231, v232
    v_max3_u32 v144, v144, v233, v234
    v_max3_u32 v144, v144, v235, v236
    v_max3_u32 v144, v144, v237, v238
    v_max3_u32 v144, v144, v239, v240
    v_max3_u32 v144, v144, v241, v242
    v_max_u32 v144, v144, v243
    v_cmp_eq_u32 vcc, -1, v144
    s_cbranch_vccnz L2mr_108
L2mo_110:
    buffer_load_dword v148, off, s[8:11], s67 sc1
    buffer_load_dword v149, off, s[8:11], s68 sc1
    s_cmp_eq_u32 s5, 0
    s_cbranch_scc1 L2ng_115
    s_lshl_b32 s71, s76, 15
    s_add_u32 s72, s73, 0
    buffer_load_dwordx4 v[32:35], v131, s[8:11], s72 offen sc1
    s_add_u32 s72, s73, 4096
    buffer_load_dwordx4 v[36:39], v131, s[8:11], s72 offen sc1
    s_add_u32 s72, s73, 8192
    buffer_load_dwordx4 v[40:43], v131, s[8:11], s72 offen sc1
    s_add_u32 s72, s73, 12288
    buffer_load_dwordx4 v[44:47], v131, s[8:11], s72 offen sc1
    s_add_u32 s72, s73, 16384
    buffer_load_dwordx4 v[48:51], v131, s[8:11], s72 offen sc1
    s_add_u32 s72, s73, 20480
    buffer_load_dwordx4 v[52:55], v131, s[8:11], s72 offen sc1
    s_add_u32 s72, s73, 24576
    buffer_load_dwordx4 v[56:59], v131, s[8:11], s72 offen sc1
    s_add_u32 s72, s73, 28672
    buffer_load_dwordx4 v[60:63], v131, s[8:11], s72 offen sc1
L2ng_115:
    v_mfma_f32_16x16x32_bf16 v[92:95], v[176:179], v[160:163], 0
    v_mfma_f32_16x16x32_bf16 v[96:99], v[192:195], v[160:163], 0
    v_mfma_f32_16x16x32_bf16 v[100:103], v[224:227], v[160:163], 0
    v_mfma_f32_16x16x32_bf16 v[92:95], v[180:183], v[164:167], v[92:95]
    v_mfma_f32_16x16x32_bf16 v[96:99], v[196:199], v[164:167], v[96:99]
    v_mfma_f32_16x16x32_bf16 v[100:103], v[228:231], v[164:167], v[100:103]
    v_mfma_f32_16x16x32_bf16 v[92:95], v[184:187], v[168:171], v[92:95]
    v_mfma_f32_16x16x32_bf16 v[96:99], v[200:203], v[168:171], v[96:99]
    v_mfma_f32_16x16x32_bf16 v[100:103], v[232:235], v[168:171], v[100:103]
    v_mfma_f32_16x16x32_bf16 v[92:95], v[188:191], v[172:175], v[92:95]
    v_mfma_f32_16x16x32_bf16 v[96:99], v[204:207], v[172:175], v[96:99]
    v_mfma_f32_16x16x32_bf16 v[100:103], v[236:239], v[172:175], v[100:103]
    v_cndmask_b32 v92, v92, v146, s[32:33]
    v_cndmask_b32 v93, v93, v146, s[34:35]
    v_cndmask_b32 v94, v94, v146, s[36:37]
    v_cndmask_b32 v95, v95, v146, s[38:39]
    v_cndmask_b32 v96, v96, v146, s[40:41]
    v_cndmask_b32 v97, v97, v146, s[42:43]
    v_cndmask_b32 v98, v98, v146, s[44:45]
    v_cndmask_b32 v99, v99, v146, s[46:47]
    v_max3_f32 v144, v92, v93, v94
    v_max3_f32 v145, v95, v96, v97
    v_max3_f32 v144, v144, v98, v99
    v_max3_f32 v145, v145, v100, v101
    v_max_f32 v144, v144, v145
    v_mov_b32 v145, v144
    s_nop 1
    v_permlane32_swap_b32 v144, v145
    v_max_f32 v144, v144, v145
    v_mov_b32 v145, v144
    s_nop 1
    v_permlane16_swap_b32 v144, v145
    v_max_f32 v144, v144, v145
    v_mul_f32 v144, s48, v144
    v_fma_f32 v92, v92, s48, -v144
    v_fma_f32 v93, v93, s48, -v144
    v_fma_f32 v94, v94, s48, -v144
    v_fma_f32 v95, v95, s48, -v144
    v_fma_f32 v96, v96, s48, -v144
    v_fma_f32 v97, v97, s48, -v144
    v_fma_f32 v98, v98, s48, -v144
    v_fma_f32 v99, v99, s48, -v144
    v_fma_f32 v100, v100, s48, -v144
    v_fma_f32 v101, v101, s48, -v144
    v_exp_f32 v92, v92
    v_exp_f32 v93, v93
    v_exp_f32 v94, v94
    v_exp_f32 v95, v95
    v_exp_f32 v96, v96
    v_exp_f32 v97, v97
    v_exp_f32 v98, v98
    v_exp_f32 v99, v99
    v_exp_f32 v100, v100
    v_exp_f32 v101, v101
    v_cvt_pk_bf16_f32 v104, v92, v93
    v_cvt_pk_bf16_f32 v105, v94, v95
    v_cvt_pk_bf16_f32 v106, v96, v97
    v_cvt_pk_bf16_f32 v107, v98, v99
    v_cvt_pk_bf16_f32 v108, v100, v101
    v_mov_b32 v109, 0
    v_mov_b32 v84, v240
    v_mov_b32 v85, 0
    v_mov_b32 v86, v241
    v_mov_b32 v87, 0
    v_mov_b32 v88, v242
    v_mov_b32 v89, 0
    v_mov_b32 v90, v243
    v_mov_b32 v91, 0
    v_mfma_f32_16x16x32_bf16 v[112:115], v[208:211], v[104:107], 0
    v_mfma_f32_16x16x32_bf16 v[116:119], v[212:215], v[104:107], 0
    v_mfma_f32_16x16x32_bf16 v[120:123], v[216:219], v[104:107], 0
    v_mfma_f32_16x16x32_bf16 v[124:127], v[220:223], v[104:107], 0
    v_mfma_f32_16x16x16_bf16 v[112:115], v[84:85], v[108:109], v[112:115]
    v_mfma_f32_16x16x16_bf16 v[116:119], v[86:87], v[108:109], v[116:119]
    v_mfma_f32_16x16x16_bf16 v[120:123], v[88:89], v[108:109], v[120:123]
    v_mfma_f32_16x16x16_bf16 v[124:127], v[90:91], v[108:109], v[124:127]
    v_add_f32 v144, v92, v93
    v_add_f32 v144, v144, v94
    v_add_f32 v144, v144, v95
    v_add_f32 v144, v144, v96
    v_add_f32 v144, v144, v97
    v_add_f32 v144, v144, v98
    v_add_f32 v144, v144, v99
    v_add_f32 v144, v144, v100
    v_add_f32 v144, v144, v101
    v_mov_b32 v145, v144
    s_nop 1
    v_permlane32_swap_b32 v144, v145
    v_add_f32 v144, v144, v145
    v_mov_b32 v145, v144
    s_nop 1
    v_permlane16_swap_b32 v144, v145
    v_add_f32 v144, v144, v145
    v_rcp_f32 v144, v144
    v_add_u32 v145, s57, v130
    v_mul_f32 v112, v112, v144
    v_mul_f32 v113, v113, v144
    v_mul_f32 v114, v114, v144
    v_mul_f32 v115, v115, v144
    v_mul_f32 v116, v116, v144
    v_mul_f32 v117, v117, v144
    v_mul_f32 v118, v118, v144
    v_mul_f32 v119, v119, v144
    v_mul_f32 v120, v120, v144
    v_mul_f32 v121, v121, v144
    v_mul_f32 v122, v122, v144
    v_mul_f32 v123, v123, v144
    v_mul_f32 v124, v124, v144
    v_mul_f32 v125, v125, v144
    v_mul_f32 v126, v126, v144
    v_mul_f32 v127, v127, v144
    v_cvt_pk_bf16_f32 v92, v112, v113
    v_cvt_pk_bf16_f32 v93, v114, v115
    v_cvt_pk_bf16_f32 v94, v116, v117
    v_cvt_pk_bf16_f32 v95, v118, v119
    v_cvt_pk_bf16_f32 v96, v120, v121
    v_cvt_pk_bf16_f32 v97, v122, v123
    v_cvt_pk_bf16_f32 v98, v124, v125
    v_cvt_pk_bf16_f32 v99, v126, v127
    ds_write_b128 v145, v[92:95]
    ds_write_b128 v145, v[96:99] offset:1024
    s_add_u32 s20, s57, 131072
    v_add_u32 v145, s20, v128
    s_cmp_eq_u32 s5, 0
    s_cbranch_scc1 L2ng2_116
L2g0_117:
    v_mov_b32 v144, 0
    s_waitcnt vmcnt(7)
    v_mfma_f32_16x16x32_bf16 v[64:67], v[32:35], v[136:139], v[140:143]
    v_bitop3_b32 v144, v144, v32, s74 bitop3:0xf6
    v_bitop3_b32 v144, v144, v34, s74 bitop3:0xf6
    s_waitcnt vmcnt(6)
    v_mfma_f32_16x16x32_bf16 v[64:67], v[36:39], v[136:139], v[64:67]
    v_bitop3_b32 v144, v144, v36, s74 bitop3:0xf6
    v_bitop3_b32 v144, v144, v38, s74 bitop3:0xf6
    s_waitcnt vmcnt(5)
    v_mfma_f32_16x16x32_bf16 v[64:67], v[40:43], v[136:139], v[64:67]
    v_bitop3_b32 v144, v144, v40, s74 bitop3:0xf6
    v_bitop3_b32 v144, v144, v42, s74 bitop3:0xf6
    s_waitcnt vmcnt(4)
    v_mfma_f32_16x16x32_bf16 v[64:67], v[44:47], v[136:139], v[64:67]
    v_bitop3_b32 v144, v144, v44, s74 bitop3:0xf6
    v_bitop3_b32 v144, v144, v46, s74 bitop3:0xf6
    s_waitcnt vmcnt(3)
    v_mfma_f32_16x16x32_bf16 v[64:67], v[48:51], v[136:139], v[64:67]
    v_bitop3_b32 v144, v144, v48, s74 bitop3:0xf6
    v_bitop3_b32 v144, v144, v50, s74 bitop3:0xf6
    s_waitcnt vmcnt(2)
    v_mfma_f32_16x16x32_bf16 v[64:67], v[52:55], v[136:139], v[64:67]
    v_bitop3_b32 v144, v144, v52, s74 bitop3:0xf6
    v_bitop3_b32 v144, v144, v54, s74 bitop3:0xf6
    s_waitcnt vmcnt(1)
    v_mfma_f32_16x16x32_bf16 v[64:67], v[56:59], v[136:139], v[64:67]
    v_bitop3_b32 v144, v144, v56, s74 bitop3:0xf6
    v_bitop3_b32 v144, v144, v58, s74 bitop3:0xf6
    s_waitcnt vmcnt(0)
    v_mfma_f32_16x16x32_bf16 v[64:67], v[60:63], v[136:139], v[64:67]
    v_bitop3_b32 v144, v144, v60, s74 bitop3:0xf6
    v_bitop3_b32 v144, v144, v62, s74 bitop3:0xf6
    v_and_b32 v144, 1, v144
    v_cmp_ne_u32 vcc, 0, v144
    s_cbranch_vccnz L2gr_118
L2go_119:
    s_nop 2
    v_cvt_pk_bf16_f32 v68, v64, v65
    v_cvt_pk_bf16_f32 v69, v66, v67
    buffer_store_dwordx2 v[68:69], v133, s[28:31], s71 offen
    s_nop 0
L2ng2_116:
    v_lshlrev_b32 v140, 16, v28
    v_and_b32 v141, 0xffff0000, v28
    v_lshlrev_b32 v142, 16, v29
    v_and_b32 v143, 0xffff0000, v29
    v_add_f32 v140, v140, v0
    v_add_f32 v141, v141, v1
    v_add_f32 v142, v142, v2
    v_add_f32 v143, v143, v3
    v_add_f32 v140, v140, v4
    v_add_f32 v141, v141, v5
    v_add_f32 v142, v142, v6
    v_add_f32 v143, v143, v7
    v_add_f32 v140, v140, v8
    v_add_f32 v141, v141, v9
    v_add_f32 v142, v142, v10
    v_add_f32 v143, v143, v11
    v_add_f32 v140, v140, v12
    v_add_f32 v141, v141, v13
    v_add_f32 v142, v142, v14
    v_add_f32 v143, v143, v15
    v_add_f32 v140, v140, v16
    v_add_f32 v141, v141, v17
    v_add_f32 v142, v142, v18
    v_add_f32 v143, v143, v19
    v_add_f32 v140, v140, v20
    v_add_f32 v141, v141, v21
    v_add_f32 v142, v142, v22
    v_add_f32 v143, v143, v23
    v_add_f32 v140, v140, v24
    v_add_f32 v141, v141, v25
    v_add_f32 v142, v142, v26
    v_add_f32 v143, v143, v27
    s_waitcnt vmcnt(1) lgkmcnt(0)
    s_cmp_lg_u32 s5, 0
    s_cbranch_scc1 L2w_120
    s_waitcnt vmcnt(0)
L2w_120:
    s_barrier
    ds_read_b128 v[0:3], v145 offset:0
    ds_read_b128 v[4:7], v145 offset:1024
    ds_read_b128 v[8:11], v145 offset:2048
    ds_read_b128 v[12:15], v145 offset:3072
    ds_read_b128 v[16:19], v145 offset:4096
    ds_read_b128 v[20:23], v145 offset:5120
    ds_read_b128 v[24:27], v145 offset:6144
    ds_read_b128 v[28:31], v145 offset:7168
    v_readfirstlane_b32 s67, v148
    v_readfirstlane_b32 s68, v149
    s_lshl_b32 s73, s4, 15
    s_add_u32 s73, s73, s56
    s_mov_b32 s74, s49
    s_mov_b32 s75, s53
    s_mov_b32 s76, s6
    s_cmp_ge_u32 s67, 1
    s_cselect_b32 s70, 1, 0
    s_cmp_ge_u32 s68, 7
    s_cselect_b32 s70, s70, 0
    s_cmp_lt_u32 s66, 64
    s_cselect_b32 s70, s70, 0
    s_cmp_eq_u32 s70, 0
    s_cbranch_scc1 L2nl_121
    s_lshl_b32 s20, s66, 5
    s_add_u32 s20, s20, s4
    s_lshl_b32 s58, s20, 13
    s_lshl_b32 s21, s54, 10
    s_add_u32 s21, s21, s58
    s_add_u32 s21, s21, 16777216
    s_add_u32 s23, s21, 4096
    buffer_load_dwordx4 v[160:163], v128, s[8:11], s21 offen offset:0 sc1
    buffer_load_dwordx4 v[164:167], v128, s[8:11], s21 offen offset:2048 sc1
    buffer_load_dwordx4 v[168:171], v128, s[8:11], s23 offen offset:0 sc1
    buffer_load_dwordx4 v[172:175], v128, s[8:11], s23 offen offset:2048 sc1
    s_add_u32 s21, s58, 33554432
    s_add_u32 s23, s21, 4096
    buffer_load_dwordx4 v[176:179], v128, s[8:11], s21 offen offset:0 sc1
    buffer_load_dwordx4 v[192:195], v128, s[8:11], s21 offen offset:1024 sc1
    buffer_load_dwordx4 v[180:183], v128, s[8:11], s21 offen offset:2048 sc1
    buffer_load_dwordx4 v[196:199], v128, s[8:11], s21 offen offset:3072 sc1
    buffer_load_dwordx4 v[184:187], v128, s[8:11], s23 offen offset:0 sc1
    buffer_load_dwordx4 v[200:203], v128, s[8:11], s23 offen offset:1024 sc1
    buffer_load_dwordx4 v[188:191], v128, s[8:11], s23 offen offset:2048 sc1
    buffer_load_dwordx4 v[204:207], v128, s[8:11], s23 offen offset:3072 sc1
    s_lshl_b32 s21, s55, 12
    s_add_u32 s21, s21, s58
    s_add_u32 s21, s21, 50331648
    buffer_load_dwordx4 v[208:211], v128, s[8:11], s21 offen offset:0 sc1
    buffer_load_dwordx4 v[212:215], v128, s[8:11], s21 offen offset:1024 sc1
    buffer_load_dwordx4 v[216:219], v128, s[8:11], s21 offen offset:2048 sc1
    buffer_load_dwordx4 v[220:223], v128, s[8:11], s21 offen offset:3072 sc1
L2nl_121:
    s_lshl_b32 s20, s3, 18
    s_add_u32 s20, s20, s56
    s_lshl_b32 s21, s4, 10
    s_add_u32 s20, s20, s21
    s_waitcnt lgkmcnt(7)
    v_mfma_f32_16x16x32_bf16 v[32:35], v[0:3], a[0:3], 0
    s_waitcnt lgkmcnt(3)
    v_mfma_f32_16x16x32_bf16 v[36:39], v[16:19], a[0:3], 0
    v_mfma_f32_16x16x32_bf16 v[32:35], v[4:7], a[4:7], v[32:35]
    s_waitcnt lgkmcnt(2)
    v_mfma_f32_16x16x32_bf16 v[36:39], v[20:23], a[4:7], v[36:39]
    v_mfma_f32_16x16x32_bf16 v[32:35], v[8:11], a[8:11], v[32:35]
    s_waitcnt lgkmcnt(1)
    v_mfma_f32_16x16x32_bf16 v[36:39], v[24:27], a[8:11], v[36:39]
    v_mfma_f32_16x16x32_bf16 v[32:35], v[12:15], a[12:15], v[32:35]
    s_waitcnt lgkmcnt(0)
    v_mfma_f32_16x16x32_bf16 v[36:39], v[28:31], a[12:15], v[36:39]
    v_mfma_f32_16x16x32_bf16 v[40:43], v[0:3], a[16:19], 0
    v_mfma_f32_16x16x32_bf16 v[44:47], v[16:19], a[16:19], 0
    v_mfma_f32_16x16x32_bf16 v[40:43], v[4:7], a[20:23], v[40:43]
    v_cvt_pk_bf16_f32 v48, v32, v33
    v_cvt_pk_bf16_f32 v49, v34, v35
    v_mfma_f32_16x16x32_bf16 v[44:47], v[20:23], a[20:23], v[44:47]
    v_cvt_pk_bf16_f32 v50, v36, v37
    v_cvt_pk_bf16_f32 v51, v38, v39
    v_mfma_f32_16x16x32_bf16 v[40:43], v[8:11], a[24:27], v[40:43]
    v_and_or_b32 v48, v48, -2, s49
    v_and_or_b32 v50, v50, -2, s49
    v_mfma_f32_16x16x32_bf16 v[44:47], v[24:27], a[24:27], v[44:47]
    buffer_store_dwordx4 v[48:51], v128, s[8:11], s20 offen sc1
    s_add_u32 s20, s20, 32768
    v_mfma_f32_16x16x32_bf16 v[40:43], v[12:15], a[28:31], v[40:43]
    v_mfma_f32_16x16x32_bf16 v[44:47], v[28:31], a[28:31], v[44:47]
    v_mfma_f32_16x16x32_bf16 v[32:35], v[0:3], a[32:35], 0
    v_mfma_f32_16x16x32_bf16 v[36:39], v[16:19], a[32:35], 0
    v_mfma_f32_16x16x32_bf16 v[32:35], v[4:7], a[36:39], v[32:35]
    v_cvt_pk_bf16_f32 v52, v40, v41
    v_cvt_pk_bf16_f32 v53, v42, v43
    v_mfma_f32_16x16x32_bf16 v[36:39], v[20:23], a[36:39], v[36:39]
    v_cvt_pk_bf16_f32 v54, v44, v45
    v_cvt_pk_bf16_f32 v55, v46, v47
    v_mfma_f32_16x16x32_bf16 v[32:35], v[8:11], a[40:43], v[32:35]
    v_and_or_b32 v52, v52, -2, s49
    v_and_or_b32 v54, v54, -2, s49
    v_mfma_f32_16x16x32_bf16 v[36:39], v[24:27], a[40:43], v[36:39]
    buffer_store_dwordx4 v[52:55], v128, s[8:11], s20 offen sc1
    s_add_u32 s20, s20, 32768
    v_mfma_f32_16x16x32_bf16 v[32:35], v[12:15], a[44:47], v[32:35]
    v_mfma_f32_16x16x32_bf16 v[36:39], v[28:31], a[44:47], v[36:39]
    v_mfma_f32_16x16x32_bf16 v[40:43], v[0:3], a[48:51], 0
    v_mfma_f32_16x16x32_bf16 v[44:47], v[16:19], a[48:51], 0
    v_mfma_f32_16x16x32_bf16 v[40:43], v[4:7], a[52:55], v[40:43]
    v_cvt_pk_bf16_f32 v48, v32, v33
    v_cvt_pk_bf16_f32 v49, v34, v35
    v_mfma_f32_16x16x32_bf16 v[44:47], v[20:23], a[52:55], v[44:47]
    v_cvt_pk_bf16_f32 v50, v36, v37
    v_cvt_pk_bf16_f32 v51, v38, v39
    v_mfma_f32_16x16x32_bf16 v[40:43], v[8:11], a[56:59], v[40:43]
    v_and_or_b32 v48, v48, -2, s49
    v_and_or_b32 v50, v50, -2, s49
    v_mfma_f32_16x16x32_bf16 v[44:47], v[24:27], a[56:59], v[44:47]
    buffer_store_dwordx4 v[48:51], v128, s[8:11], s20 offen sc1
    s_add_u32 s20, s20, 32768
    v_mfma_f32_16x16x32_bf16 v[40:43], v[12:15], a[60:63], v[40:43]
    v_mfma_f32_16x16x32_bf16 v[44:47], v[28:31], a[60:63], v[44:47]
    v_mfma_f32_16x16x32_bf16 v[32:35], v[0:3], a[64:67], 0
    v_mfma_f32_16x16x32_bf16 v[36:39], v[16:19], a[64:67], 0
    v_mfma_f32_16x16x32_bf16 v[32:35], v[4:7], a[68:71], v[32:35]
    v_cvt_pk_bf16_f32 v52, v40, v41
    v_cvt_pk_bf16_f32 v53, v42, v43
    v_mfma_f32_16x16x32_bf16 v[36:39], v[20:23], a[68:71], v[36:39]
    v_cvt_pk_bf16_f32 v54, v44, v45
    v_cvt_pk_bf16_f32 v55, v46, v47
    v_mfma_f32_16x16x32_bf16 v[32:35], v[8:11], a[72:75], v[32:35]
    v_and_or_b32 v52, v52, -2, s49
    v_and_or_b32 v54, v54, -2, s49
    v_mfma_f32_16x16x32_bf16 v[36:39], v[24:27], a[72:75], v[36:39]
    buffer_store_dwordx4 v[52:55], v128, s[8:11], s20 offen sc1
    s_add_u32 s20, s20, 32768
    v_mfma_f32_16x16x32_bf16 v[32:35], v[12:15], a[76:79], v[32:35]
    v_mfma_f32_16x16x32_bf16 v[36:39], v[28:31], a[76:79], v[36:39]
    v_mfma_f32_16x16x32_bf16 v[40:43], v[0:3], a[80:83], 0
    v_mfma_f32_16x16x32_bf16 v[44:47], v[16:19], a[80:83], 0
    v_mfma_f32_16x16x32_bf16 v[40:43], v[4:7], a[84:87], v[40:43]
    v_cvt_pk_bf16_f32 v48, v32, v33
    v_cvt_pk_bf16_f32 v49, v34, v35
    v_mfma_f32_16x16x32_bf16 v[44:47], v[20:23], a[84:87], v[44:47]
    v_cvt_pk_bf16_f32 v50, v36, v37
    v_cvt_pk_bf16_f32 v51, v38, v39
    v_mfma_f32_16x16x32_bf16 v[40:43], v[8:11], a[88:91], v[40:43]
    v_and_or_b32 v48, v48, -2, s49
    v_and_or_b32 v50, v50, -2, s49
    v_mfma_f32_16x16x32_bf16 v[44:47], v[24:27], a[88:91], v[44:47]
    buffer_store_dwordx4 v[48:51], v128, s[8:11], s20 offen sc1
    s_add_u32 s20, s20, 32768
    v_mfma_f32_16x16x32_bf16 v[40:43], v[12:15], a[92:95], v[40:43]
    v_mfma_f32_16x16x32_bf16 v[44:47], v[28:31], a[92:95], v[44:47]
    v_mfma_f32_16x16x32_bf16 v[32:35], v[0:3], a[96:99], 0
    v_mfma_f32_16x16x32_bf16 v[36:39], v[16:19], a[96:99], 0
    v_mfma_f32_16x16x32_bf16 v[32:35], v[4:7], a[100:103], v[32:35]
    v_cvt_pk_bf16_f32 v52, v40, v41
    v_cvt_pk_bf16_f32 v53, v42, v43
    v_mfma_f32_16x16x32_bf16 v[36:39], v[20:23], a[100:103], v[36:39]
    v_cvt_pk_bf16_f32 v54, v44, v45
    v_cvt_pk_bf16_f32 v55, v46, v47
    v_mfma_f32_16x16x32_bf16 v[32:35], v[8:11], a[104:107], v[32:35]
    v_and_or_b32 v52, v52, -2, s49
    v_and_or_b32 v54, v54, -2, s49
    v_mfma_f32_16x16x32_bf16 v[36:39], v[24:27], a[104:107], v[36:39]
    buffer_store_dwordx4 v[52:55], v128, s[8:11], s20 offen sc1
    s_add_u32 s20, s20, 32768
    v_mfma_f32_16x16x32_bf16 v[32:35], v[12:15], a[108:111], v[32:35]
    v_mfma_f32_16x16x32_bf16 v[36:39], v[28:31], a[108:111], v[36:39]
    v_mfma_f32_16x16x32_bf16 v[40:43], v[0:3], a[112:115], 0
    v_mfma_f32_16x16x32_bf16 v[44:47], v[16:19], a[112:115], 0
    v_mfma_f32_16x16x32_bf16 v[40:43], v[4:7], a[116:119], v[40:43]
    v_cvt_pk_bf16_f32 v48, v32, v33
    v_cvt_pk_bf16_f32 v49, v34, v35
    v_mfma_f32_16x16x32_bf16 v[44:47], v[20:23], a[116:119], v[44:47]
    v_cvt_pk_bf16_f32 v50, v36, v37
    v_cvt_pk_bf16_f32 v51, v38, v39
    v_mfma_f32_16x16x32_bf16 v[40:43], v[8:11], a[120:123], v[40:43]
    v_and_or_b32 v48, v48, -2, s49
    v_and_or_b32 v50, v50, -2, s49
    v_mfma_f32_16x16x32_bf16 v[44:47], v[24:27], a[120:123], v[44:47]
    buffer_store_dwordx4 v[48:51], v128, s[8:11], s20 offen sc1
    s_add_u32 s20, s20, 32768
    v_mfma_f32_16x16x32_bf16 v[40:43], v[12:15], a[124:127], v[40:43]
    v_mfma_f32_16x16x32_bf16 v[44:47], v[28:31], a[124:127], v[44:47]
    s_nop 3
    v_cvt_pk_bf16_f32 v52, v40, v41
    v_cvt_pk_bf16_f32 v53, v42, v43
    s_nop 1
    v_cvt_pk_bf16_f32 v54, v44, v45
    v_cvt_pk_bf16_f32 v55, v46, v47
    v_and_or_b32 v52, v52, -2, s49
    v_and_or_b32 v54, v54, -2, s49
    buffer_store_dwordx4 v[52:55], v128, s[8:11], s20 offen sc1
    s_add_u32 s20, s20, 32768
    s_add_u32 s5, s5, 1
    s_mov_b32 s6, s66
    s_cmp_lt_u32 s6, 64
    s_cbranch_scc0 L2fin_122
    s_cmp_eq_u32 s70, 0
    s_cbranch_scc1 L2slow_107
    s_lshr_b32 s23, s58, 1
    s_add_u32 s23, s23, 67108864
    buffer_load_dwordx4 v[224:227], v128, s[8:11], s23 offen offset:0 sc1
    buffer_load_dwordx4 v[228:231], v128, s[8:11], s23 offen offset:1024 sc1
    buffer_load_dwordx4 v[232:235], v128, s[8:11], s23 offen offset:2048 sc1
    buffer_load_dwordx4 v[236:239], v128, s[8:11], s23 offen offset:3072 sc1
    s_lshr_b32 s21, s58, 2
    s_lshl_b32 s23, s55, 10
    s_add_u32 s21, s21, s23
    s_add_u32 s21, s21, 75497472
    buffer_load_dwordx2 v[240:241], v129, s[8:11], s21 offen sc1
    buffer_load_dwordx2 v[242:243], v129, s[8:11], s21 offen offset:512 sc1
    s_branch L2top_105
L2fin_122:
    s_lshl_b32 s71, s76, 15
    s_add_u32 s72, s73, 0
    buffer_load_dwordx4 v[32:35], v131, s[8:11], s72 offen sc1
    s_add_u32 s72, s73, 4096
    buffer_load_dwordx4 v[36:39], v131, s[8:11], s72 offen sc1
    s_add_u32 s72, s73, 8192
    buffer_load_dwordx4 v[40:43], v131, s[8:11], s72 offen sc1
    s_add_u32 s72, s73, 12288
    buffer_load_dwordx4 v[44:47], v131, s[8:11], s72 offen sc1
    s_add_u32 s72, s73, 16384
    buffer_load_dwordx4 v[48:51], v131, s[8:11], s72 offen sc1
    s_add_u32 s72, s73, 20480
    buffer_load_dwordx4 v[52:55], v131, s[8:11], s72 offen sc1
    s_add_u32 s72, s73, 24576
    buffer_load_dwordx4 v[56:59], v131, s[8:11], s72 offen sc1
    s_add_u32 s72, s73, 28672
    buffer_load_dwordx4 v[60:63], v131, s[8:11], s72 offen sc1
L2g0_123:
    v_mov_b32 v144, 0
    s_waitcnt vmcnt(7)
    v_mfma_f32_16x16x32_bf16 v[64:67], v[32:35], v[136:139], v[140:143]
    v_bitop3_b32 v144, v144, v32, s74 bitop3:0xf6
    v_bitop3_b32 v144, v144, v34, s74 bitop3:0xf6
    s_waitcnt vmcnt(6)
    v_mfma_f32_16x16x32_bf16 v[64:67], v[36:39], v[136:139], v[64:67]
    v_bitop3_b32 v144, v144, v36, s74 bitop3:0xf6
    v_bitop3_b32 v144, v144, v38, s74 bitop3:0xf6
    s_waitcnt vmcnt(5)
    v_mfma_f32_16x16x32_bf16 v[64:67], v[40:43], v[136:139], v[64:67]
    v_bitop3_b32 v144, v144, v40, s74 bitop3:0xf6
    v_bitop3_b32 v144, v144, v42, s74 bitop3:0xf6
    s_waitcnt vmcnt(4)
    v_mfma_f32_16x16x32_bf16 v[64:67], v[44:47], v[136:139], v[64:67]
    v_bitop3_b32 v144, v144, v44, s74 bitop3:0xf6
    v_bitop3_b32 v144, v144, v46, s74 bitop3:0xf6
    s_waitcnt vmcnt(3)
    v_mfma_f32_16x16x32_bf16 v[64:67], v[48:51], v[136:139], v[64:67]
    v_bitop3_b32 v144, v144, v48, s74 bitop3:0xf6
    v_bitop3_b32 v144, v144, v50, s74 bitop3:0xf6
    s_waitcnt vmcnt(2)
    v_mfma_f32_16x16x32_bf16 v[64:67], v[52:55], v[136:139], v[64:67]
    v_bitop3_b32 v144, v144, v52, s74 bitop3:0xf6
    v_bitop3_b32 v144, v144, v54, s74 bitop3:0xf6
    s_waitcnt vmcnt(1)
    v_mfma_f32_16x16x32_bf16 v[64:67], v[56:59], v[136:139], v[64:67]
    v_bitop3_b32 v144, v144, v56, s74 bitop3:0xf6
    v_bitop3_b32 v144, v144, v58, s74 bitop3:0xf6
    s_waitcnt vmcnt(0)
    v_mfma_f32_16x16x32_bf16 v[64:67], v[60:63], v[136:139], v[64:67]
    v_bitop3_b32 v144, v144, v60, s74 bitop3:0xf6
    v_bitop3_b32 v144, v144, v62, s74 bitop3:0xf6
    v_and_b32 v144, 1, v144
    v_cmp_ne_u32 vcc, 0, v144
    s_cbranch_vccnz L2gr_124
L2go_125:
    s_nop 2
    v_cvt_pk_bf16_f32 v68, v64, v65
    v_cvt_pk_bf16_f32 v69, v66, v67
    buffer_store_dwordx2 v[68:69], v133, s[28:31], s71 offen
    s_nop 0
    s_branch L2end_106
L2gr_118:
    s_add_u32 s51, s51, 1
    s_cmp_gt_u32 s51, 100000000
    s_cbranch_scc1 L2go_119
    s_add_u32 s72, s73, 0
    buffer_load_dwordx4 v[32:35], v131, s[8:11], s72 offen sc1
    s_add_u32 s72, s73, 4096
    buffer_load_dwordx4 v[36:39], v131, s[8:11], s72 offen sc1
    s_add_u32 s72, s73, 8192
    buffer_load_dwordx4 v[40:43], v131, s[8:11], s72 offen sc1
    s_add_u32 s72, s73, 12288
    buffer_load_dwordx4 v[44:47], v131, s[8:11], s72 offen sc1
    s_add_u32 s72, s73, 16384
    buffer_load_dwordx4 v[48:51], v131, s[8:11], s72 offen sc1
    s_add_u32 s72, s73, 20480
    buffer_load_dwordx4 v[52:55], v131, s[8:11], s72 offen sc1
    s_add_u32 s72, s73, 24576
    buffer_load_dwordx4 v[56:59], v131, s[8:11], s72 offen sc1
    s_add_u32 s72, s73, 28672
    buffer_load_dwordx4 v[60:63], v131, s[8:11], s72 offen sc1
    s_waitcnt vmcnt(0)
    s_branch L2g0_117
L2gr_124:
    s_add_u32 s51, s51, 1
    s_cmp_gt_u32 s51, 100000000
    s_cbranch_scc1 L2go_125
    s_add_u32 s72, s73, 0
    buffer_load_dwordx4 v[32:35], v131, s[8:11], s72 offen sc1
    s_add_u32 s72, s73, 4096
    buffer_load_dwordx4 v[36:39], v131, s[8:11], s72 offen sc1
    s_add_u32 s72, s73, 8192
    buffer_load_dwordx4 v[40:43], v131, s[8:11], s72 offen sc1
    s_add_u32 s72, s73, 12288
    buffer_load_dwordx4 v[44:47], v131, s[8:11], s72 offen sc1
    s_add_u32 s72, s73, 16384
    buffer_load_dwordx4 v[48:51], v131, s[8:11], s72 offen sc1
    s_add_u32 s72, s73, 20480
    buffer_load_dwordx4 v[52:55], v131, s[8:11], s72 offen sc1
    s_add_u32 s72, s73, 24576
    buffer_load_dwordx4 v[56:59], v131, s[8:11], s72 offen sc1
    s_add_u32 s72, s73, 28672
    buffer_load_dwordx4 v[60:63], v131, s[8:11], s72 offen sc1
    s_waitcnt vmcnt(0)
    s_branch L2g0_123
L2mr_108:
    s_add_u32 s51, s51, 1
    s_cmp_gt_u32 s51, 100000000
    s_cbranch_scc1 L2mo_110
    s_sleep 2
    s_lshr_b32 s23, s58, 1
    s_add_u32 s23, s23, 67108864
    buffer_load_dwordx4 v[224:227], v128, s[8:11], s23 offen offset:0 sc1
    buffer_load_dwordx4 v[228:231], v128, s[8:11], s23 offen offset:1024 sc1
    buffer_load_dwordx4 v[232:235], v128, s[8:11], s23 offen offset:2048 sc1
    buffer_load_dwordx4 v[236:239], v128, s[8:11], s23 offen offset:3072 sc1
    s_lshr_b32 s21, s58, 2
    s_lshl_b32 s23, s55, 10
    s_add_u32 s21, s21, s23
    s_add_u32 s21, s21, 75497472
    buffer_load_dwordx2 v[240:241], v129, s[8:11], s21 offen sc1
    buffer_load_dwordx2 v[242:243], v129, s[8:11], s21 offen offset:512 sc1
    s_branch L2mc_109
L2end_106:
    s_branch Lm_exit
Lm_wloop:
    s_mov_b32 s16, s78
    s_and_b32 s17, s79, 0xffff
    s_mov_b32 s18, 256
    s_mov_b32 s19, 0x20000
    s_waitcnt lgkmcnt(0)
    s_barrier
    s_mov_b32 s94, 255
    s_cmp_lg_u32 s3, 0
    s_cbranch_scc1 Lm_w1
Lm_w0:
    s_memrealtime s[80:81]
    s_waitcnt lgkmcnt(0)
    s_sub_u32 s92, s80, s100
    s_mov_b32 s94, 255
    s_cmp_lt_u32 s92, 3000
    s_cselect_b32 s89, 1, 0
    s_cmp_eq_u32 s89, 1
    s_cselect_b32 s88, s91, 1
    s_andn2_b32 s88, s88, s84
    s_cmp_eq_u32 s88, 0
    s_cbranch_scc1 Lm_w1
    buffer_load_dword v244, off, s[16:19], 0 offset:0 sc1
    buffer_load_dword v245, off, s[16:19], 0 offset:12 sc1
    buffer_load_dword v246, off, s[16:19], 0 offset:24 sc1
    s_waitcnt vmcnt(0)
    v_readfirstlane_b32 s85, v244
    v_readfirstlane_b32 s86, v245
    v_readfirstlane_b32 s87, v246
    s_nop 3
    s_cmp_lt_u32 s87, 32
    s_cselect_b32 s94, 2, s94
    s_cmp_lt_u32 s86, 32
    s_cselect_b32 s94, 1, s94
    s_cmp_lt_u32 s85, 32
    s_cselect_b32 s94, 0, s94
    s_cmp_eq_u32 s94, 255
    s_cselect_b32 s84, 1, 0
    s_cbranch_scc1 Lm_w1
    s_cmp_eq_u32 s89, 0
    s_cbranch_scc1 Lm_w1
    s_sleep 16
    s_branch Lm_w0
Lm_w1:
    v_mov_b32 v252, s94
    v_mov_b32 v251, 162304
    s_cmp_lg_u32 s3, 0
    s_cbranch_scc1 Lb_126
    s_mov_b64 exec, 1
    s_waitcnt vmcnt(0)
    ds_write_b32 v251, v252
    s_waitcnt lgkmcnt(0)
    s_mov_b64 exec, -1
Lb_126:
    s_barrier
    ds_read_b32 v250, v251
    s_waitcnt lgkmcnt(0)
    v_readfirstlane_b32 s93, v250
    s_nop 3
    s_cmp_eq_u32 s93, 255
    s_cselect_b32 s88, s91, 0
    s_cmp_eq_u32 s88, 1
    s_cbranch_scc1 Lm_wexit
    s_mul_i32 s96, s93, 12
    s_add_u32 s96, s96, 0
    s_lshl_b32 s95, s42, 2
    s_add_u32 s95, s95, 40
    s_cmp_eq_u32 s93, 255
    s_cselect_b32 s96, s95, s96
    s_barrier
    v_mov_b32 v252, 1
    s_cmp_lg_u32 s3, 0
    s_cbranch_scc1 La_127
    s_mov_b64 exec, 1
    buffer_atomic_add v252, off, s[16:19], s96 sc0
    s_mov_b64 exec, -1
La_127:
    v_mov_b32 v251, 162304
    s_cmp_lg_u32 s3, 0
    s_cbranch_scc1 Lb_128
    s_mov_b64 exec, 1
    s_waitcnt vmcnt(0)
    ds_write_b32 v251, v252
    s_waitcnt lgkmcnt(0)
    s_mov_b64 exec, -1
Lb_128:
    s_barrier
    ds_read_b32 v250, v251
    s_waitcnt lgkmcnt(0)
    v_readfirstlane_b32 s4, v250
    s_nop 3
    s_mov_b32 s92, s4
    s_cmp_lg_u32 s93, 255
    s_cbranch_scc1 Lm_got
Lm_wtask:
    v_and_b32 v244, 63, v253
    v_lshlrev_b32 v242, 4, v244
    s_lshl_b32 s28, s3, 10
    s_cmp_lt_u32 s92, 128
    s_cbranch_scc1 Lm_wt2
    s_add_u32 s42, s42, 1
    s_cmp_ge_u32 s42, 5
    s_cselect_b32 s42, 0, s42
    s_add_u32 s43, s43, 1
    s_cmp_ge_u32 s43, 5
    s_cselect_b32 s91, 1, 0
    s_branch Lm_wloop
Lm_wt2:
    s_lshr_b32 s4, s92, 3
    s_and_b32 s93, s92, 7
    s_mul_i32 s93, s93, 5
    s_add_u32 s5, s93, s42
    s_cmp_ge_u32 s5, 39
    s_cbranch_scc1 Lm_wloop
    s_cmp_ge_u32 s5, 32
    s_cbranch_scc1 Lm_ffn
    s_lshl_b32 s92, s4, 5
    s_add_u32 s92, s92, s5
    s_lshl_b32 s92, s92, 2
    s_add_u32 s92, s92, 131072000
    v_lshrrev_b32 v244, 4, v242
    v_bfe_u32 v245, v244, 2, 2
    v_lshrrev_b32 v246, 4, v244
    v_lshl_add_u32 v247, v246, 3, v245
    v_lshlrev_b32 v247, 8, v247
    v_and_b32 v244, 3, v244
    v_lshl_add_u32 v247, v244, 3, v247
    v_and_b32 v246, 1, v246
    v_lshl_add_u32 v245, v246, 2, v245
    v_lshl_add_u32 v232, v245, 5, v247
    v_xor_b32 v233, 32, v232
    v_xor_b32 v234, 64, v232
    v_xor_b32 v235, 96, v232
    v_xor_b32 v236, 128, v232
    v_xor_b32 v237, 160, v232
    v_xor_b32 v238, 192, v232
    v_xor_b32 v239, 224, v232
    v_add_u32 v224, 0x10000, v232
    v_add_u32 v225, 0x10000, v233
    v_add_u32 v226, 0x10000, v234
    v_add_u32 v227, 0x10000, v235
    v_add_u32 v228, 0x10000, v236
    v_add_u32 v229, 0x10000, v237
    v_add_u32 v230, 0x10000, v238
    v_add_u32 v231, 0x10000, v239
    v_lshrrev_b32 v244, 8, v242
    v_bfe_u32 v245, v242, 4, 4
    s_lshr_b32 s20, s3, 1
    s_lshl_b32 s20, s20, 2
    v_or_b32 v246, s20, v244
    v_lshlrev_b32 v246, 1, v246
    v_xor_b32 v245, v245, v246
    v_lshlrev_b32 v245, 4, v245
    s_lshl_b32 s20, s3, 2
    v_add_u32 v244, s20, v244
    v_lshl_add_u32 v240, v244, 13, v245
    s_lshl_b32 s20, s5, 8
    v_add_u32 v240, s20, v240
    s_load_dwordx2 s[32:33], s[0:1], 32
    s_load_dwordx2 s[34:35], s[0:1], 24
    s_load_dwordx2 s[36:37], s[0:1], 16
    s_waitcnt lgkmcnt(0)
    s_mov_b32 s12, s32
    s_and_b32 s13, s33, 0xffff
    s_mov_b32 s14, 4194304
    s_mov_b32 s15, 0x20000
    s_mov_b32 s16, s34
    s_and_b32 s17, s35, 0xffff
    s_mov_b32 s18, 4194304
    s_mov_b32 s19, 0x20000
    s_lshl_b32 s30, s4, 2
    s_add_u32 s30, s30, s3
    s_lshl_b32 s30, s30, 5
    s_add_u32 s30, s30, s5
    s_lshl_b32 s30, s30, 13
    s_add_u32 s30, s30, 50331648
    s_add_u32 m0, s28, 0
    s_mov_b32 s29, 0
    buffer_load_dwordx4 v240, s[12:15], s29 offen lds
    s_add_u32 m0, s28, 4096
    s_mov_b32 s29, 131072
    buffer_load_dwordx4 v240, s[12:15], s29 offen lds
    s_add_u32 m0, s28, 8192
    s_mov_b32 s29, 262144
    buffer_load_dwordx4 v240, s[12:15], s29 offen lds
    s_add_u32 m0, s28, 12288
    s_mov_b32 s29, 393216
    buffer_load_dwordx4 v240, s[12:15], s29 offen lds
    s_add_u32 m0, s28, 16384
    s_mov_b32 s29, 524288
    buffer_load_dwordx4 v240, s[12:15], s29 offen lds
    s_add_u32 m0, s28, 20480
    s_mov_b32 s29, 655360
    buffer_load_dwordx4 v240, s[12:15], s29 offen lds
    s_add_u32 m0, s28, 24576
    s_mov_b32 s29, 786432
    buffer_load_dwordx4 v240, s[12:15], s29 offen lds
    s_add_u32 m0, s28, 28672
    s_mov_b32 s29, 917504
    buffer_load_dwordx4 v240, s[12:15], s29 offen lds
    s_add_u32 m0, s28, 32768
    s_mov_b32 s29, 1048576
    buffer_load_dwordx4 v240, s[12:15], s29 offen lds
    s_add_u32 m0, s28, 36864
    s_mov_b32 s29, 1179648
    buffer_load_dwordx4 v240, s[12:15], s29 offen lds
    s_add_u32 m0, s28, 40960
    s_mov_b32 s29, 1310720
    buffer_load_dwordx4 v240, s[12:15], s29 offen lds
    s_add_u32 m0, s28, 45056
    s_mov_b32 s29, 1441792
    buffer_load_dwordx4 v240, s[12:15], s29 offen lds
    s_add_u32 m0, s28, 49152
    s_mov_b32 s29, 1572864
    buffer_load_dwordx4 v240, s[12:15], s29 offen lds
    s_add_u32 m0, s28, 53248
    s_mov_b32 s29, 1703936
    buffer_load_dwordx4 v240, s[12:15], s29 offen lds
    s_add_u32 m0, s28, 57344
    s_mov_b32 s29, 1835008
    buffer_load_dwordx4 v240, s[12:15], s29 offen lds
    s_add_u32 m0, s28, 61440
    s_mov_b32 s29, 1966080
    buffer_load_dwordx4 v240, s[12:15], s29 offen lds
    s_add_u32 m0, s28, 65536
    s_mov_b32 s29, 2097152
    buffer_load_dwordx4 v240, s[12:15], s29 offen lds
    s_add_u32 m0, s28, 69632
    s_mov_b32 s29, 2228224
    buffer_load_dwordx4 v240, s[12:15], s29 offen lds
    s_add_u32 m0, s28, 73728
    s_mov_b32 s29, 2359296
    buffer_load_dwordx4 v240, s[12:15], s29 offen lds
    s_add_u32 m0, s28, 77824
    s_mov_b32 s29, 2490368
    buffer_load_dwordx4 v240, s[12:15], s29 offen lds
    s_add_u32 m0, s28, 81920
    s_mov_b32 s29, 2621440
    buffer_load_dwordx4 v240, s[12:15], s29 offen lds
    s_add_u32 m0, s28, 86016
    s_mov_b32 s29, 2752512
    buffer_load_dwordx4 v240, s[12:15], s29 offen lds
    s_add_u32 m0, s28, 90112
    s_mov_b32 s29, 2883584
    buffer_load_dwordx4 v240, s[12:15], s29 offen lds
    s_add_u32 m0, s28, 94208
    s_mov_b32 s29, 3014656
    buffer_load_dwordx4 v240, s[12:15], s29 offen lds
    s_add_u32 m0, s28, 98304
    s_mov_b32 s29, 3145728
    buffer_load_dwordx4 v240, s[12:15], s29 offen lds
    s_add_u32 m0, s28, 102400
    s_mov_b32 s29, 3276800
    buffer_load_dwordx4 v240, s[12:15], s29 offen lds
    s_add_u32 m0, s28, 106496
    s_mov_b32 s29, 3407872
    buffer_load_dwordx4 v240, s[12:15], s29 offen lds
    s_add_u32 m0, s28, 110592
    s_mov_b32 s29, 3538944
    buffer_load_dwordx4 v240, s[12:15], s29 offen lds
    s_cmp_eq_u32 s83, 1
    s_cbranch_scc1 Lm_lnoka
    s_cmp_lg_u32 s3, 0
    s_cbranch_scc1 Lm_lnba
    s_mov_b32 s44, s78
    s_and_b32 s45, s79, 0xffff
    s_mov_b32 s46, 256
    s_mov_b32 s47, 0x20000
    s_mov_b32 s94, 0
    v_lshrrev_b32 v244, 2, v242
    v_and_b32 v244, 60, v244
    s_nop 1
Lm_lnwa:
    buffer_load_dword v245, v244, s[44:47], 0 offen offset:128 sc1
    s_waitcnt vmcnt(0)
    v_cmp_gt_u32 vcc, 16, v245
    s_add_u32 s94, s94, 1
    s_cmp_gt_u32 s94, 30000000
    s_cbranch_scc1 Lm_lnba
    s_cmp_eq_u32 vcc_lo, 0
    s_cselect_b32 s83, 1, 0
    s_lshr_b32 s95, vcc_lo, s4
    s_and_b32 s95, s95, 1
    s_cbranch_scc0 Lm_lnba
    s_sleep 8
    s_branch Lm_lnwa
Lm_lnba:
    v_mov_b32 v252, s83
    s_barrier
    v_mov_b32 v247, 162304
    s_cmp_lg_u32 s3, 0
    s_cbranch_scc1 Lm_lnca
    ds_write_b32 v247, v252
    s_waitcnt lgkmcnt(0)
Lm_lnca:
    s_barrier
    ds_read_b32 v246, v247
    s_waitcnt lgkmcnt(0)
    v_readfirstlane_b32 s83, v246
    s_nop 3
    s_nop 0
Lm_lnoka:
    s_lshl_b32 s20, s4, 2
    s_add_u32 s20, s20, s3
    s_lshl_b32 s20, s20, 15
    s_add_u32 s20, s20, 0
    buffer_load_dwordx4 v[0:3], v242, s[8:11], s20 offen offset:0 sc1
    buffer_load_dwordx4 v[4:7], v242, s[8:11], s20 offen offset:1024 sc1
    buffer_load_dwordx4 v[8:11], v242, s[8:11], s20 offen offset:2048 sc1
    buffer_load_dwordx4 v[12:15], v242, s[8:11], s20 offen offset:3072 sc1
    s_add_u32 s20, s20, 4096
    buffer_load_dwordx4 v[16:19], v242, s[8:11], s20 offen offset:0 sc1
    buffer_load_dwordx4 v[20:23], v242, s[8:11], s20 offen offset:1024 sc1
    buffer_load_dwordx4 v[24:27], v242, s[8:11], s20 offen offset:2048 sc1
    buffer_load_dwordx4 v[28:31], v242, s[8:11], s20 offen offset:3072 sc1
    s_add_u32 s20, s20, 4096
    buffer_load_dwordx4 v[32:35], v242, s[8:11], s20 offen offset:0 sc1
    buffer_load_dwordx4 v[36:39], v242, s[8:11], s20 offen offset:1024 sc1
    buffer_load_dwordx4 v[40:43], v242, s[8:11], s20 offen offset:2048 sc1
    buffer_load_dwordx4 v[44:47], v242, s[8:11], s20 offen offset:3072 sc1
    s_add_u32 s20, s20, 4096
    buffer_load_dwordx4 v[48:51], v242, s[8:11], s20 offen offset:0 sc1
    buffer_load_dwordx4 v[52:55], v242, s[8:11], s20 offen offset:1024 sc1
    buffer_load_dwordx4 v[56:59], v242, s[8:11], s20 offen offset:2048 sc1
    buffer_load_dwordx4 v[60:63], v242, s[8:11], s20 offen offset:3072 sc1
    s_add_u32 s20, s20, 4096
    buffer_load_dwordx4 v[64:67], v242, s[8:11], s20 offen offset:0 sc1
    buffer_load_dwordx4 v[68:71], v242, s[8:11], s20 offen offset:1024 sc1
    buffer_load_dwordx4 v[72:75], v242, s[8:11], s20 offen offset:2048 sc1
    buffer_load_dwordx4 v[76:79], v242, s[8:11], s20 offen offset:3072 sc1
    s_add_u32 s20, s20, 4096
    buffer_load_dwordx4 v[80:83], v242, s[8:11], s20 offen offset:0 sc1
    buffer_load_dwordx4 v[84:87], v242, s[8:11], s20 offen offset:1024 sc1
    buffer_load_dwordx4 v[88:91], v242, s[8:11], s20 offen offset:2048 sc1
    buffer_load_dwordx4 v[92:95], v242, s[8:11], s20 offen offset:3072 sc1
    s_add_u32 s20, s20, 4096
    buffer_load_dwordx4 v[96:99], v242, s[8:11], s20 offen offset:0 sc1
    buffer_load_dwordx4 v[100:103], v242, s[8:11], s20 offen offset:1024 sc1
    buffer_load_dwordx4 v[104:107], v242, s[8:11], s20 offen offset:2048 sc1
    buffer_load_dwordx4 v[108:111], v242, s[8:11], s20 offen offset:3072 sc1
    s_add_u32 s20, s20, 4096
    buffer_load_dwordx4 v[112:115], v242, s[8:11], s20 offen offset:0 sc1
    buffer_load_dwordx4 v[116:119], v242, s[8:11], s20 offen offset:1024 sc1
    buffer_load_dwordx4 v[120:123], v242, s[8:11], s20 offen offset:2048 sc1
    buffer_load_dwordx4 v[124:127], v242, s[8:11], s20 offen offset:3072 sc1
    s_waitcnt vmcnt(56)
    s_barrier
    ds_read_b64_tr_b16 v[192:193], v232 offset:0
    ds_read_b64_tr_b16 v[194:195], v232 offset:1024
    ds_read_b64_tr_b16 v[196:197], v233 offset:0
    ds_read_b64_tr_b16 v[198:199], v233 offset:1024
    ds_read_b64_tr_b16 v[200:201], v234 offset:0
    ds_read_b64_tr_b16 v[202:203], v234 offset:1024
    ds_read_b64_tr_b16 v[204:205], v235 offset:0
    ds_read_b64_tr_b16 v[206:207], v235 offset:1024
    s_waitcnt vmcnt(31) lgkmcnt(6)
    v_mfma_f32_16x16x32_bf16 v[128:131], v[0:3], v[192:195], 0
    ds_read_b64_tr_b16 v[208:209], v236 offset:0
    ds_read_b64_tr_b16 v[210:211], v236 offset:1024
    s_waitcnt vmcnt(15)
    v_mfma_f32_16x16x32_bf16 v[132:135], v[64:67], v[192:195], 0
    s_waitcnt lgkmcnt(6)
    v_mfma_f32_16x16x32_bf16 v[136:139], v[0:3], v[196:199], 0
    ds_read_b64_tr_b16 v[212:213], v237 offset:0
    ds_read_b64_tr_b16 v[214:215], v237 offset:1024
    v_mfma_f32_16x16x32_bf16 v[140:143], v[64:67], v[196:199], 0
    s_waitcnt lgkmcnt(6)
    v_mfma_f32_16x16x32_bf16 v[144:147], v[0:3], v[200:203], 0
    ds_read_b64_tr_b16 v[192:193], v238 offset:0
    ds_read_b64_tr_b16 v[194:195], v238 offset:1024
    v_mfma_f32_16x16x32_bf16 v[148:151], v[64:67], v[200:203], 0
    s_barrier
    s_waitcnt lgkmcnt(6)
    v_mfma_f32_16x16x32_bf16 v[152:155], v[0:3], v[204:207], 0
    ds_read_b64_tr_b16 v[196:197], v239 offset:0
    ds_read_b64_tr_b16 v[198:199], v239 offset:1024
    v_mfma_f32_16x16x32_bf16 v[156:159], v[64:67], v[204:207], 0
    s_waitcnt lgkmcnt(6)
    v_mfma_f32_16x16x32_bf16 v[160:163], v[0:3], v[208:211], 0
    ds_read_b64_tr_b16 v[200:201], v232 offset:8192
    ds_read_b64_tr_b16 v[202:203], v232 offset:9216
    v_mfma_f32_16x16x32_bf16 v[164:167], v[64:67], v[208:211], 0
    s_add_u32 m0, s28, 114688
    s_mov_b32 s29, 3670016
    buffer_load_dwordx4 v240, s[12:15], s29 offen lds
    s_waitcnt lgkmcnt(6)
    v_mfma_f32_16x16x32_bf16 v[168:171], v[0:3], v[212:215], 0
    ds_read_b64_tr_b16 v[204:205], v233 offset:8192
    ds_read_b64_tr_b16 v[206:207], v233 offset:9216
    v_mfma_f32_16x16x32_bf16 v[172:175], v[64:67], v[212:215], 0
    s_waitcnt lgkmcnt(6)
    v_mfma_f32_16x16x32_bf16 v[176:179], v[0:3], v[192:195], 0
    ds_read_b64_tr_b16 v[208:209], v234 offset:8192
    ds_read_b64_tr_b16 v[210:211], v234 offset:9216
    v_mfma_f32_16x16x32_bf16 v[180:183], v[64:67], v[192:195], 0
    s_add_u32 m0, s28, 118784
    s_mov_b32 s29, 3801088
    buffer_load_dwordx4 v240, s[12:15], s29 offen lds
    s_waitcnt lgkmcnt(6)
    v_mfma_f32_16x16x32_bf16 v[184:187], v[0:3], v[196:199], 0
    ds_read_b64_tr_b16 v[212:213], v235 offset:8192
    ds_read_b64_tr_b16 v[214:215], v235 offset:9216
    v_mfma_f32_16x16x32_bf16 v[188:191], v[64:67], v[196:199], 0
    s_waitcnt lgkmcnt(6)
    v_mfma_f32_16x16x32_bf16 v[128:131], v[4:7], v[200:203], v[128:131]
    ds_read_b64_tr_b16 v[192:193], v236 offset:8192
    ds_read_b64_tr_b16 v[194:195], v236 offset:9216
    s_waitcnt vmcnt(16)
    v_mfma_f32_16x16x32_bf16 v[132:135], v[68:71], v[200:203], v[132:135]
    s_add_u32 m0, s28, 122880
    s_mov_b32 s29, 3932160
    buffer_load_dwordx4 v240, s[12:15], s29 offen lds
    s_waitcnt lgkmcnt(6)
    v_mfma_f32_16x16x32_bf16 v[136:139], v[4:7], v[204:207], v[136:139]
    ds_read_b64_tr_b16 v[196:197], v237 offset:8192
    ds_read_b64_tr_b16 v[198:199], v237 offset:9216
    v_mfma_f32_16x16x32_bf16 v[140:143], v[68:71], v[204:207], v[140:143]
    s_waitcnt lgkmcnt(6)
    v_mfma_f32_16x16x32_bf16 v[144:147], v[4:7], v[208:211], v[144:147]
    ds_read_b64_tr_b16 v[200:201], v238 offset:8192
    ds_read_b64_tr_b16 v[202:203], v238 offset:9216
    v_mfma_f32_16x16x32_bf16 v[148:151], v[68:71], v[208:211], v[148:151]
    s_add_u32 m0, s28, 126976
    s_mov_b32 s29, 4063232
    buffer_load_dwordx4 v240, s[12:15], s29 offen lds
    s_waitcnt lgkmcnt(6)
    v_mfma_f32_16x16x32_bf16 v[152:155], v[4:7], v[212:215], v[152:155]
    ds_read_b64_tr_b16 v[204:205], v239 offset:8192
    ds_read_b64_tr_b16 v[206:207], v239 offset:9216
    v_mfma_f32_16x16x32_bf16 v[156:159], v[68:71], v[212:215], v[156:159]
    s_waitcnt lgkmcnt(6)
    v_mfma_f32_16x16x32_bf16 v[160:163], v[4:7], v[192:195], v[160:163]
    ds_read_b64_tr_b16 v[208:209], v232 offset:16384
    ds_read_b64_tr_b16 v[210:211], v232 offset:17408
    v_mfma_f32_16x16x32_bf16 v[164:167], v[68:71], v[192:195], v[164:167]
    s_waitcnt lgkmcnt(6)
    v_mfma_f32_16x16x32_bf16 v[168:171], v[4:7], v[196:199], v[168:171]
    ds_read_b64_tr_b16 v[212:213], v233 offset:16384
    ds_read_b64_tr_b16 v[214:215], v233 offset:17408
    v_mfma_f32_16x16x32_bf16 v[172:175], v[68:71], v[196:199], v[172:175]
    s_waitcnt lgkmcnt(6)
    v_mfma_f32_16x16x32_bf16 v[176:179], v[4:7], v[200:203], v[176:179]
    ds_read_b64_tr_b16 v[192:193], v234 offset:16384
    ds_read_b64_tr_b16 v[194:195], v234 offset:17408
    v_mfma_f32_16x16x32_bf16 v[180:183], v[68:71], v[200:203], v[180:183]
    s_waitcnt lgkmcnt(6)
    v_mfma_f32_16x16x32_bf16 v[184:187], v[4:7], v[204:207], v[184:187]
    ds_read_b64_tr_b16 v[196:197], v235 offset:16384
    ds_read_b64_tr_b16 v[198:199], v235 offset:17408
    v_mfma_f32_16x16x32_bf16 v[188:191], v[68:71], v[204:207], v[188:191]
    s_waitcnt lgkmcnt(6)
    v_mfma_f32_16x16x32_bf16 v[128:131], v[8:11], v[208:211], v[128:131]
    ds_read_b64_tr_b16 v[200:201], v236 offset:16384
    ds_read_b64_tr_b16 v[202:203], v236 offset:17408
    s_waitcnt vmcnt(17)
    v_mfma_f32_16x16x32_bf16 v[132:135], v[72:75], v[208:211], v[132:135]
    s_waitcnt lgkmcnt(6)
    v_mfma_f32_16x16x32_bf16 v[136:139], v[8:11], v[212:215], v[136:139]
    ds_read_b64_tr_b16 v[204:205], v237 offset:16384
    ds_read_b64_tr_b16 v[206:207], v237 offset:17408
    v_mfma_f32_16x16x32_bf16 v[140:143], v[72:75], v[212:215], v[140:143]
    s_waitcnt lgkmcnt(6)
    v_mfma_f32_16x16x32_bf16 v[144:147], v[8:11], v[192:195], v[144:147]
    ds_read_b64_tr_b16 v[208:209], v238 offset:16384
    ds_read_b64_tr_b16 v[210:211], v238 offset:17408
    v_mfma_f32_16x16x32_bf16 v[148:151], v[72:75], v[192:195], v[148:151]
    s_barrier
    s_waitcnt lgkmcnt(6)
    v_mfma_f32_16x16x32_bf16 v[152:155], v[8:11], v[196:199], v[152:155]
    ds_read_b64_tr_b16 v[212:213], v239 offset:16384
    ds_read_b64_tr_b16 v[214:215], v239 offset:17408
    v_mfma_f32_16x16x32_bf16 v[156:159], v[72:75], v[196:199], v[156:159]
    s_waitcnt lgkmcnt(6)
    v_mfma_f32_16x16x32_bf16 v[160:163], v[8:11], v[200:203], v[160:163]
    ds_read_b64_tr_b16 v[192:193], v232 offset:24576
    ds_read_b64_tr_b16 v[194:195], v232 offset:25600
    v_mfma_f32_16x16x32_bf16 v[164:167], v[72:75], v[200:203], v[164:167]
    s_add_u32 m0, s28, 0
    s_mov_b32 s29, 0
    buffer_load_dwordx4 v240, s[16:19], s29 offen lds
    s_waitcnt lgkmcnt(6)
    v_mfma_f32_16x16x32_bf16 v[168:171], v[8:11], v[204:207], v[168:171]
    ds_read_b64_tr_b16 v[196:197], v233 offset:24576
    ds_read_b64_tr_b16 v[198:199], v233 offset:25600
    v_mfma_f32_16x16x32_bf16 v[172:175], v[72:75], v[204:207], v[172:175]
    s_waitcnt lgkmcnt(6)
    v_mfma_f32_16x16x32_bf16 v[176:179], v[8:11], v[208:211], v[176:179]
    ds_read_b64_tr_b16 v[200:201], v234 offset:24576
    ds_read_b64_tr_b16 v[202:203], v234 offset:25600
    v_mfma_f32_16x16x32_bf16 v[180:183], v[72:75], v[208:211], v[180:183]
    s_add_u32 m0, s28, 4096
    s_mov_b32 s29, 131072
    buffer_load_dwordx4 v240, s[16:19], s29 offen lds
    s_waitcnt lgkmcnt(6)
    v_mfma_f32_16x16x32_bf16 v[184:187], v[8:11], v[212:215], v[184:187]
    ds_read_b64_tr_b16 v[204:205], v235 offset:24576
    ds_read_b64_tr_b16 v[206:207], v235 offset:25600
    v_mfma_f32_16x16x32_bf16 v[188:191], v[72:75], v[212:215], v[188:191]
    s_waitcnt lgkmcnt(6)
    v_mfma_f32_16x16x32_bf16 v[128:131], v[12:15], v[192:195], v[128:131]
    ds_read_b64_tr_b16 v[208:209], v236 offset:24576
    ds_read_b64_tr_b16 v[210:211], v236 offset:25600
    s_waitcnt vmcnt(18)
    v_mfma_f32_16x16x32_bf16 v[132:135], v[76:79], v[192:195], v[132:135]
    s_add_u32 m0, s28, 8192
    s_mov_b32 s29, 262144
    buffer_load_dwordx4 v240, s[16:19], s29 offen lds
    s_waitcnt lgkmcnt(6)
    v_mfma_f32_16x16x32_bf16 v[136:139], v[12:15], v[196:199], v[136:139]
    ds_read_b64_tr_b16 v[212:213], v237 offset:24576
    ds_read_b64_tr_b16 v[214:215], v237 offset:25600
    v_mfma_f32_16x16x32_bf16 v[140:143], v[76:79], v[196:199], v[140:143]
    s_waitcnt lgkmcnt(6)
    v_mfma_f32_16x16x32_bf16 v[144:147], v[12:15], v[200:203], v[144:147]
    ds_read_b64_tr_b16 v[192:193], v238 offset:24576
    ds_read_b64_tr_b16 v[194:195], v238 offset:25600
    v_mfma_f32_16x16x32_bf16 v[148:151], v[76:79], v[200:203], v[148:151]
    s_add_u32 m0, s28, 12288
    s_mov_b32 s29, 393216
    buffer_load_dwordx4 v240, s[16:19], s29 offen lds
    s_waitcnt lgkmcnt(6)
    v_mfma_f32_16x16x32_bf16 v[152:155], v[12:15], v[204:207], v[152:155]
    ds_read_b64_tr_b16 v[196:197], v239 offset:24576
    ds_read_b64_tr_b16 v[198:199], v239 offset:25600
    v_mfma_f32_16x16x32_bf16 v[156:159], v[76:79], v[204:207], v[156:159]
    s_waitcnt lgkmcnt(6)
    v_mfma_f32_16x16x32_bf16 v[160:163], v[12:15], v[208:211], v[160:163]
    ds_read_b64_tr_b16 v[200:201], v232 offset:32768
    ds_read_b64_tr_b16 v[202:203], v232 offset:33792
    v_mfma_f32_16x16x32_bf16 v[164:167], v[76:79], v[208:211], v[164:167]
    s_waitcnt lgkmcnt(6)
    v_mfma_f32_16x16x32_bf16 v[168:171], v[12:15], v[212:215], v[168:171]
    ds_read_b64_tr_b16 v[204:205], v233 offset:32768
    ds_read_b64_tr_b16 v[206:207], v233 offset:33792
    v_mfma_f32_16x16x32_bf16 v[172:175], v[76:79], v[212:215], v[172:175]
    s_waitcnt lgkmcnt(6)
    v_mfma_f32_16x16x32_bf16 v[176:179], v[12:15], v[192:195], v[176:179]
    ds_read_b64_tr_b16 v[208:209], v234 offset:32768
    ds_read_b64_tr_b16 v[210:211], v234 offset:33792
    v_mfma_f32_16x16x32_bf16 v[180:183], v[76:79], v[192:195], v[180:183]
    s_waitcnt lgkmcnt(6)
    v_mfma_f32_16x16x32_bf16 v[184:187], v[12:15], v[196:199], v[184:187]
    ds_read_b64_tr_b16 v[212:213], v235 offset:32768
    ds_read_b64_tr_b16 v[214:215], v235 offset:33792
    v_mfma_f32_16x16x32_bf16 v[188:191], v[76:79], v[196:199], v[188:191]
    s_waitcnt lgkmcnt(6)
    v_mfma_f32_16x16x32_bf16 v[128:131], v[16:19], v[200:203], v[128:131]
    ds_read_b64_tr_b16 v[192:193], v236 offset:32768
    ds_read_b64_tr_b16 v[194:195], v236 offset:33792
    s_waitcnt vmcnt(19)
    v_mfma_f32_16x16x32_bf16 v[132:135], v[80:83], v[200:203], v[132:135]
    s_waitcnt lgkmcnt(6)
    v_mfma_f32_16x16x32_bf16 v[136:139], v[16:19], v[204:207], v[136:139]
    ds_read_b64_tr_b16 v[196:197], v237 offset:32768
    ds_read_b64_tr_b16 v[198:199], v237 offset:33792
    v_mfma_f32_16x16x32_bf16 v[140:143], v[80:83], v[204:207], v[140:143]
    s_waitcnt lgkmcnt(6)
    v_mfma_f32_16x16x32_bf16 v[144:147], v[16:19], v[208:211], v[144:147]
    ds_read_b64_tr_b16 v[200:201], v238 offset:32768
    ds_read_b64_tr_b16 v[202:203], v238 offset:33792
    v_mfma_f32_16x16x32_bf16 v[148:151], v[80:83], v[208:211], v[148:151]
    s_barrier
    s_waitcnt lgkmcnt(6)
    v_mfma_f32_16x16x32_bf16 v[152:155], v[16:19], v[212:215], v[152:155]
    ds_read_b64_tr_b16 v[204:205], v239 offset:32768
    ds_read_b64_tr_b16 v[206:207], v239 offset:33792
    v_mfma_f32_16x16x32_bf16 v[156:159], v[80:83], v[212:215], v[156:159]
    s_waitcnt lgkmcnt(6)
    v_mfma_f32_16x16x32_bf16 v[160:163], v[16:19], v[192:195], v[160:163]
    ds_read_b64_tr_b16 v[208:209], v232 offset:40960
    ds_read_b64_tr_b16 v[210:211], v232 offset:41984
    v_mfma_f32_16x16x32_bf16 v[164:167], v[80:83], v[192:195], v[164:167]
    s_add_u32 m0, s28, 16384
    s_mov_b32 s29, 524288
    buffer_load_dwordx4 v240, s[16:19], s29 offen lds
    s_waitcnt lgkmcnt(6)
    v_mfma_f32_16x16x32_bf16 v[168:171], v[16:19], v[196:199], v[168:171]
    ds_read_b64_tr_b16 v[212:213], v233 offset:40960
    ds_read_b64_tr_b16 v[214:215], v233 offset:41984
    v_mfma_f32_16x16x32_bf16 v[172:175], v[80:83], v[196:199], v[172:175]
    s_waitcnt lgkmcnt(6)
    v_mfma_f32_16x16x32_bf16 v[176:179], v[16:19], v[200:203], v[176:179]
    ds_read_b64_tr_b16 v[192:193], v234 offset:40960
    ds_read_b64_tr_b16 v[194:195], v234 offset:41984
    v_mfma_f32_16x16x32_bf16 v[180:183], v[80:83], v[200:203], v[180:183]
    s_add_u32 m0, s28, 20480
    s_mov_b32 s29, 655360
    buffer_load_dwordx4 v240, s[16:19], s29 offen lds
    s_waitcnt lgkmcnt(6)
    v_mfma_f32_16x16x32_bf16 v[184:187], v[16:19], v[204:207], v[184:187]
    ds_read_b64_tr_b16 v[196:197], v235 offset:40960
    ds_read_b64_tr_b16 v[198:199], v235 offset:41984
    v_mfma_f32_16x16x32_bf16 v[188:191], v[80:83], v[204:207], v[188:191]
    s_waitcnt lgkmcnt(6)
    v_mfma_f32_16x16x32_bf16 v[128:131], v[20:23], v[208:211], v[128:131]
    ds_read_b64_tr_b16 v[200:201], v236 offset:40960
    ds_read_b64_tr_b16 v[202:203], v236 offset:41984
    s_waitcnt vmcnt(20)
    v_mfma_f32_16x16x32_bf16 v[132:135], v[84:87], v[208:211], v[132:135]
    s_add_u32 m0, s28, 24576
    s_mov_b32 s29, 786432
    buffer_load_dwordx4 v240, s[16:19], s29 offen lds
    s_waitcnt lgkmcnt(6)
    v_mfma_f32_16x16x32_bf16 v[136:139], v[20:23], v[212:215], v[136:139]
    ds_read_b64_tr_b16 v[204:205], v237 offset:40960
    ds_read_b64_tr_b16 v[206:207], v237 offset:41984
    v_mfma_f32_16x16x32_bf16 v[140:143], v[84:87], v[212:215], v[140:143]
    s_waitcnt lgkmcnt(6)
    v_mfma_f32_16x16x32_bf16 v[144:147], v[20:23], v[192:195], v[144:147]
    ds_read_b64_tr_b16 v[208:209], v238 offset:40960
    ds_read_b64_tr_b16 v[210:211], v238 offset:41984
    v_mfma_f32_16x16x32_bf16 v[148:151], v[84:87], v[192:195], v[148:151]
    s_add_u32 m0, s28, 28672
    s_mov_b32 s29, 917504
    buffer_load_dwordx4 v240, s[16:19], s29 offen lds
    s_waitcnt lgkmcnt(6)
    v_mfma_f32_16x16x32_bf16 v[152:155], v[20:23], v[196:199], v[152:155]
    ds_read_b64_tr_b16 v[212:213], v239 offset:40960
    ds_read_b64_tr_b16 v[214:215], v239 offset:41984
    v_mfma_f32_16x16x32_bf16 v[156:159], v[84:87], v[196:199], v[156:159]
    s_waitcnt lgkmcnt(6)
    v_mfma_f32_16x16x32_bf16 v[160:163], v[20:23], v[200:203], v[160:163]
    ds_read_b64_tr_b16 v[192:193], v232 offset:49152
    ds_read_b64_tr_b16 v[194:195], v232 offset:50176
    v_mfma_f32_16x16x32_bf16 v[164:167], v[84:87], v[200:203], v[164:167]
    s_waitcnt lgkmcnt(6)
    v_mfma_f32_16x16x32_bf16 v[168:171], v[20:23], v[204:207], v[168:171]
    ds_read_b64_tr_b16 v[196:197], v233 offset:49152
    ds_read_b64_tr_b16 v[198:199], v233 offset:50176
    v_mfma_f32_16x16x32_bf16 v[172:175], v[84:87], v[204:207], v[172:175]
    s_waitcnt lgkmcnt(6)
    v_mfma_f32_16x16x32_bf16 v[176:179], v[20:23], v[208:211], v[176:179]
    ds_read_b64_tr_b16 v[200:201], v234 offset:49152
    ds_read_b64_tr_b16 v[202:203], v234 offset:50176
    v_mfma_f32_16x16x32_bf16 v[180:183], v[84:87], v[208:211], v[180:183]
    s_waitcnt lgkmcnt(6)
    v_mfma_f32_16x16x32_bf16 v[184:187], v[20:23], v[212:215], v[184:187]
    ds_read_b64_tr_b16 v[204:205], v235 offset:49152
    ds_read_b64_tr_b16 v[206:207], v235 offset:50176
    v_mfma_f32_16x16x32_bf16 v[188:191], v[84:87], v[212:215], v[188:191]
    s_waitcnt lgkmcnt(6)
    v_mfma_f32_16x16x32_bf16 v[128:131], v[24:27], v[192:195], v[128:131]
    ds_read_b64_tr_b16 v[208:209], v236 offset:49152
    ds_read_b64_tr_b16 v[210:211], v236 offset:50176
    s_waitcnt vmcnt(21)
    v_mfma_f32_16x16x32_bf16 v[132:135], v[88:91], v[192:195], v[132:135]
    s_waitcnt lgkmcnt(6)
    v_mfma_f32_16x16x32_bf16 v[136:139], v[24:27], v[196:199], v[136:139]
    ds_read_b64_tr_b16 v[212:213], v237 offset:49152
    ds_read_b64_tr_b16 v[214:215], v237 offset:50176
    v_mfma_f32_16x16x32_bf16 v[140:143], v[88:91], v[196:199], v[140:143]
    s_waitcnt lgkmcnt(6)
    v_mfma_f32_16x16x32_bf16 v[144:147], v[24:27], v[200:203], v[144:147]
    ds_read_b64_tr_b16 v[192:193], v238 offset:49152
    ds_read_b64_tr_b16 v[194:195], v238 offset:50176
    v_mfma_f32_16x16x32_bf16 v[148:151], v[88:91], v[200:203], v[148:151]
    s_barrier
    s_waitcnt lgkmcnt(6)
    v_mfma_f32_16x16x32_bf16 v[152:155], v[24:27], v[204:207], v[152:155]
    ds_read_b64_tr_b16 v[196:197], v239 offset:49152
    ds_read_b64_tr_b16 v[198:199], v239 offset:50176
    v_mfma_f32_16x16x32_bf16 v[156:159], v[88:91], v[204:207], v[156:159]
    s_waitcnt lgkmcnt(6)
    v_mfma_f32_16x16x32_bf16 v[160:163], v[24:27], v[208:211], v[160:163]
    ds_read_b64_tr_b16 v[200:201], v232 offset:57344
    ds_read_b64_tr_b16 v[202:203], v232 offset:58368
    v_mfma_f32_16x16x32_bf16 v[164:167], v[88:91], v[208:211], v[164:167]
    s_add_u32 m0, s28, 32768
    s_mov_b32 s29, 1048576
    buffer_load_dwordx4 v240, s[16:19], s29 offen lds
    s_waitcnt lgkmcnt(6)
    v_mfma_f32_16x16x32_bf16 v[168:171], v[24:27], v[212:215], v[168:171]
    ds_read_b64_tr_b16 v[204:205], v233 offset:57344
    ds_read_b64_tr_b16 v[206:207], v233 offset:58368
    v_mfma_f32_16x16x32_bf16 v[172:175], v[88:91], v[212:215], v[172:175]
    s_waitcnt lgkmcnt(6)
    v_mfma_f32_16x16x32_bf16 v[176:179], v[24:27], v[192:195], v[176:179]
    ds_read_b64_tr_b16 v[208:209], v234 offset:57344
    ds_read_b64_tr_b16 v[210:211], v234 offset:58368
    v_mfma_f32_16x16x32_bf16 v[180:183], v[88:91], v[192:195], v[180:183]
    s_add_u32 m0, s28, 36864
    s_mov_b32 s29, 1179648
    buffer_load_dwordx4 v240, s[16:19], s29 offen lds
    s_waitcnt lgkmcnt(6)
    v_mfma_f32_16x16x32_bf16 v[184:187], v[24:27], v[196:199], v[184:187]
    ds_read_b64_tr_b16 v[212:213], v235 offset:57344
    ds_read_b64_tr_b16 v[214:215], v235 offset:58368
    v_mfma_f32_16x16x32_bf16 v[188:191], v[88:91], v[196:199], v[188:191]
    s_waitcnt lgkmcnt(6)
    v_mfma_f32_16x16x32_bf16 v[128:131], v[28:31], v[200:203], v[128:131]
    ds_read_b64_tr_b16 v[192:193], v236 offset:57344
    ds_read_b64_tr_b16 v[194:195], v236 offset:58368
    s_waitcnt vmcnt(22)
    v_mfma_f32_16x16x32_bf16 v[132:135], v[92:95], v[200:203], v[132:135]
    s_add_u32 m0, s28, 40960
    s_mov_b32 s29, 1310720
    buffer_load_dwordx4 v240, s[16:19], s29 offen lds
    s_waitcnt lgkmcnt(6)
    v_mfma_f32_16x16x32_bf16 v[136:139], v[28:31], v[204:207], v[136:139]
    ds_read_b64_tr_b16 v[196:197], v237 offset:57344
    ds_read_b64_tr_b16 v[198:199], v237 offset:58368
    v_mfma_f32_16x16x32_bf16 v[140:143], v[92:95], v[204:207], v[140:143]
    s_waitcnt lgkmcnt(6)
    v_mfma_f32_16x16x32_bf16 v[144:147], v[28:31], v[208:211], v[144:147]
    ds_read_b64_tr_b16 v[200:201], v238 offset:57344
    ds_read_b64_tr_b16 v[202:203], v238 offset:58368
    v_mfma_f32_16x16x32_bf16 v[148:151], v[92:95], v[208:211], v[148:151]
    s_add_u32 m0, s28, 45056
    s_mov_b32 s29, 1441792
    buffer_load_dwordx4 v240, s[16:19], s29 offen lds
    s_waitcnt lgkmcnt(6)
    v_mfma_f32_16x16x32_bf16 v[152:155], v[28:31], v[212:215], v[152:155]
    ds_read_b64_tr_b16 v[204:205], v239 offset:57344
    ds_read_b64_tr_b16 v[206:207], v239 offset:58368
    v_mfma_f32_16x16x32_bf16 v[156:159], v[92:95], v[212:215], v[156:159]
    s_waitcnt lgkmcnt(6)
    v_mfma_f32_16x16x32_bf16 v[160:163], v[28:31], v[192:195], v[160:163]
    ds_read_b64_tr_b16 v[208:209], v224 offset:0
    ds_read_b64_tr_b16 v[210:211], v224 offset:1024
    v_mfma_f32_16x16x32_bf16 v[164:167], v[92:95], v[192:195], v[164:167]
    s_waitcnt lgkmcnt(6)
    v_mfma_f32_16x16x32_bf16 v[168:171], v[28:31], v[196:199], v[168:171]
    ds_read_b64_tr_b16 v[212:213], v225 offset:0
    ds_read_b64_tr_b16 v[214:215], v225 offset:1024
    v_mfma_f32_16x16x32_bf16 v[172:175], v[92:95], v[196:199], v[172:175]
    s_waitcnt lgkmcnt(6)
    v_mfma_f32_16x16x32_bf16 v[176:179], v[28:31], v[200:203], v[176:179]
    ds_read_b64_tr_b16 v[192:193], v226 offset:0
    ds_read_b64_tr_b16 v[194:195], v226 offset:1024
    v_mfma_f32_16x16x32_bf16 v[180:183], v[92:95], v[200:203], v[180:183]
    s_waitcnt lgkmcnt(6)
    v_mfma_f32_16x16x32_bf16 v[184:187], v[28:31], v[204:207], v[184:187]
    ds_read_b64_tr_b16 v[196:197], v227 offset:0
    ds_read_b64_tr_b16 v[198:199], v227 offset:1024
    v_mfma_f32_16x16x32_bf16 v[188:191], v[92:95], v[204:207], v[188:191]
    s_waitcnt lgkmcnt(6)
    v_mfma_f32_16x16x32_bf16 v[128:131], v[32:35], v[208:211], v[128:131]
    ds_read_b64_tr_b16 v[200:201], v228 offset:0
    ds_read_b64_tr_b16 v[202:203], v228 offset:1024
    s_waitcnt vmcnt(23)
    v_mfma_f32_16x16x32_bf16 v[132:135], v[96:99], v[208:211], v[132:135]
    s_waitcnt lgkmcnt(6)
    v_mfma_f32_16x16x32_bf16 v[136:139], v[32:35], v[212:215], v[136:139]
    ds_read_b64_tr_b16 v[204:205], v229 offset:0
    ds_read_b64_tr_b16 v[206:207], v229 offset:1024
    v_mfma_f32_16x16x32_bf16 v[140:143], v[96:99], v[212:215], v[140:143]
    s_waitcnt lgkmcnt(6)
    v_mfma_f32_16x16x32_bf16 v[144:147], v[32:35], v[192:195], v[144:147]
    ds_read_b64_tr_b16 v[208:209], v230 offset:0
    ds_read_b64_tr_b16 v[210:211], v230 offset:1024
    v_mfma_f32_16x16x32_bf16 v[148:151], v[96:99], v[192:195], v[148:151]
    s_barrier
    s_waitcnt lgkmcnt(6)
    v_mfma_f32_16x16x32_bf16 v[152:155], v[32:35], v[196:199], v[152:155]
    ds_read_b64_tr_b16 v[212:213], v231 offset:0
    ds_read_b64_tr_b16 v[214:215], v231 offset:1024
    v_mfma_f32_16x16x32_bf16 v[156:159], v[96:99], v[196:199], v[156:159]
    s_waitcnt lgkmcnt(6)
    v_mfma_f32_16x16x32_bf16 v[160:163], v[32:35], v[200:203], v[160:163]
    ds_read_b64_tr_b16 v[192:193], v224 offset:8192
    ds_read_b64_tr_b16 v[194:195], v224 offset:9216
    v_mfma_f32_16x16x32_bf16 v[164:167], v[96:99], v[200:203], v[164:167]
    s_add_u32 m0, s28, 49152
    s_mov_b32 s29, 1572864
    buffer_load_dwordx4 v240, s[16:19], s29 offen lds
    s_waitcnt lgkmcnt(6)
    v_mfma_f32_16x16x32_bf16 v[168:171], v[32:35], v[204:207], v[168:171]
    ds_read_b64_tr_b16 v[196:197], v225 offset:8192
    ds_read_b64_tr_b16 v[198:199], v225 offset:9216
    v_mfma_f32_16x16x32_bf16 v[172:175], v[96:99], v[204:207], v[172:175]
    s_waitcnt lgkmcnt(6)
    v_mfma_f32_16x16x32_bf16 v[176:179], v[32:35], v[208:211], v[176:179]
    ds_read_b64_tr_b16 v[200:201], v226 offset:8192
    ds_read_b64_tr_b16 v[202:203], v226 offset:9216
    v_mfma_f32_16x16x32_bf16 v[180:183], v[96:99], v[208:211], v[180:183]
    s_add_u32 m0, s28, 53248
    s_mov_b32 s29, 1703936
    buffer_load_dwordx4 v240, s[16:19], s29 offen lds
    s_waitcnt lgkmcnt(6)
    v_mfma_f32_16x16x32_bf16 v[184:187], v[32:35], v[212:215], v[184:187]
    ds_read_b64_tr_b16 v[204:205], v227 offset:8192
    ds_read_b64_tr_b16 v[206:207], v227 offset:9216
    v_mfma_f32_16x16x32_bf16 v[188:191], v[96:99], v[212:215], v[188:191]
    s_waitcnt lgkmcnt(6)
    v_mfma_f32_16x16x32_bf16 v[128:131], v[36:39], v[192:195], v[128:131]
    ds_read_b64_tr_b16 v[208:209], v228 offset:8192
    ds_read_b64_tr_b16 v[210:211], v228 offset:9216
    s_waitcnt vmcnt(24)
    v_mfma_f32_16x16x32_bf16 v[132:135], v[100:103], v[192:195], v[132:135]
    s_add_u32 m0, s28, 57344
    s_mov_b32 s29, 1835008
    buffer_load_dwordx4 v240, s[16:19], s29 offen lds
    s_waitcnt lgkmcnt(6)
    v_mfma_f32_16x16x32_bf16 v[136:139], v[36:39], v[196:199], v[136:139]
    ds_read_b64_tr_b16 v[212:213], v229 offset:8192
    ds_read_b64_tr_b16 v[214:215], v229 offset:9216
    v_mfma_f32_16x16x32_bf16 v[140:143], v[100:103], v[196:199], v[140:143]
    s_waitcnt lgkmcnt(6)
    v_mfma_f32_16x16x32_bf16 v[144:147], v[36:39], v[200:203], v[144:147]
    ds_read_b64_tr_b16 v[192:193], v230 offset:8192
    ds_read_b64_tr_b16 v[194:195], v230 offset:9216
    v_mfma_f32_16x16x32_bf16 v[148:151], v[100:103], v[200:203], v[148:151]
    s_add_u32 m0, s28, 61440
    s_mov_b32 s29, 1966080
    buffer_load_dwordx4 v240, s[16:19], s29 offen lds
    s_waitcnt lgkmcnt(6)
    v_mfma_f32_16x16x32_bf16 v[152:155], v[36:39], v[204:207], v[152:155]
    ds_read_b64_tr_b16 v[196:197], v231 offset:8192
    ds_read_b64_tr_b16 v[198:199], v231 offset:9216
    v_mfma_f32_16x16x32_bf16 v[156:159], v[100:103], v[204:207], v[156:159]
    s_waitcnt lgkmcnt(6)
    v_mfma_f32_16x16x32_bf16 v[160:163], v[36:39], v[208:211], v[160:163]
    ds_read_b64_tr_b16 v[200:201], v224 offset:16384
    ds_read_b64_tr_b16 v[202:203], v224 offset:17408
    v_mfma_f32_16x16x32_bf16 v[164:167], v[100:103], v[208:211], v[164:167]
    s_waitcnt lgkmcnt(6)
    v_mfma_f32_16x16x32_bf16 v[168:171], v[36:39], v[212:215], v[168:171]
    ds_read_b64_tr_b16 v[204:205], v225 offset:16384
    ds_read_b64_tr_b16 v[206:207], v225 offset:17408
    v_mfma_f32_16x16x32_bf16 v[172:175], v[100:103], v[212:215], v[172:175]
    s_waitcnt lgkmcnt(6)
    v_mfma_f32_16x16x32_bf16 v[176:179], v[36:39], v[192:195], v[176:179]
    ds_read_b64_tr_b16 v[208:209], v226 offset:16384
    ds_read_b64_tr_b16 v[210:211], v226 offset:17408
    v_mfma_f32_16x16x32_bf16 v[180:183], v[100:103], v[192:195], v[180:183]
    s_waitcnt lgkmcnt(6)
    v_mfma_f32_16x16x32_bf16 v[184:187], v[36:39], v[196:199], v[184:187]
    ds_read_b64_tr_b16 v[212:213], v227 offset:16384
    ds_read_b64_tr_b16 v[214:215], v227 offset:17408
    v_mfma_f32_16x16x32_bf16 v[188:191], v[100:103], v[196:199], v[188:191]
    s_waitcnt lgkmcnt(6)
    v_mfma_f32_16x16x32_bf16 v[128:131], v[40:43], v[200:203], v[128:131]
    ds_read_b64_tr_b16 v[192:193], v228 offset:16384
    ds_read_b64_tr_b16 v[194:195], v228 offset:17408
    s_waitcnt vmcnt(25)
    v_mfma_f32_16x16x32_bf16 v[132:135], v[104:107], v[200:203], v[132:135]
    s_waitcnt lgkmcnt(6)
    v_mfma_f32_16x16x32_bf16 v[136:139], v[40:43], v[204:207], v[136:139]
    ds_read_b64_tr_b16 v[196:197], v229 offset:16384
    ds_read_b64_tr_b16 v[198:199], v229 offset:17408
    v_mfma_f32_16x16x32_bf16 v[140:143], v[104:107], v[204:207], v[140:143]
    s_waitcnt lgkmcnt(6)
    v_mfma_f32_16x16x32_bf16 v[144:147], v[40:43], v[208:211], v[144:147]
    ds_read_b64_tr_b16 v[200:201], v230 offset:16384
    ds_read_b64_tr_b16 v[202:203], v230 offset:17408
    v_mfma_f32_16x16x32_bf16 v[148:151], v[104:107], v[208:211], v[148:151]
    s_barrier
    s_waitcnt lgkmcnt(6)
    v_mfma_f32_16x16x32_bf16 v[152:155], v[40:43], v[212:215], v[152:155]
    ds_read_b64_tr_b16 v[204:205], v231 offset:16384
    ds_read_b64_tr_b16 v[206:207], v231 offset:17408
    v_mfma_f32_16x16x32_bf16 v[156:159], v[104:107], v[212:215], v[156:159]
    s_waitcnt lgkmcnt(6)
    v_mfma_f32_16x16x32_bf16 v[160:163], v[40:43], v[192:195], v[160:163]
    ds_read_b64_tr_b16 v[208:209], v224 offset:24576
    ds_read_b64_tr_b16 v[210:211], v224 offset:25600
    v_mfma_f32_16x16x32_bf16 v[164:167], v[104:107], v[192:195], v[164:167]
    s_add_u32 m0, s28, 65536
    s_mov_b32 s29, 2097152
    buffer_load_dwordx4 v240, s[16:19], s29 offen lds
    s_waitcnt lgkmcnt(6)
    v_mfma_f32_16x16x32_bf16 v[168:171], v[40:43], v[196:199], v[168:171]
    ds_read_b64_tr_b16 v[212:213], v225 offset:24576
    ds_read_b64_tr_b16 v[214:215], v225 offset:25600
    v_mfma_f32_16x16x32_bf16 v[172:175], v[104:107], v[196:199], v[172:175]
    s_waitcnt lgkmcnt(6)
    v_mfma_f32_16x16x32_bf16 v[176:179], v[40:43], v[200:203], v[176:179]
    ds_read_b64_tr_b16 v[192:193], v226 offset:24576
    ds_read_b64_tr_b16 v[194:195], v226 offset:25600
    v_mfma_f32_16x16x32_bf16 v[180:183], v[104:107], v[200:203], v[180:183]
    s_add_u32 m0, s28, 69632
    s_mov_b32 s29, 2228224
    buffer_load_dwordx4 v240, s[16:19], s29 offen lds
    s_waitcnt lgkmcnt(6)
    v_mfma_f32_16x16x32_bf16 v[184:187], v[40:43], v[204:207], v[184:187]
    ds_read_b64_tr_b16 v[196:197], v227 offset:24576
    ds_read_b64_tr_b16 v[198:199], v227 offset:25600
    v_mfma_f32_16x16x32_bf16 v[188:191], v[104:107], v[204:207], v[188:191]
    s_waitcnt lgkmcnt(6)
    v_mfma_f32_16x16x32_bf16 v[128:131], v[44:47], v[208:211], v[128:131]
    ds_read_b64_tr_b16 v[200:201], v228 offset:24576
    ds_read_b64_tr_b16 v[202:203], v228 offset:25600
    s_waitcnt vmcnt(26)
    v_mfma_f32_16x16x32_bf16 v[132:135], v[108:111], v[208:211], v[132:135]
    s_add_u32 m0, s28, 73728
    s_mov_b32 s29, 2359296
    buffer_load_dwordx4 v240, s[16:19], s29 offen lds
    s_waitcnt lgkmcnt(6)
    v_mfma_f32_16x16x32_bf16 v[136:139], v[44:47], v[212:215], v[136:139]
    ds_read_b64_tr_b16 v[204:205], v229 offset:24576
    ds_read_b64_tr_b16 v[206:207], v229 offset:25600
    v_mfma_f32_16x16x32_bf16 v[140:143], v[108:111], v[212:215], v[140:143]
    s_waitcnt lgkmcnt(6)
    v_mfma_f32_16x16x32_bf16 v[144:147], v[44:47], v[192:195], v[144:147]
    ds_read_b64_tr_b16 v[208:209], v230 offset:24576
    ds_read_b64_tr_b16 v[210:211], v230 offset:25600
    v_mfma_f32_16x16x32_bf16 v[148:151], v[108:111], v[192:195], v[148:151]
    s_add_u32 m0, s28, 77824
    s_mov_b32 s29, 2490368
    buffer_load_dwordx4 v240, s[16:19], s29 offen lds
    s_waitcnt lgkmcnt(6)
    v_mfma_f32_16x16x32_bf16 v[152:155], v[44:47], v[196:199], v[152:155]
    ds_read_b64_tr_b16 v[212:213], v231 offset:24576
    ds_read_b64_tr_b16 v[214:215], v231 offset:25600
    v_mfma_f32_16x16x32_bf16 v[156:159], v[108:111], v[196:199], v[156:159]
    s_waitcnt lgkmcnt(6)
    v_mfma_f32_16x16x32_bf16 v[160:163], v[44:47], v[200:203], v[160:163]
    ds_read_b64_tr_b16 v[192:193], v224 offset:32768
    ds_read_b64_tr_b16 v[194:195], v224 offset:33792
    v_mfma_f32_16x16x32_bf16 v[164:167], v[108:111], v[200:203], v[164:167]
    s_waitcnt lgkmcnt(6)
    v_mfma_f32_16x16x32_bf16 v[168:171], v[44:47], v[204:207], v[168:171]
    ds_read_b64_tr_b16 v[196:197], v225 offset:32768
    ds_read_b64_tr_b16 v[198:199], v225 offset:33792
    v_mfma_f32_16x16x32_bf16 v[172:175], v[108:111], v[204:207], v[172:175]
    s_waitcnt lgkmcnt(6)
    v_mfma_f32_16x16x32_bf16 v[176:179], v[44:47], v[208:211], v[176:179]
    ds_read_b64_tr_b16 v[200:201], v226 offset:32768
    ds_read_b64_tr_b16 v[202:203], v226 offset:33792
    v_mfma_f32_16x16x32_bf16 v[180:183], v[108:111], v[208:211], v[180:183]
    s_waitcnt lgkmcnt(6)
    v_mfma_f32_16x16x32_bf16 v[184:187], v[44:47], v[212:215], v[184:187]
    ds_read_b64_tr_b16 v[204:205], v227 offset:32768
    ds_read_b64_tr_b16 v[206:207], v227 offset:33792
    v_mfma_f32_16x16x32_bf16 v[188:191], v[108:111], v[212:215], v[188:191]
    s_waitcnt lgkmcnt(6)
    v_mfma_f32_16x16x32_bf16 v[128:131], v[48:51], v[192:195], v[128:131]
    ds_read_b64_tr_b16 v[208:209], v228 offset:32768
    ds_read_b64_tr_b16 v[210:211], v228 offset:33792
    s_waitcnt vmcnt(27)
    v_mfma_f32_16x16x32_bf16 v[132:135], v[112:115], v[192:195], v[132:135]
    s_waitcnt lgkmcnt(6)
    v_mfma_f32_16x16x32_bf16 v[136:139], v[48:51], v[196:199], v[136:139]
    ds_read_b64_tr_b16 v[212:213], v229 offset:32768
    ds_read_b64_tr_b16 v[214:215], v229 offset:33792
    v_mfma_f32_16x16x32_bf16 v[140:143], v[112:115], v[196:199], v[140:143]
    s_waitcnt lgkmcnt(6)
    v_mfma_f32_16x16x32_bf16 v[144:147], v[48:51], v[200:203], v[144:147]
    ds_read_b64_tr_b16 v[192:193], v230 offset:32768
    ds_read_b64_tr_b16 v[194:195], v230 offset:33792
    v_mfma_f32_16x16x32_bf16 v[148:151], v[112:115], v[200:203], v[148:151]
    s_waitcnt vmcnt(20)
    s_barrier
    s_waitcnt lgkmcnt(6)
    v_mfma_f32_16x16x32_bf16 v[152:155], v[48:51], v[204:207], v[152:155]
    ds_read_b64_tr_b16 v[196:197], v231 offset:32768
    ds_read_b64_tr_b16 v[198:199], v231 offset:33792
    v_mfma_f32_16x16x32_bf16 v[156:159], v[112:115], v[204:207], v[156:159]
    s_waitcnt lgkmcnt(6)
    v_mfma_f32_16x16x32_bf16 v[160:163], v[48:51], v[208:211], v[160:163]
    ds_read_b64_tr_b16 v[200:201], v224 offset:40960
    ds_read_b64_tr_b16 v[202:203], v224 offset:41984
    v_mfma_f32_16x16x32_bf16 v[164:167], v[112:115], v[208:211], v[164:167]
    s_add_u32 m0, s28, 81920
    s_mov_b32 s29, 2621440
    buffer_load_dwordx4 v240, s[16:19], s29 offen lds
    s_waitcnt lgkmcnt(6)
    v_mfma_f32_16x16x32_bf16 v[168:171], v[48:51], v[212:215], v[168:171]
    ds_read_b64_tr_b16 v[204:205], v225 offset:40960
    ds_read_b64_tr_b16 v[206:207], v225 offset:41984
    v_mfma_f32_16x16x32_bf16 v[172:175], v[112:115], v[212:215], v[172:175]
    s_waitcnt lgkmcnt(6)
    v_mfma_f32_16x16x32_bf16 v[176:179], v[48:51], v[192:195], v[176:179]
    ds_read_b64_tr_b16 v[208:209], v226 offset:40960
    ds_read_b64_tr_b16 v[210:211], v226 offset:41984
    v_mfma_f32_16x16x32_bf16 v[180:183], v[112:115], v[192:195], v[180:183]
    s_add_u32 m0, s28, 86016
    s_mov_b32 s29, 2752512
    buffer_load_dwordx4 v240, s[16:19], s29 offen lds
    s_waitcnt lgkmcnt(6)
    v_mfma_f32_16x16x32_bf16 v[184:187], v[48:51], v[196:199], v[184:187]
    ds_read_b64_tr_b16 v[212:213], v227 offset:40960
    ds_read_b64_tr_b16 v[214:215], v227 offset:41984
    v_mfma_f32_16x16x32_bf16 v[188:191], v[112:115], v[196:199], v[188:191]
    s_waitcnt lgkmcnt(6)
    v_mfma_f32_16x16x32_bf16 v[128:131], v[52:55], v[200:203], v[128:131]
    ds_read_b64_tr_b16 v[192:193], v228 offset:40960
    ds_read_b64_tr_b16 v[194:195], v228 offset:41984
    v_mfma_f32_16x16x32_bf16 v[132:135], v[116:119], v[200:203], v[132:135]
    s_add_u32 m0, s28, 90112
    s_mov_b32 s29, 2883584
    buffer_load_dwordx4 v240, s[16:19], s29 offen lds
    s_waitcnt lgkmcnt(6)
    v_mfma_f32_16x16x32_bf16 v[136:139], v[52:55], v[204:207], v[136:139]
    ds_read_b64_tr_b16 v[196:197], v229 offset:40960
    ds_read_b64_tr_b16 v[198:199], v229 offset:41984
    v_mfma_f32_16x16x32_bf16 v[140:143], v[116:119], v[204:207], v[140:143]
    s_waitcnt lgkmcnt(6)
    v_mfma_f32_16x16x32_bf16 v[144:147], v[52:55], v[208:211], v[144:147]
    ds_read_b64_tr_b16 v[200:201], v230 offset:40960
    ds_read_b64_tr_b16 v[202:203], v230 offset:41984
    v_mfma_f32_16x16x32_bf16 v[148:151], v[116:119], v[208:211], v[148:151]
    s_add_u32 m0, s28, 94208
    s_mov_b32 s29, 3014656
    buffer_load_dwordx4 v240, s[16:19], s29 offen lds
    s_waitcnt lgkmcnt(6)
    v_mfma_f32_16x16x32_bf16 v[152:155], v[52:55], v[212:215], v[152:155]
    ds_read_b64_tr_b16 v[204:205], v231 offset:40960
    ds_read_b64_tr_b16 v[206:207], v231 offset:41984
    v_mfma_f32_16x16x32_bf16 v[156:159], v[116:119], v[212:215], v[156:159]
    s_waitcnt lgkmcnt(6)
    v_mfma_f32_16x16x32_bf16 v[160:163], v[52:55], v[192:195], v[160:163]
    ds_read_b64_tr_b16 v[208:209], v224 offset:49152
    ds_read_b64_tr_b16 v[210:211], v224 offset:50176
    v_mfma_f32_16x16x32_bf16 v[164:167], v[116:119], v[192:195], v[164:167]
    s_waitcnt lgkmcnt(6)
    v_mfma_f32_16x16x32_bf16 v[168:171], v[52:55], v[196:199], v[168:171]
    ds_read_b64_tr_b16 v[212:213], v225 offset:49152
    ds_read_b64_tr_b16 v[214:215], v225 offset:50176
    v_mfma_f32_16x16x32_bf16 v[172:175], v[116:119], v[196:199], v[172:175]
    s_waitcnt lgkmcnt(6)
    v_mfma_f32_16x16x32_bf16 v[176:179], v[52:55], v[200:203], v[176:179]
    ds_read_b64_tr_b16 v[192:193], v226 offset:49152
    ds_read_b64_tr_b16 v[194:195], v226 offset:50176
    v_mfma_f32_16x16x32_bf16 v[180:183], v[116:119], v[200:203], v[180:183]
    s_waitcnt lgkmcnt(6)
    v_mfma_f32_16x16x32_bf16 v[184:187], v[52:55], v[204:207], v[184:187]
    ds_read_b64_tr_b16 v[196:197], v227 offset:49152
    ds_read_b64_tr_b16 v[198:199], v227 offset:50176
    v_mfma_f32_16x16x32_bf16 v[188:191], v[116:119], v[204:207], v[188:191]
    s_waitcnt lgkmcnt(6)
    v_mfma_f32_16x16x32_bf16 v[128:131], v[56:59], v[208:211], v[128:131]
    ds_read_b64_tr_b16 v[200:201], v228 offset:49152
    ds_read_b64_tr_b16 v[202:203], v228 offset:50176
    v_mfma_f32_16x16x32_bf16 v[132:135], v[120:123], v[208:211], v[132:135]
    s_waitcnt lgkmcnt(6)
    v_mfma_f32_16x16x32_bf16 v[136:139], v[56:59], v[212:215], v[136:139]
    ds_read_b64_tr_b16 v[204:205], v229 offset:49152
    ds_read_b64_tr_b16 v[206:207], v229 offset:50176
    v_mfma_f32_16x16x32_bf16 v[140:143], v[120:123], v[212:215], v[140:143]
    s_waitcnt lgkmcnt(6)
    v_mfma_f32_16x16x32_bf16 v[144:147], v[56:59], v[192:195], v[144:147]
    ds_read_b64_tr_b16 v[208:209], v230 offset:49152
    ds_read_b64_tr_b16 v[210:211], v230 offset:50176
    v_mfma_f32_16x16x32_bf16 v[148:151], v[120:123], v[192:195], v[148:151]
    s_waitcnt vmcnt(20)
    s_barrier
    s_waitcnt lgkmcnt(6)
    v_mfma_f32_16x16x32_bf16 v[152:155], v[56:59], v[196:199], v[152:155]
    ds_read_b64_tr_b16 v[212:213], v231 offset:49152
    ds_read_b64_tr_b16 v[214:215], v231 offset:50176
    v_mfma_f32_16x16x32_bf16 v[156:159], v[120:123], v[196:199], v[156:159]
    s_waitcnt lgkmcnt(6)
    v_mfma_f32_16x16x32_bf16 v[160:163], v[56:59], v[200:203], v[160:163]
    ds_read_b64_tr_b16 v[192:193], v224 offset:57344
    ds_read_b64_tr_b16 v[194:195], v224 offset:58368
    v_mfma_f32_16x16x32_bf16 v[164:167], v[120:123], v[200:203], v[164:167]
    s_add_u32 m0, s28, 98304
    s_mov_b32 s29, 3145728
    buffer_load_dwordx4 v240, s[16:19], s29 offen lds
    s_waitcnt lgkmcnt(6)
    v_mfma_f32_16x16x32_bf16 v[168:171], v[56:59], v[204:207], v[168:171]
    ds_read_b64_tr_b16 v[196:197], v225 offset:57344
    ds_read_b64_tr_b16 v[198:199], v225 offset:58368
    v_mfma_f32_16x16x32_bf16 v[172:175], v[120:123], v[204:207], v[172:175]
    s_waitcnt lgkmcnt(6)
    v_mfma_f32_16x16x32_bf16 v[176:179], v[56:59], v[208:211], v[176:179]
    ds_read_b64_tr_b16 v[200:201], v226 offset:57344
    ds_read_b64_tr_b16 v[202:203], v226 offset:58368
    v_mfma_f32_16x16x32_bf16 v[180:183], v[120:123], v[208:211], v[180:183]
    s_add_u32 m0, s28, 102400
    s_mov_b32 s29, 3276800
    buffer_load_dwordx4 v240, s[16:19], s29 offen lds
    s_waitcnt lgkmcnt(6)
    v_mfma_f32_16x16x32_bf16 v[184:187], v[56:59], v[212:215], v[184:187]
    ds_read_b64_tr_b16 v[204:205], v227 offset:57344
    ds_read_b64_tr_b16 v[206:207], v227 offset:58368
    v_mfma_f32_16x16x32_bf16 v[188:191], v[120:123], v[212:215], v[188:191]
    s_waitcnt lgkmcnt(6)
    v_mfma_f32_16x16x32_bf16 v[128:131], v[60:63], v[192:195], v[128:131]
    ds_read_b64_tr_b16 v[208:209], v228 offset:57344
    ds_read_b64_tr_b16 v[210:211], v228 offset:58368
    v_mfma_f32_16x16x32_bf16 v[132:135], v[124:127], v[192:195], v[132:135]
    s_add_u32 m0, s28, 106496
    s_mov_b32 s29, 3407872
    buffer_load_dwordx4 v240, s[16:19], s29 offen lds
    s_waitcnt lgkmcnt(6)
    v_mfma_f32_16x16x32_bf16 v[136:139], v[60:63], v[196:199], v[136:139]
    ds_read_b64_tr_b16 v[212:213], v229 offset:57344
    ds_read_b64_tr_b16 v[214:215], v229 offset:58368
    v_mfma_f32_16x16x32_bf16 v[140:143], v[124:127], v[196:199], v[140:143]
    s_waitcnt lgkmcnt(6)
    v_mfma_f32_16x16x32_bf16 v[144:147], v[60:63], v[200:203], v[144:147]
    ds_read_b64_tr_b16 v[192:193], v230 offset:57344
    ds_read_b64_tr_b16 v[194:195], v230 offset:58368
    v_mfma_f32_16x16x32_bf16 v[148:151], v[124:127], v[200:203], v[148:151]
    s_add_u32 m0, s28, 110592
    s_mov_b32 s29, 3538944
    buffer_load_dwordx4 v240, s[16:19], s29 offen lds
    s_waitcnt lgkmcnt(6)
    v_mfma_f32_16x16x32_bf16 v[152:155], v[60:63], v[204:207], v[152:155]
    ds_read_b64_tr_b16 v[196:197], v231 offset:57344
    ds_read_b64_tr_b16 v[198:199], v231 offset:58368
    v_mfma_f32_16x16x32_bf16 v[156:159], v[124:127], v[204:207], v[156:159]
    s_waitcnt lgkmcnt(6)
    v_mfma_f32_16x16x32_bf16 v[160:163], v[60:63], v[208:211], v[160:163]
    v_mfma_f32_16x16x32_bf16 v[164:167], v[124:127], v[208:211], v[164:167]
    s_waitcnt lgkmcnt(4)
    v_mfma_f32_16x16x32_bf16 v[168:171], v[60:63], v[212:215], v[168:171]
    v_mfma_f32_16x16x32_bf16 v[172:175], v[124:127], v[212:215], v[172:175]
    s_waitcnt lgkmcnt(2)
    v_mfma_f32_16x16x32_bf16 v[176:179], v[60:63], v[192:195], v[176:179]
    v_mfma_f32_16x16x32_bf16 v[180:183], v[124:127], v[192:195], v[180:183]
    s_waitcnt lgkmcnt(0)
    v_mfma_f32_16x16x32_bf16 v[184:187], v[60:63], v[196:199], v[184:187]
    v_mfma_f32_16x16x32_bf16 v[188:191], v[124:127], v[196:199], v[188:191]
    s_add_u32 s21, s30, 4096
    v_cvt_pk_bf16_f32 v216, v128, v129
    v_cvt_pk_bf16_f32 v217, v130, v131
    v_cvt_pk_bf16_f32 v218, v132, v133
    v_cvt_pk_bf16_f32 v219, v134, v135
    buffer_store_dwordx4 v[216:219], v242, s[8:11], s30 offen offset:0 sc1
    v_cvt_pk_bf16_f32 v220, v136, v137
    v_cvt_pk_bf16_f32 v221, v138, v139
    v_cvt_pk_bf16_f32 v222, v140, v141
    v_cvt_pk_bf16_f32 v223, v142, v143
    buffer_store_dwordx4 v[220:223], v242, s[8:11], s30 offen offset:1024 sc1
    v_cvt_pk_bf16_f32 v216, v144, v145
    v_cvt_pk_bf16_f32 v217, v146, v147
    v_cvt_pk_bf16_f32 v218, v148, v149
    v_cvt_pk_bf16_f32 v219, v150, v151
    buffer_store_dwordx4 v[216:219], v242, s[8:11], s30 offen offset:2048 sc1
    v_cvt_pk_bf16_f32 v220, v152, v153
    v_cvt_pk_bf16_f32 v221, v154, v155
    v_cvt_pk_bf16_f32 v222, v156, v157
    v_cvt_pk_bf16_f32 v223, v158, v159
    buffer_store_dwordx4 v[220:223], v242, s[8:11], s30 offen offset:3072 sc1
    v_cvt_pk_bf16_f32 v216, v160, v161
    v_cvt_pk_bf16_f32 v217, v162, v163
    v_cvt_pk_bf16_f32 v218, v164, v165
    v_cvt_pk_bf16_f32 v219, v166, v167
    buffer_store_dwordx4 v[216:219], v242, s[8:11], s21 offen offset:0 sc1
    v_cvt_pk_bf16_f32 v220, v168, v169
    v_cvt_pk_bf16_f32 v221, v170, v171
    v_cvt_pk_bf16_f32 v222, v172, v173
    v_cvt_pk_bf16_f32 v223, v174, v175
    buffer_store_dwordx4 v[220:223], v242, s[8:11], s21 offen offset:1024 sc1
    v_cvt_pk_bf16_f32 v216, v176, v177
    v_cvt_pk_bf16_f32 v217, v178, v179
    v_cvt_pk_bf16_f32 v218, v180, v181
    v_cvt_pk_bf16_f32 v219, v182, v183
    buffer_store_dwordx4 v[216:219], v242, s[8:11], s21 offen offset:2048 sc1
    v_cvt_pk_bf16_f32 v220, v184, v185
    v_cvt_pk_bf16_f32 v221, v186, v187
    v_cvt_pk_bf16_f32 v222, v188, v189
    v_cvt_pk_bf16_f32 v223, v190, v191
    buffer_store_dwordx4 v[220:223], v242, s[8:11], s21 offen offset:3072 sc1
    s_sub_u32 s30, s30, 16777216
    s_mov_b32 s31, 0
Lkq_129:
    s_mov_b32 s12, s16
    s_mov_b32 s13, s17
    s_mov_b32 s16, s36
    s_and_b32 s17, s37, 0xffff
    ds_read_b64_tr_b16 v[192:193], v232 offset:0
    ds_read_b64_tr_b16 v[194:195], v232 offset:1024
    ds_read_b64_tr_b16 v[196:197], v233 offset:0
    ds_read_b64_tr_b16 v[198:199], v233 offset:1024
    ds_read_b64_tr_b16 v[200:201], v234 offset:0
    ds_read_b64_tr_b16 v[202:203], v234 offset:1024
    ds_read_b64_tr_b16 v[204:205], v235 offset:0
    ds_read_b64_tr_b16 v[206:207], v235 offset:1024
    s_waitcnt lgkmcnt(6)
    v_mfma_f32_16x16x32_bf16 v[128:131], v[192:195], v[0:3], 0
    ds_read_b64_tr_b16 v[208:209], v236 offset:0
    ds_read_b64_tr_b16 v[210:211], v236 offset:1024
    v_mfma_f32_16x16x32_bf16 v[132:135], v[192:195], v[64:67], 0
    s_waitcnt lgkmcnt(6)
    v_mfma_f32_16x16x32_bf16 v[136:139], v[196:199], v[0:3], 0
    ds_read_b64_tr_b16 v[212:213], v237 offset:0
    ds_read_b64_tr_b16 v[214:215], v237 offset:1024
    v_mfma_f32_16x16x32_bf16 v[140:143], v[196:199], v[64:67], 0
    s_waitcnt lgkmcnt(6)
    v_mfma_f32_16x16x32_bf16 v[144:147], v[200:203], v[0:3], 0
    ds_read_b64_tr_b16 v[192:193], v238 offset:0
    ds_read_b64_tr_b16 v[194:195], v238 offset:1024
    v_mfma_f32_16x16x32_bf16 v[148:151], v[200:203], v[64:67], 0
    s_waitcnt vmcnt(20)
    s_barrier
    s_waitcnt lgkmcnt(6)
    v_mfma_f32_16x16x32_bf16 v[152:155], v[204:207], v[0:3], 0
    ds_read_b64_tr_b16 v[196:197], v239 offset:0
    ds_read_b64_tr_b16 v[198:199], v239 offset:1024
    v_mfma_f32_16x16x32_bf16 v[156:159], v[204:207], v[64:67], 0
    s_waitcnt lgkmcnt(6)
    v_mfma_f32_16x16x32_bf16 v[160:163], v[208:211], v[0:3], 0
    ds_read_b64_tr_b16 v[200:201], v232 offset:8192
    ds_read_b64_tr_b16 v[202:203], v232 offset:9216
    v_mfma_f32_16x16x32_bf16 v[164:167], v[208:211], v[64:67], 0
    s_add_u32 m0, s28, 114688
    s_mov_b32 s29, 3670016
    buffer_load_dwordx4 v240, s[12:15], s29 offen lds
    s_waitcnt lgkmcnt(6)
    v_mfma_f32_16x16x32_bf16 v[168:171], v[212:215], v[0:3], 0
    ds_read_b64_tr_b16 v[204:205], v233 offset:8192
    ds_read_b64_tr_b16 v[206:207], v233 offset:9216
    v_mfma_f32_16x16x32_bf16 v[172:175], v[212:215], v[64:67], 0
    s_waitcnt lgkmcnt(6)
    v_mfma_f32_16x16x32_bf16 v[176:179], v[192:195], v[0:3], 0
    ds_read_b64_tr_b16 v[208:209], v234 offset:8192
    ds_read_b64_tr_b16 v[210:211], v234 offset:9216
    v_mfma_f32_16x16x32_bf16 v[180:183], v[192:195], v[64:67], 0
    s_add_u32 m0, s28, 118784
    s_mov_b32 s29, 3801088
    buffer_load_dwordx4 v240, s[12:15], s29 offen lds
    s_waitcnt lgkmcnt(6)
    v_mfma_f32_16x16x32_bf16 v[184:187], v[196:199], v[0:3], 0
    ds_read_b64_tr_b16 v[212:213], v235 offset:8192
    ds_read_b64_tr_b16 v[214:215], v235 offset:9216
    v_mfma_f32_16x16x32_bf16 v[188:191], v[196:199], v[64:67], 0
    s_waitcnt lgkmcnt(6)
    v_mfma_f32_16x16x32_bf16 v[128:131], v[200:203], v[4:7], v[128:131]
    ds_read_b64_tr_b16 v[192:193], v236 offset:8192
    ds_read_b64_tr_b16 v[194:195], v236 offset:9216
    v_mfma_f32_16x16x32_bf16 v[132:135], v[200:203], v[68:71], v[132:135]
    s_add_u32 m0, s28, 122880
    s_mov_b32 s29, 3932160
    buffer_load_dwordx4 v240, s[12:15], s29 offen lds
    s_waitcnt lgkmcnt(6)
    v_mfma_f32_16x16x32_bf16 v[136:139], v[204:207], v[4:7], v[136:139]
    ds_read_b64_tr_b16 v[196:197], v237 offset:8192
    ds_read_b64_tr_b16 v[198:199], v237 offset:9216
    v_mfma_f32_16x16x32_bf16 v[140:143], v[204:207], v[68:71], v[140:143]
    s_waitcnt lgkmcnt(6)
    v_mfma_f32_16x16x32_bf16 v[144:147], v[208:211], v[4:7], v[144:147]
    ds_read_b64_tr_b16 v[200:201], v238 offset:8192
    ds_read_b64_tr_b16 v[202:203], v238 offset:9216
    v_mfma_f32_16x16x32_bf16 v[148:151], v[208:211], v[68:71], v[148:151]
    s_add_u32 m0, s28, 126976
    s_mov_b32 s29, 4063232
    buffer_load_dwordx4 v240, s[12:15], s29 offen lds
    s_waitcnt lgkmcnt(6)
    v_mfma_f32_16x16x32_bf16 v[152:155], v[212:215], v[4:7], v[152:155]
    ds_read_b64_tr_b16 v[204:205], v239 offset:8192
    ds_read_b64_tr_b16 v[206:207], v239 offset:9216
    v_mfma_f32_16x16x32_bf16 v[156:159], v[212:215], v[68:71], v[156:159]
    s_waitcnt lgkmcnt(6)
    v_mfma_f32_16x16x32_bf16 v[160:163], v[192:195], v[4:7], v[160:163]
    ds_read_b64_tr_b16 v[208:209], v232 offset:16384
    ds_read_b64_tr_b16 v[210:211], v232 offset:17408
    v_mfma_f32_16x16x32_bf16 v[164:167], v[192:195], v[68:71], v[164:167]
    s_waitcnt lgkmcnt(6)
    v_mfma_f32_16x16x32_bf16 v[168:171], v[196:199], v[4:7], v[168:171]
    ds_read_b64_tr_b16 v[212:213], v233 offset:16384
    ds_read_b64_tr_b16 v[214:215], v233 offset:17408
    v_mfma_f32_16x16x32_bf16 v[172:175], v[196:199], v[68:71], v[172:175]
    s_waitcnt lgkmcnt(6)
    v_mfma_f32_16x16x32_bf16 v[176:179], v[200:203], v[4:7], v[176:179]
    ds_read_b64_tr_b16 v[192:193], v234 offset:16384
    ds_read_b64_tr_b16 v[194:195], v234 offset:17408
    v_mfma_f32_16x16x32_bf16 v[180:183], v[200:203], v[68:71], v[180:183]
    s_waitcnt lgkmcnt(6)
    v_mfma_f32_16x16x32_bf16 v[184:187], v[204:207], v[4:7], v[184:187]
    ds_read_b64_tr_b16 v[196:197], v235 offset:16384
    ds_read_b64_tr_b16 v[198:199], v235 offset:17408
    v_mfma_f32_16x16x32_bf16 v[188:191], v[204:207], v[68:71], v[188:191]
    s_waitcnt lgkmcnt(6)
    v_mfma_f32_16x16x32_bf16 v[128:131], v[208:211], v[8:11], v[128:131]
    ds_read_b64_tr_b16 v[200:201], v236 offset:16384
    ds_read_b64_tr_b16 v[202:203], v236 offset:17408
    v_mfma_f32_16x16x32_bf16 v[132:135], v[208:211], v[72:75], v[132:135]
    s_waitcnt lgkmcnt(6)
    v_mfma_f32_16x16x32_bf16 v[136:139], v[212:215], v[8:11], v[136:139]
    ds_read_b64_tr_b16 v[204:205], v237 offset:16384
    ds_read_b64_tr_b16 v[206:207], v237 offset:17408
    v_mfma_f32_16x16x32_bf16 v[140:143], v[212:215], v[72:75], v[140:143]
    s_waitcnt lgkmcnt(6)
    v_mfma_f32_16x16x32_bf16 v[144:147], v[192:195], v[8:11], v[144:147]
    ds_read_b64_tr_b16 v[208:209], v238 offset:16384
    ds_read_b64_tr_b16 v[210:211], v238 offset:17408
    v_mfma_f32_16x16x32_bf16 v[148:151], v[192:195], v[72:75], v[148:151]
    s_waitcnt vmcnt(20)
    s_barrier
    s_waitcnt lgkmcnt(6)
    v_mfma_f32_16x16x32_bf16 v[152:155], v[196:199], v[8:11], v[152:155]
    ds_read_b64_tr_b16 v[212:213], v239 offset:16384
    ds_read_b64_tr_b16 v[214:215], v239 offset:17408
    v_mfma_f32_16x16x32_bf16 v[156:159], v[196:199], v[72:75], v[156:159]
    s_waitcnt lgkmcnt(6)
    v_mfma_f32_16x16x32_bf16 v[160:163], v[200:203], v[8:11], v[160:163]
    ds_read_b64_tr_b16 v[192:193], v232 offset:24576
    ds_read_b64_tr_b16 v[194:195], v232 offset:25600
    v_mfma_f32_16x16x32_bf16 v[164:167], v[200:203], v[72:75], v[164:167]
    s_add_u32 m0, s28, 0
    s_mov_b32 s29, 0
    buffer_load_dwordx4 v240, s[16:19], s29 offen lds
    s_waitcnt lgkmcnt(6)
    v_mfma_f32_16x16x32_bf16 v[168:171], v[204:207], v[8:11], v[168:171]
    ds_read_b64_tr_b16 v[196:197], v233 offset:24576
    ds_read_b64_tr_b16 v[198:199], v233 offset:25600
    v_mfma_f32_16x16x32_bf16 v[172:175], v[204:207], v[72:75], v[172:175]
    s_waitcnt lgkmcnt(6)
    v_mfma_f32_16x16x32_bf16 v[176:179], v[208:211], v[8:11], v[176:179]
    ds_read_b64_tr_b16 v[200:201], v234 offset:24576
    ds_read_b64_tr_b16 v[202:203], v234 offset:25600
    v_mfma_f32_16x16x32_bf16 v[180:183], v[208:211], v[72:75], v[180:183]
    s_add_u32 m0, s28, 4096
    s_mov_b32 s29, 131072
    buffer_load_dwordx4 v240, s[16:19], s29 offen lds
    s_waitcnt lgkmcnt(6)
    v_mfma_f32_16x16x32_bf16 v[184:187], v[212:215], v[8:11], v[184:187]
    ds_read_b64_tr_b16 v[204:205], v235 offset:24576
    ds_read_b64_tr_b16 v[206:207], v235 offset:25600
    v_mfma_f32_16x16x32_bf16 v[188:191], v[212:215], v[72:75], v[188:191]
    s_waitcnt lgkmcnt(6)
    v_mfma_f32_16x16x32_bf16 v[128:131], v[192:195], v[12:15], v[128:131]
    ds_read_b64_tr_b16 v[208:209], v236 offset:24576
    ds_read_b64_tr_b16 v[210:211], v236 offset:25600
    v_mfma_f32_16x16x32_bf16 v[132:135], v[192:195], v[76:79], v[132:135]
    s_add_u32 m0, s28, 8192
    s_mov_b32 s29, 262144
    buffer_load_dwordx4 v240, s[16:19], s29 offen lds
    s_waitcnt lgkmcnt(6)
    v_mfma_f32_16x16x32_bf16 v[136:139], v[196:199], v[12:15], v[136:139]
    ds_read_b64_tr_b16 v[212:213], v237 offset:24576
    ds_read_b64_tr_b16 v[214:215], v237 offset:25600
    v_mfma_f32_16x16x32_bf16 v[140:143], v[196:199], v[76:79], v[140:143]
    s_waitcnt lgkmcnt(6)
    v_mfma_f32_16x16x32_bf16 v[144:147], v[200:203], v[12:15], v[144:147]
    ds_read_b64_tr_b16 v[192:193], v238 offset:24576
    ds_read_b64_tr_b16 v[194:195], v238 offset:25600
    v_mfma_f32_16x16x32_bf16 v[148:151], v[200:203], v[76:79], v[148:151]
    s_add_u32 m0, s28, 12288
    s_mov_b32 s29, 393216
    buffer_load_dwordx4 v240, s[16:19], s29 offen lds
    s_waitcnt lgkmcnt(6)
    v_mfma_f32_16x16x32_bf16 v[152:155], v[204:207], v[12:15], v[152:155]
    ds_read_b64_tr_b16 v[196:197], v239 offset:24576
    ds_read_b64_tr_b16 v[198:199], v239 offset:25600
    v_mfma_f32_16x16x32_bf16 v[156:159], v[204:207], v[76:79], v[156:159]
    s_waitcnt lgkmcnt(6)
    v_mfma_f32_16x16x32_bf16 v[160:163], v[208:211], v[12:15], v[160:163]
    ds_read_b64_tr_b16 v[200:201], v232 offset:32768
    ds_read_b64_tr_b16 v[202:203], v232 offset:33792
    v_mfma_f32_16x16x32_bf16 v[164:167], v[208:211], v[76:79], v[164:167]
    s_waitcnt lgkmcnt(6)
    v_mfma_f32_16x16x32_bf16 v[168:171], v[212:215], v[12:15], v[168:171]
    ds_read_b64_tr_b16 v[204:205], v233 offset:32768
    ds_read_b64_tr_b16 v[206:207], v233 offset:33792
    v_mfma_f32_16x16x32_bf16 v[172:175], v[212:215], v[76:79], v[172:175]
    s_waitcnt lgkmcnt(6)
    v_mfma_f32_16x16x32_bf16 v[176:179], v[192:195], v[12:15], v[176:179]
    ds_read_b64_tr_b16 v[208:209], v234 offset:32768
    ds_read_b64_tr_b16 v[210:211], v234 offset:33792
    v_mfma_f32_16x16x32_bf16 v[180:183], v[192:195], v[76:79], v[180:183]
    s_waitcnt lgkmcnt(6)
    v_mfma_f32_16x16x32_bf16 v[184:187], v[196:199], v[12:15], v[184:187]
    ds_read_b64_tr_b16 v[212:213], v235 offset:32768
    ds_read_b64_tr_b16 v[214:215], v235 offset:33792
    v_mfma_f32_16x16x32_bf16 v[188:191], v[196:199], v[76:79], v[188:191]
    s_waitcnt lgkmcnt(6)
    v_mfma_f32_16x16x32_bf16 v[128:131], v[200:203], v[16:19], v[128:131]
    ds_read_b64_tr_b16 v[192:193], v236 offset:32768
    ds_read_b64_tr_b16 v[194:195], v236 offset:33792
    v_mfma_f32_16x16x32_bf16 v[132:135], v[200:203], v[80:83], v[132:135]
    s_waitcnt lgkmcnt(6)
    v_mfma_f32_16x16x32_bf16 v[136:139], v[204:207], v[16:19], v[136:139]
    ds_read_b64_tr_b16 v[196:197], v237 offset:32768
    ds_read_b64_tr_b16 v[198:199], v237 offset:33792
    v_mfma_f32_16x16x32_bf16 v[140:143], v[204:207], v[80:83], v[140:143]
    s_waitcnt lgkmcnt(6)
    v_mfma_f32_16x16x32_bf16 v[144:147], v[208:211], v[16:19], v[144:147]
    ds_read_b64_tr_b16 v[200:201], v238 offset:32768
    ds_read_b64_tr_b16 v[202:203], v238 offset:33792
    v_mfma_f32_16x16x32_bf16 v[148:151], v[208:211], v[80:83], v[148:151]
    s_waitcnt vmcnt(20)
    s_barrier
    s_waitcnt lgkmcnt(6)
    v_mfma_f32_16x16x32_bf16 v[152:155], v[212:215], v[16:19], v[152:155]
    ds_read_b64_tr_b16 v[204:205], v239 offset:32768
    ds_read_b64_tr_b16 v[206:207], v239 offset:33792
    v_mfma_f32_16x16x32_bf16 v[156:159], v[212:215], v[80:83], v[156:159]
    s_waitcnt lgkmcnt(6)
    v_mfma_f32_16x16x32_bf16 v[160:163], v[192:195], v[16:19], v[160:163]
    ds_read_b64_tr_b16 v[208:209], v232 offset:40960
    ds_read_b64_tr_b16 v[210:211], v232 offset:41984
    v_mfma_f32_16x16x32_bf16 v[164:167], v[192:195], v[80:83], v[164:167]
    s_add_u32 m0, s28, 16384
    s_mov_b32 s29, 524288
    buffer_load_dwordx4 v240, s[16:19], s29 offen lds
    s_waitcnt lgkmcnt(6)
    v_mfma_f32_16x16x32_bf16 v[168:171], v[196:199], v[16:19], v[168:171]
    ds_read_b64_tr_b16 v[212:213], v233 offset:40960
    ds_read_b64_tr_b16 v[214:215], v233 offset:41984
    v_mfma_f32_16x16x32_bf16 v[172:175], v[196:199], v[80:83], v[172:175]
    s_waitcnt lgkmcnt(6)
    v_mfma_f32_16x16x32_bf16 v[176:179], v[200:203], v[16:19], v[176:179]
    ds_read_b64_tr_b16 v[192:193], v234 offset:40960
    ds_read_b64_tr_b16 v[194:195], v234 offset:41984
    v_mfma_f32_16x16x32_bf16 v[180:183], v[200:203], v[80:83], v[180:183]
    s_add_u32 m0, s28, 20480
    s_mov_b32 s29, 655360
    buffer_load_dwordx4 v240, s[16:19], s29 offen lds
    s_waitcnt lgkmcnt(6)
    v_mfma_f32_16x16x32_bf16 v[184:187], v[204:207], v[16:19], v[184:187]
    ds_read_b64_tr_b16 v[196:197], v235 offset:40960
    ds_read_b64_tr_b16 v[198:199], v235 offset:41984
    v_mfma_f32_16x16x32_bf16 v[188:191], v[204:207], v[80:83], v[188:191]
    s_waitcnt lgkmcnt(6)
    v_mfma_f32_16x16x32_bf16 v[128:131], v[208:211], v[20:23], v[128:131]
    ds_read_b64_tr_b16 v[200:201], v236 offset:40960
    ds_read_b64_tr_b16 v[202:203], v236 offset:41984
    v_mfma_f32_16x16x32_bf16 v[132:135], v[208:211], v[84:87], v[132:135]
    s_add_u32 m0, s28, 24576
    s_mov_b32 s29, 786432
    buffer_load_dwordx4 v240, s[16:19], s29 offen lds
    s_waitcnt lgkmcnt(6)
    v_mfma_f32_16x16x32_bf16 v[136:139], v[212:215], v[20:23], v[136:139]
    ds_read_b64_tr_b16 v[204:205], v237 offset:40960
    ds_read_b64_tr_b16 v[206:207], v237 offset:41984
    v_mfma_f32_16x16x32_bf16 v[140:143], v[212:215], v[84:87], v[140:143]
    s_waitcnt lgkmcnt(6)
    v_mfma_f32_16x16x32_bf16 v[144:147], v[192:195], v[20:23], v[144:147]
    ds_read_b64_tr_b16 v[208:209], v238 offset:40960
    ds_read_b64_tr_b16 v[210:211], v238 offset:41984
    v_mfma_f32_16x16x32_bf16 v[148:151], v[192:195], v[84:87], v[148:151]
    s_add_u32 m0, s28, 28672
    s_mov_b32 s29, 917504
    buffer_load_dwordx4 v240, s[16:19], s29 offen lds
    s_waitcnt lgkmcnt(6)
    v_mfma_f32_16x16x32_bf16 v[152:155], v[196:199], v[20:23], v[152:155]
    ds_read_b64_tr_b16 v[212:213], v239 offset:40960
    ds_read_b64_tr_b16 v[214:215], v239 offset:41984
    v_mfma_f32_16x16x32_bf16 v[156:159], v[196:199], v[84:87], v[156:159]
    s_waitcnt lgkmcnt(6)
    v_mfma_f32_16x16x32_bf16 v[160:163], v[200:203], v[20:23], v[160:163]
    ds_read_b64_tr_b16 v[192:193], v232 offset:49152
    ds_read_b64_tr_b16 v[194:195], v232 offset:50176
    v_mfma_f32_16x16x32_bf16 v[164:167], v[200:203], v[84:87], v[164:167]
    s_waitcnt lgkmcnt(6)
    v_mfma_f32_16x16x32_bf16 v[168:171], v[204:207], v[20:23], v[168:171]
    ds_read_b64_tr_b16 v[196:197], v233 offset:49152
    ds_read_b64_tr_b16 v[198:199], v233 offset:50176
    v_mfma_f32_16x16x32_bf16 v[172:175], v[204:207], v[84:87], v[172:175]
    s_waitcnt lgkmcnt(6)
    v_mfma_f32_16x16x32_bf16 v[176:179], v[208:211], v[20:23], v[176:179]
    ds_read_b64_tr_b16 v[200:201], v234 offset:49152
    ds_read_b64_tr_b16 v[202:203], v234 offset:50176
    v_mfma_f32_16x16x32_bf16 v[180:183], v[208:211], v[84:87], v[180:183]
    s_waitcnt lgkmcnt(6)
    v_mfma_f32_16x16x32_bf16 v[184:187], v[212:215], v[20:23], v[184:187]
    ds_read_b64_tr_b16 v[204:205], v235 offset:49152
    ds_read_b64_tr_b16 v[206:207], v235 offset:50176
    v_mfma_f32_16x16x32_bf16 v[188:191], v[212:215], v[84:87], v[188:191]
    s_waitcnt lgkmcnt(6)
    v_mfma_f32_16x16x32_bf16 v[128:131], v[192:195], v[24:27], v[128:131]
    ds_read_b64_tr_b16 v[208:209], v236 offset:49152
    ds_read_b64_tr_b16 v[210:211], v236 offset:50176
    v_mfma_f32_16x16x32_bf16 v[132:135], v[192:195], v[88:91], v[132:135]
    s_waitcnt lgkmcnt(6)
    v_mfma_f32_16x16x32_bf16 v[136:139], v[196:199], v[24:27], v[136:139]
    ds_read_b64_tr_b16 v[212:213], v237 offset:49152
    ds_read_b64_tr_b16 v[214:215], v237 offset:50176
    v_mfma_f32_16x16x32_bf16 v[140:143], v[196:199], v[88:91], v[140:143]
    s_waitcnt lgkmcnt(6)
    v_mfma_f32_16x16x32_bf16 v[144:147], v[200:203], v[24:27], v[144:147]
    ds_read_b64_tr_b16 v[192:193], v238 offset:49152
    ds_read_b64_tr_b16 v[194:195], v238 offset:50176
    v_mfma_f32_16x16x32_bf16 v[148:151], v[200:203], v[88:91], v[148:151]
    s_waitcnt vmcnt(20)
    s_waitcnt vmcnt(12)
    s_barrier
    s_waitcnt lgkmcnt(6)
    v_mfma_f32_16x16x32_bf16 v[152:155], v[204:207], v[24:27], v[152:155]
    ds_read_b64_tr_b16 v[196:197], v239 offset:49152
    ds_read_b64_tr_b16 v[198:199], v239 offset:50176
    v_mfma_f32_16x16x32_bf16 v[156:159], v[204:207], v[88:91], v[156:159]
    s_waitcnt lgkmcnt(6)
    v_mfma_f32_16x16x32_bf16 v[160:163], v[208:211], v[24:27], v[160:163]
    ds_read_b64_tr_b16 v[200:201], v232 offset:57344
    ds_read_b64_tr_b16 v[202:203], v232 offset:58368
    v_mfma_f32_16x16x32_bf16 v[164:167], v[208:211], v[88:91], v[164:167]
    s_add_u32 m0, s28, 32768
    s_mov_b32 s29, 1048576
    buffer_load_dwordx4 v240, s[16:19], s29 offen lds
    s_waitcnt lgkmcnt(6)
    v_mfma_f32_16x16x32_bf16 v[168:171], v[212:215], v[24:27], v[168:171]
    ds_read_b64_tr_b16 v[204:205], v233 offset:57344
    ds_read_b64_tr_b16 v[206:207], v233 offset:58368
    v_mfma_f32_16x16x32_bf16 v[172:175], v[212:215], v[88:91], v[172:175]
    s_waitcnt lgkmcnt(6)
    v_mfma_f32_16x16x32_bf16 v[176:179], v[192:195], v[24:27], v[176:179]
    ds_read_b64_tr_b16 v[208:209], v234 offset:57344
    ds_read_b64_tr_b16 v[210:211], v234 offset:58368
    v_mfma_f32_16x16x32_bf16 v[180:183], v[192:195], v[88:91], v[180:183]
    s_add_u32 m0, s28, 36864
    s_mov_b32 s29, 1179648
    buffer_load_dwordx4 v240, s[16:19], s29 offen lds
    s_waitcnt lgkmcnt(6)
    v_mfma_f32_16x16x32_bf16 v[184:187], v[196:199], v[24:27], v[184:187]
    ds_read_b64_tr_b16 v[212:213], v235 offset:57344
    ds_read_b64_tr_b16 v[214:215], v235 offset:58368
    v_mfma_f32_16x16x32_bf16 v[188:191], v[196:199], v[88:91], v[188:191]
    s_waitcnt lgkmcnt(6)
    v_mfma_f32_16x16x32_bf16 v[128:131], v[200:203], v[28:31], v[128:131]
    ds_read_b64_tr_b16 v[192:193], v236 offset:57344
    ds_read_b64_tr_b16 v[194:195], v236 offset:58368
    v_mfma_f32_16x16x32_bf16 v[132:135], v[200:203], v[92:95], v[132:135]
    s_add_u32 m0, s28, 40960
    s_mov_b32 s29, 1310720
    buffer_load_dwordx4 v240, s[16:19], s29 offen lds
    s_waitcnt lgkmcnt(6)
    v_mfma_f32_16x16x32_bf16 v[136:139], v[204:207], v[28:31], v[136:139]
    ds_read_b64_tr_b16 v[196:197], v237 offset:57344
    ds_read_b64_tr_b16 v[198:199], v237 offset:58368
    v_mfma_f32_16x16x32_bf16 v[140:143], v[204:207], v[92:95], v[140:143]
    s_waitcnt lgkmcnt(6)
    v_mfma_f32_16x16x32_bf16 v[144:147], v[208:211], v[28:31], v[144:147]
    ds_read_b64_tr_b16 v[200:201], v238 offset:57344
    ds_read_b64_tr_b16 v[202:203], v238 offset:58368
    v_mfma_f32_16x16x32_bf16 v[148:151], v[208:211], v[92:95], v[148:151]
    s_add_u32 m0, s28, 45056
    s_mov_b32 s29, 1441792
    buffer_load_dwordx4 v240, s[16:19], s29 offen lds
    s_waitcnt lgkmcnt(6)
    v_mfma_f32_16x16x32_bf16 v[152:155], v[212:215], v[28:31], v[152:155]
    ds_read_b64_tr_b16 v[204:205], v239 offset:57344
    ds_read_b64_tr_b16 v[206:207], v239 offset:58368
    v_mfma_f32_16x16x32_bf16 v[156:159], v[212:215], v[92:95], v[156:159]
    s_waitcnt lgkmcnt(6)
    v_mfma_f32_16x16x32_bf16 v[160:163], v[192:195], v[28:31], v[160:163]
    ds_read_b64_tr_b16 v[208:209], v224 offset:0
    ds_read_b64_tr_b16 v[210:211], v224 offset:1024
    v_mfma_f32_16x16x32_bf16 v[164:167], v[192:195], v[92:95], v[164:167]
    s_cmp_lg_u32 s31, 1
    s_cbranch_scc1 Lm_kvn
    s_cmp_lg_u32 s3, 0
    s_cbranch_scc1 Lm_kvn
    v_mov_b32 v250, 1
    s_mov_b64 exec, 1
    buffer_atomic_add v250, off, s[8:11], s92
    s_mov_b64 exec, -1
Lm_kvn:
    s_waitcnt lgkmcnt(6)
    v_mfma_f32_16x16x32_bf16 v[168:171], v[196:199], v[28:31], v[168:171]
    ds_read_b64_tr_b16 v[212:213], v225 offset:0
    ds_read_b64_tr_b16 v[214:215], v225 offset:1024
    v_mfma_f32_16x16x32_bf16 v[172:175], v[196:199], v[92:95], v[172:175]
    s_waitcnt lgkmcnt(6)
    v_mfma_f32_16x16x32_bf16 v[176:179], v[200:203], v[28:31], v[176:179]
    ds_read_b64_tr_b16 v[192:193], v226 offset:0
    ds_read_b64_tr_b16 v[194:195], v226 offset:1024
    v_mfma_f32_16x16x32_bf16 v[180:183], v[200:203], v[92:95], v[180:183]
    s_waitcnt lgkmcnt(6)
    v_mfma_f32_16x16x32_bf16 v[184:187], v[204:207], v[28:31], v[184:187]
    ds_read_b64_tr_b16 v[196:197], v227 offset:0
    ds_read_b64_tr_b16 v[198:199], v227 offset:1024
    v_mfma_f32_16x16x32_bf16 v[188:191], v[204:207], v[92:95], v[188:191]
    s_waitcnt lgkmcnt(6)
    v_mfma_f32_16x16x32_bf16 v[128:131], v[208:211], v[32:35], v[128:131]
    ds_read_b64_tr_b16 v[200:201], v228 offset:0
    ds_read_b64_tr_b16 v[202:203], v228 offset:1024
    v_mfma_f32_16x16x32_bf16 v[132:135], v[208:211], v[96:99], v[132:135]
    s_waitcnt lgkmcnt(6)
    v_mfma_f32_16x16x32_bf16 v[136:139], v[212:215], v[32:35], v[136:139]
    ds_read_b64_tr_b16 v[204:205], v229 offset:0
    ds_read_b64_tr_b16 v[206:207], v229 offset:1024
    v_mfma_f32_16x16x32_bf16 v[140:143], v[212:215], v[96:99], v[140:143]
    s_waitcnt lgkmcnt(6)
    v_mfma_f32_16x16x32_bf16 v[144:147], v[192:195], v[32:35], v[144:147]
    ds_read_b64_tr_b16 v[208:209], v230 offset:0
    ds_read_b64_tr_b16 v[210:211], v230 offset:1024
    v_mfma_f32_16x16x32_bf16 v[148:151], v[192:195], v[96:99], v[148:151]
    s_barrier
    s_waitcnt lgkmcnt(6)
    v_mfma_f32_16x16x32_bf16 v[152:155], v[196:199], v[32:35], v[152:155]
    ds_read_b64_tr_b16 v[212:213], v231 offset:0
    ds_read_b64_tr_b16 v[214:215], v231 offset:1024
    v_mfma_f32_16x16x32_bf16 v[156:159], v[196:199], v[96:99], v[156:159]
    s_waitcnt lgkmcnt(6)
    v_mfma_f32_16x16x32_bf16 v[160:163], v[200:203], v[32:35], v[160:163]
    ds_read_b64_tr_b16 v[192:193], v224 offset:8192
    ds_read_b64_tr_b16 v[194:195], v224 offset:9216
    v_mfma_f32_16x16x32_bf16 v[164:167], v[200:203], v[96:99], v[164:167]
    s_add_u32 m0, s28, 49152
    s_mov_b32 s29, 1572864
    buffer_load_dwordx4 v240, s[16:19], s29 offen lds
    s_waitcnt lgkmcnt(6)
    v_mfma_f32_16x16x32_bf16 v[168:171], v[204:207], v[32:35], v[168:171]
    ds_read_b64_tr_b16 v[196:197], v225 offset:8192
    ds_read_b64_tr_b16 v[198:199], v225 offset:9216
    v_mfma_f32_16x16x32_bf16 v[172:175], v[204:207], v[96:99], v[172:175]
    s_waitcnt lgkmcnt(6)
    v_mfma_f32_16x16x32_bf16 v[176:179], v[208:211], v[32:35], v[176:179]
    ds_read_b64_tr_b16 v[200:201], v226 offset:8192
    ds_read_b64_tr_b16 v[202:203], v226 offset:9216
    v_mfma_f32_16x16x32_bf16 v[180:183], v[208:211], v[96:99], v[180:183]
    s_add_u32 m0, s28, 53248
    s_mov_b32 s29, 1703936
    buffer_load_dwordx4 v240, s[16:19], s29 offen lds
    s_waitcnt lgkmcnt(6)
    v_mfma_f32_16x16x32_bf16 v[184:187], v[212:215], v[32:35], v[184:187]
    ds_read_b64_tr_b16 v[204:205], v227 offset:8192
    ds_read_b64_tr_b16 v[206:207], v227 offset:9216
    v_mfma_f32_16x16x32_bf16 v[188:191], v[212:215], v[96:99], v[188:191]
    s_waitcnt lgkmcnt(6)
    v_mfma_f32_16x16x32_bf16 v[128:131], v[192:195], v[36:39], v[128:131]
    ds_read_b64_tr_b16 v[208:209], v228 offset:8192
    ds_read_b64_tr_b16 v[210:211], v228 offset:9216
    v_mfma_f32_16x16x32_bf16 v[132:135], v[192:195], v[100:103], v[132:135]
    s_add_u32 m0, s28, 57344
    s_mov_b32 s29, 1835008
    buffer_load_dwordx4 v240, s[16:19], s29 offen lds
    s_waitcnt lgkmcnt(6)
    v_mfma_f32_16x16x32_bf16 v[136:139], v[196:199], v[36:39], v[136:139]
    ds_read_b64_tr_b16 v[212:213], v229 offset:8192
    ds_read_b64_tr_b16 v[214:215], v229 offset:9216
    v_mfma_f32_16x16x32_bf16 v[140:143], v[196:199], v[100:103], v[140:143]
    s_waitcnt lgkmcnt(6)
    v_mfma_f32_16x16x32_bf16 v[144:147], v[200:203], v[36:39], v[144:147]
    ds_read_b64_tr_b16 v[192:193], v230 offset:8192
    ds_read_b64_tr_b16 v[194:195], v230 offset:9216
    v_mfma_f32_16x16x32_bf16 v[148:151], v[200:203], v[100:103], v[148:151]
    s_add_u32 m0, s28, 61440
    s_mov_b32 s29, 1966080
    buffer_load_dwordx4 v240, s[16:19], s29 offen lds
    s_waitcnt lgkmcnt(6)
    v_mfma_f32_16x16x32_bf16 v[152:155], v[204:207], v[36:39], v[152:155]
    ds_read_b64_tr_b16 v[196:197], v231 offset:8192
    ds_read_b64_tr_b16 v[198:199], v231 offset:9216
    v_mfma_f32_16x16x32_bf16 v[156:159], v[204:207], v[100:103], v[156:159]
    s_waitcnt lgkmcnt(6)
    v_mfma_f32_16x16x32_bf16 v[160:163], v[208:211], v[36:39], v[160:163]
    ds_read_b64_tr_b16 v[200:201], v224 offset:16384
    ds_read_b64_tr_b16 v[202:203], v224 offset:17408
    v_mfma_f32_16x16x32_bf16 v[164:167], v[208:211], v[100:103], v[164:167]
    s_waitcnt lgkmcnt(6)
    v_mfma_f32_16x16x32_bf16 v[168:171], v[212:215], v[36:39], v[168:171]
    ds_read_b64_tr_b16 v[204:205], v225 offset:16384
    ds_read_b64_tr_b16 v[206:207], v225 offset:17408
    v_mfma_f32_16x16x32_bf16 v[172:175], v[212:215], v[100:103], v[172:175]
    s_waitcnt lgkmcnt(6)
    v_mfma_f32_16x16x32_bf16 v[176:179], v[192:195], v[36:39], v[176:179]
    ds_read_b64_tr_b16 v[208:209], v226 offset:16384
    ds_read_b64_tr_b16 v[210:211], v226 offset:17408
    v_mfma_f32_16x16x32_bf16 v[180:183], v[192:195], v[100:103], v[180:183]
    s_waitcnt lgkmcnt(6)
    v_mfma_f32_16x16x32_bf16 v[184:187], v[196:199], v[36:39], v[184:187]
    ds_read_b64_tr_b16 v[212:213], v227 offset:16384
    ds_read_b64_tr_b16 v[214:215], v227 offset:17408
    v_mfma_f32_16x16x32_bf16 v[188:191], v[196:199], v[100:103], v[188:191]
    s_waitcnt lgkmcnt(6)
    v_mfma_f32_16x16x32_bf16 v[128:131], v[200:203], v[40:43], v[128:131]
    ds_read_b64_tr_b16 v[192:193], v228 offset:16384
    ds_read_b64_tr_b16 v[194:195], v228 offset:17408
    v_mfma_f32_16x16x32_bf16 v[132:135], v[200:203], v[104:107], v[132:135]
    s_waitcnt lgkmcnt(6)
    v_mfma_f32_16x16x32_bf16 v[136:139], v[204:207], v[40:43], v[136:139]
    ds_read_b64_tr_b16 v[196:197], v229 offset:16384
    ds_read_b64_tr_b16 v[198:199], v229 offset:17408
    v_mfma_f32_16x16x32_bf16 v[140:143], v[204:207], v[104:107], v[140:143]
    s_waitcnt lgkmcnt(6)
    v_mfma_f32_16x16x32_bf16 v[144:147], v[208:211], v[40:43], v[144:147]
    ds_read_b64_tr_b16 v[200:201], v230 offset:16384
    ds_read_b64_tr_b16 v[202:203], v230 offset:17408
    v_mfma_f32_16x16x32_bf16 v[148:151], v[208:211], v[104:107], v[148:151]
    s_barrier
    s_waitcnt lgkmcnt(6)
    v_mfma_f32_16x16x32_bf16 v[152:155], v[212:215], v[40:43], v[152:155]
    ds_read_b64_tr_b16 v[204:205], v231 offset:16384
    ds_read_b64_tr_b16 v[206:207], v231 offset:17408
    v_mfma_f32_16x16x32_bf16 v[156:159], v[212:215], v[104:107], v[156:159]
    s_waitcnt lgkmcnt(6)
    v_mfma_f32_16x16x32_bf16 v[160:163], v[192:195], v[40:43], v[160:163]
    ds_read_b64_tr_b16 v[208:209], v224 offset:24576
    ds_read_b64_tr_b16 v[210:211], v224 offset:25600
    v_mfma_f32_16x16x32_bf16 v[164:167], v[192:195], v[104:107], v[164:167]
    s_add_u32 m0, s28, 65536
    s_mov_b32 s29, 2097152
    buffer_load_dwordx4 v240, s[16:19], s29 offen lds
    s_waitcnt lgkmcnt(6)
    v_mfma_f32_16x16x32_bf16 v[168:171], v[196:199], v[40:43], v[168:171]
    ds_read_b64_tr_b16 v[212:213], v225 offset:24576
    ds_read_b64_tr_b16 v[214:215], v225 offset:25600
    v_mfma_f32_16x16x32_bf16 v[172:175], v[196:199], v[104:107], v[172:175]
    s_waitcnt lgkmcnt(6)
    v_mfma_f32_16x16x32_bf16 v[176:179], v[200:203], v[40:43], v[176:179]
    ds_read_b64_tr_b16 v[192:193], v226 offset:24576
    ds_read_b64_tr_b16 v[194:195], v226 offset:25600
    v_mfma_f32_16x16x32_bf16 v[180:183], v[200:203], v[104:107], v[180:183]
    s_add_u32 m0, s28, 69632
    s_mov_b32 s29, 2228224
    buffer_load_dwordx4 v240, s[16:19], s29 offen lds
    s_waitcnt lgkmcnt(6)
    v_mfma_f32_16x16x32_bf16 v[184:187], v[204:207], v[40:43], v[184:187]
    ds_read_b64_tr_b16 v[196:197], v227 offset:24576
    ds_read_b64_tr_b16 v[198:199], v227 offset:25600
    v_mfma_f32_16x16x32_bf16 v[188:191], v[204:207], v[104:107], v[188:191]
    s_waitcnt lgkmcnt(6)
    v_mfma_f32_16x16x32_bf16 v[128:131], v[208:211], v[44:47], v[128:131]
    ds_read_b64_tr_b16 v[200:201], v228 offset:24576
    ds_read_b64_tr_b16 v[202:203], v228 offset:25600
    v_mfma_f32_16x16x32_bf16 v[132:135], v[208:211], v[108:111], v[132:135]
    s_add_u32 m0, s28, 73728
    s_mov_b32 s29, 2359296
    buffer_load_dwordx4 v240, s[16:19], s29 offen lds
    s_waitcnt lgkmcnt(6)
    v_mfma_f32_16x16x32_bf16 v[136:139], v[212:215], v[44:47], v[136:139]
    ds_read_b64_tr_b16 v[204:205], v229 offset:24576
    ds_read_b64_tr_b16 v[206:207], v229 offset:25600
    v_mfma_f32_16x16x32_bf16 v[140:143], v[212:215], v[108:111], v[140:143]
    s_waitcnt lgkmcnt(6)
    v_mfma_f32_16x16x32_bf16 v[144:147], v[192:195], v[44:47], v[144:147]
    ds_read_b64_tr_b16 v[208:209], v230 offset:24576
    ds_read_b64_tr_b16 v[210:211], v230 offset:25600
    v_mfma_f32_16x16x32_bf16 v[148:151], v[192:195], v[108:111], v[148:151]
    s_add_u32 m0, s28, 77824
    s_mov_b32 s29, 2490368
    buffer_load_dwordx4 v240, s[16:19], s29 offen lds
    s_waitcnt lgkmcnt(6)
    v_mfma_f32_16x16x32_bf16 v[152:155], v[196:199], v[44:47], v[152:155]
    ds_read_b64_tr_b16 v[212:213], v231 offset:24576
    ds_read_b64_tr_b16 v[214:215], v231 offset:25600
    v_mfma_f32_16x16x32_bf16 v[156:159], v[196:199], v[108:111], v[156:159]
    s_waitcnt lgkmcnt(6)
    v_mfma_f32_16x16x32_bf16 v[160:163], v[200:203], v[44:47], v[160:163]
    ds_read_b64_tr_b16 v[192:193], v224 offset:32768
    ds_read_b64_tr_b16 v[194:195], v224 offset:33792
    v_mfma_f32_16x16x32_bf16 v[164:167], v[200:203], v[108:111], v[164:167]
    s_waitcnt lgkmcnt(6)
    v_mfma_f32_16x16x32_bf16 v[168:171], v[204:207], v[44:47], v[168:171]
    ds_read_b64_tr_b16 v[196:197], v225 offset:32768
    ds_read_b64_tr_b16 v[198:199], v225 offset:33792
    v_mfma_f32_16x16x32_bf16 v[172:175], v[204:207], v[108:111], v[172:175]
    s_waitcnt lgkmcnt(6)
    v_mfma_f32_16x16x32_bf16 v[176:179], v[208:211], v[44:47], v[176:179]
    ds_read_b64_tr_b16 v[200:201], v226 offset:32768
    ds_read_b64_tr_b16 v[202:203], v226 offset:33792
    v_mfma_f32_16x16x32_bf16 v[180:183], v[208:211], v[108:111], v[180:183]
    s_waitcnt lgkmcnt(6)
    v_mfma_f32_16x16x32_bf16 v[184:187], v[212:215], v[44:47], v[184:187]
    ds_read_b64_tr_b16 v[204:205], v227 offset:32768
    ds_read_b64_tr_b16 v[206:207], v227 offset:33792
    v_mfma_f32_16x16x32_bf16 v[188:191], v[212:215], v[108:111], v[188:191]
    s_waitcnt lgkmcnt(6)
    v_mfma_f32_16x16x32_bf16 v[128:131], v[192:195], v[48:51], v[128:131]
    ds_read_b64_tr_b16 v[208:209], v228 offset:32768
    ds_read_b64_tr_b16 v[210:211], v228 offset:33792
    v_mfma_f32_16x16x32_bf16 v[132:135], v[192:195], v[112:115], v[132:135]
    s_waitcnt lgkmcnt(6)
    v_mfma_f32_16x16x32_bf16 v[136:139], v[196:199], v[48:51], v[136:139]
    ds_read_b64_tr_b16 v[212:213], v229 offset:32768
    ds_read_b64_tr_b16 v[214:215], v229 offset:33792
    v_mfma_f32_16x16x32_bf16 v[140:143], v[196:199], v[112:115], v[140:143]
    s_waitcnt lgkmcnt(6)
    v_mfma_f32_16x16x32_bf16 v[144:147], v[200:203], v[48:51], v[144:147]
    ds_read_b64_tr_b16 v[192:193], v230 offset:32768
    ds_read_b64_tr_b16 v[194:195], v230 offset:33792
    v_mfma_f32_16x16x32_bf16 v[148:151], v[200:203], v[112:115], v[148:151]
    s_waitcnt vmcnt(20)
    s_barrier
    s_waitcnt lgkmcnt(6)
    v_mfma_f32_16x16x32_bf16 v[152:155], v[204:207], v[48:51], v[152:155]
    ds_read_b64_tr_b16 v[196:197], v231 offset:32768
    ds_read_b64_tr_b16 v[198:199], v231 offset:33792
    v_mfma_f32_16x16x32_bf16 v[156:159], v[204:207], v[112:115], v[156:159]
    s_waitcnt lgkmcnt(6)
    v_mfma_f32_16x16x32_bf16 v[160:163], v[208:211], v[48:51], v[160:163]
    ds_read_b64_tr_b16 v[200:201], v224 offset:40960
    ds_read_b64_tr_b16 v[202:203], v224 offset:41984
    v_mfma_f32_16x16x32_bf16 v[164:167], v[208:211], v[112:115], v[164:167]
    s_add_u32 m0, s28, 81920
    s_mov_b32 s29, 2621440
    buffer_load_dwordx4 v240, s[16:19], s29 offen lds
    s_waitcnt lgkmcnt(6)
    v_mfma_f32_16x16x32_bf16 v[168:171], v[212:215], v[48:51], v[168:171]
    ds_read_b64_tr_b16 v[204:205], v225 offset:40960
    ds_read_b64_tr_b16 v[206:207], v225 offset:41984
    v_mfma_f32_16x16x32_bf16 v[172:175], v[212:215], v[112:115], v[172:175]
    s_waitcnt lgkmcnt(6)
    v_mfma_f32_16x16x32_bf16 v[176:179], v[192:195], v[48:51], v[176:179]
    ds_read_b64_tr_b16 v[208:209], v226 offset:40960
    ds_read_b64_tr_b16 v[210:211], v226 offset:41984
    v_mfma_f32_16x16x32_bf16 v[180:183], v[192:195], v[112:115], v[180:183]
    s_add_u32 m0, s28, 86016
    s_mov_b32 s29, 2752512
    buffer_load_dwordx4 v240, s[16:19], s29 offen lds
    s_waitcnt lgkmcnt(6)
    v_mfma_f32_16x16x32_bf16 v[184:187], v[196:199], v[48:51], v[184:187]
    ds_read_b64_tr_b16 v[212:213], v227 offset:40960
    ds_read_b64_tr_b16 v[214:215], v227 offset:41984
    v_mfma_f32_16x16x32_bf16 v[188:191], v[196:199], v[112:115], v[188:191]
    s_waitcnt lgkmcnt(6)
    v_mfma_f32_16x16x32_bf16 v[128:131], v[200:203], v[52:55], v[128:131]
    ds_read_b64_tr_b16 v[192:193], v228 offset:40960
    ds_read_b64_tr_b16 v[194:195], v228 offset:41984
    v_mfma_f32_16x16x32_bf16 v[132:135], v[200:203], v[116:119], v[132:135]
    s_add_u32 m0, s28, 90112
    s_mov_b32 s29, 2883584
    buffer_load_dwordx4 v240, s[16:19], s29 offen lds
    s_waitcnt lgkmcnt(6)
    v_mfma_f32_16x16x32_bf16 v[136:139], v[204:207], v[52:55], v[136:139]
    ds_read_b64_tr_b16 v[196:197], v229 offset:40960
    ds_read_b64_tr_b16 v[198:199], v229 offset:41984
    v_mfma_f32_16x16x32_bf16 v[140:143], v[204:207], v[116:119], v[140:143]
    s_waitcnt lgkmcnt(6)
    v_mfma_f32_16x16x32_bf16 v[144:147], v[208:211], v[52:55], v[144:147]
    ds_read_b64_tr_b16 v[200:201], v230 offset:40960
    ds_read_b64_tr_b16 v[202:203], v230 offset:41984
    v_mfma_f32_16x16x32_bf16 v[148:151], v[208:211], v[116:119], v[148:151]
    s_add_u32 m0, s28, 94208
    s_mov_b32 s29, 3014656
    buffer_load_dwordx4 v240, s[16:19], s29 offen lds
    s_waitcnt lgkmcnt(6)
    v_mfma_f32_16x16x32_bf16 v[152:155], v[212:215], v[52:55], v[152:155]
    ds_read_b64_tr_b16 v[204:205], v231 offset:40960
    ds_read_b64_tr_b16 v[206:207], v231 offset:41984
    v_mfma_f32_16x16x32_bf16 v[156:159], v[212:215], v[116:119], v[156:159]
    s_waitcnt lgkmcnt(6)
    v_mfma_f32_16x16x32_bf16 v[160:163], v[192:195], v[52:55], v[160:163]
    ds_read_b64_tr_b16 v[208:209], v224 offset:49152
    ds_read_b64_tr_b16 v[210:211], v224 offset:50176
    v_mfma_f32_16x16x32_bf16 v[164:167], v[192:195], v[116:119], v[164:167]
    s_waitcnt lgkmcnt(6)
    v_mfma_f32_16x16x32_bf16 v[168:171], v[196:199], v[52:55], v[168:171]
    ds_read_b64_tr_b16 v[212:213], v225 offset:49152
    ds_read_b64_tr_b16 v[214:215], v225 offset:50176
    v_mfma_f32_16x16x32_bf16 v[172:175], v[196:199], v[116:119], v[172:175]
    s_waitcnt lgkmcnt(6)
    v_mfma_f32_16x16x32_bf16 v[176:179], v[200:203], v[52:55], v[176:179]
    ds_read_b64_tr_b16 v[192:193], v226 offset:49152
    ds_read_b64_tr_b16 v[194:195], v226 offset:50176
    v_mfma_f32_16x16x32_bf16 v[180:183], v[200:203], v[116:119], v[180:183]
    s_waitcnt lgkmcnt(6)
    v_mfma_f32_16x16x32_bf16 v[184:187], v[204:207], v[52:55], v[184:187]
    ds_read_b64_tr_b16 v[196:197], v227 offset:49152
    ds_read_b64_tr_b16 v[198:199], v227 offset:50176
    v_mfma_f32_16x16x32_bf16 v[188:191], v[204:207], v[116:119], v[188:191]
    s_waitcnt lgkmcnt(6)
    v_mfma_f32_16x16x32_bf16 v[128:131], v[208:211], v[56:59], v[128:131]
    ds_read_b64_tr_b16 v[200:201], v228 offset:49152
    ds_read_b64_tr_b16 v[202:203], v228 offset:50176
    v_mfma_f32_16x16x32_bf16 v[132:135], v[208:211], v[120:123], v[132:135]
    s_waitcnt lgkmcnt(6)
    v_mfma_f32_16x16x32_bf16 v[136:139], v[212:215], v[56:59], v[136:139]
    ds_read_b64_tr_b16 v[204:205], v229 offset:49152
    ds_read_b64_tr_b16 v[206:207], v229 offset:50176
    v_mfma_f32_16x16x32_bf16 v[140:143], v[212:215], v[120:123], v[140:143]
    s_waitcnt lgkmcnt(6)
    v_mfma_f32_16x16x32_bf16 v[144:147], v[192:195], v[56:59], v[144:147]
    ds_read_b64_tr_b16 v[208:209], v230 offset:49152
    ds_read_b64_tr_b16 v[210:211], v230 offset:50176
    v_mfma_f32_16x16x32_bf16 v[148:151], v[192:195], v[120:123], v[148:151]
    s_waitcnt vmcnt(20)
    s_barrier
    s_waitcnt lgkmcnt(6)
    v_mfma_f32_16x16x32_bf16 v[152:155], v[196:199], v[56:59], v[152:155]
    ds_read_b64_tr_b16 v[212:213], v231 offset:49152
    ds_read_b64_tr_b16 v[214:215], v231 offset:50176
    v_mfma_f32_16x16x32_bf16 v[156:159], v[196:199], v[120:123], v[156:159]
    s_waitcnt lgkmcnt(6)
    v_mfma_f32_16x16x32_bf16 v[160:163], v[200:203], v[56:59], v[160:163]
    ds_read_b64_tr_b16 v[192:193], v224 offset:57344
    ds_read_b64_tr_b16 v[194:195], v224 offset:58368
    v_mfma_f32_16x16x32_bf16 v[164:167], v[200:203], v[120:123], v[164:167]
    s_add_u32 m0, s28, 98304
    s_mov_b32 s29, 3145728
    buffer_load_dwordx4 v240, s[16:19], s29 offen lds
    s_waitcnt lgkmcnt(6)
    v_mfma_f32_16x16x32_bf16 v[168:171], v[204:207], v[56:59], v[168:171]
    ds_read_b64_tr_b16 v[196:197], v225 offset:57344
    ds_read_b64_tr_b16 v[198:199], v225 offset:58368
    v_mfma_f32_16x16x32_bf16 v[172:175], v[204:207], v[120:123], v[172:175]
    s_waitcnt lgkmcnt(6)
    v_mfma_f32_16x16x32_bf16 v[176:179], v[208:211], v[56:59], v[176:179]
    ds_read_b64_tr_b16 v[200:201], v226 offset:57344
    ds_read_b64_tr_b16 v[202:203], v226 offset:58368
    v_mfma_f32_16x16x32_bf16 v[180:183], v[208:211], v[120:123], v[180:183]
    s_add_u32 m0, s28, 102400
    s_mov_b32 s29, 3276800
    buffer_load_dwordx4 v240, s[16:19], s29 offen lds
    s_waitcnt lgkmcnt(6)
    v_mfma_f32_16x16x32_bf16 v[184:187], v[212:215], v[56:59], v[184:187]
    ds_read_b64_tr_b16 v[204:205], v227 offset:57344
    ds_read_b64_tr_b16 v[206:207], v227 offset:58368
    v_mfma_f32_16x16x32_bf16 v[188:191], v[212:215], v[120:123], v[188:191]
    s_waitcnt lgkmcnt(6)
    v_mfma_f32_16x16x32_bf16 v[128:131], v[192:195], v[60:63], v[128:131]
    ds_read_b64_tr_b16 v[208:209], v228 offset:57344
    ds_read_b64_tr_b16 v[210:211], v228 offset:58368
    v_mfma_f32_16x16x32_bf16 v[132:135], v[192:195], v[124:127], v[132:135]
    s_add_u32 m0, s28, 106496
    s_mov_b32 s29, 3407872
    buffer_load_dwordx4 v240, s[16:19], s29 offen lds
    s_waitcnt lgkmcnt(6)
    v_mfma_f32_16x16x32_bf16 v[136:139], v[196:199], v[60:63], v[136:139]
    ds_read_b64_tr_b16 v[212:213], v229 offset:57344
    ds_read_b64_tr_b16 v[214:215], v229 offset:58368
    v_mfma_f32_16x16x32_bf16 v[140:143], v[196:199], v[124:127], v[140:143]
    s_waitcnt lgkmcnt(6)
    v_mfma_f32_16x16x32_bf16 v[144:147], v[200:203], v[60:63], v[144:147]
    ds_read_b64_tr_b16 v[192:193], v230 offset:57344
    ds_read_b64_tr_b16 v[194:195], v230 offset:58368
    v_mfma_f32_16x16x32_bf16 v[148:151], v[200:203], v[124:127], v[148:151]
    s_add_u32 m0, s28, 110592
    s_mov_b32 s29, 3538944
    buffer_load_dwordx4 v240, s[16:19], s29 offen lds
    s_waitcnt lgkmcnt(6)
    v_mfma_f32_16x16x32_bf16 v[152:155], v[204:207], v[60:63], v[152:155]
    ds_read_b64_tr_b16 v[196:197], v231 offset:57344
    ds_read_b64_tr_b16 v[198:199], v231 offset:58368
    v_mfma_f32_16x16x32_bf16 v[156:159], v[204:207], v[124:127], v[156:159]
    s_waitcnt lgkmcnt(6)
    v_mfma_f32_16x16x32_bf16 v[160:163], v[208:211], v[60:63], v[160:163]
    v_mfma_f32_16x16x32_bf16 v[164:167], v[208:211], v[124:127], v[164:167]
    s_waitcnt lgkmcnt(4)
    v_mfma_f32_16x16x32_bf16 v[168:171], v[212:215], v[60:63], v[168:171]
    v_mfma_f32_16x16x32_bf16 v[172:175], v[212:215], v[124:127], v[172:175]
    s_waitcnt lgkmcnt(2)
    v_mfma_f32_16x16x32_bf16 v[176:179], v[192:195], v[60:63], v[176:179]
    v_mfma_f32_16x16x32_bf16 v[180:183], v[192:195], v[124:127], v[180:183]
    s_waitcnt lgkmcnt(0)
    v_mfma_f32_16x16x32_bf16 v[184:187], v[196:199], v[60:63], v[184:187]
    v_mfma_f32_16x16x32_bf16 v[188:191], v[196:199], v[124:127], v[188:191]
    s_add_u32 s21, s30, 4096
    v_cvt_pk_bf16_f32 v216, v128, v129
    v_cvt_pk_bf16_f32 v217, v130, v131
    v_cvt_pk_bf16_f32 v218, v136, v137
    v_cvt_pk_bf16_f32 v219, v138, v139
    buffer_store_dwordx4 v[216:219], v242, s[8:11], s30 offen offset:0 sc1
    v_cvt_pk_bf16_f32 v220, v132, v133
    v_cvt_pk_bf16_f32 v221, v134, v135
    v_cvt_pk_bf16_f32 v222, v140, v141
    v_cvt_pk_bf16_f32 v223, v142, v143
    buffer_store_dwordx4 v[220:223], v242, s[8:11], s30 offen offset:1024 sc1
    v_cvt_pk_bf16_f32 v216, v144, v145
    v_cvt_pk_bf16_f32 v217, v146, v147
    v_cvt_pk_bf16_f32 v218, v152, v153
    v_cvt_pk_bf16_f32 v219, v154, v155
    buffer_store_dwordx4 v[216:219], v242, s[8:11], s30 offen offset:2048 sc1
    v_cvt_pk_bf16_f32 v220, v148, v149
    v_cvt_pk_bf16_f32 v221, v150, v151
    v_cvt_pk_bf16_f32 v222, v156, v157
    v_cvt_pk_bf16_f32 v223, v158, v159
    buffer_store_dwordx4 v[220:223], v242, s[8:11], s30 offen offset:3072 sc1
    v_cvt_pk_bf16_f32 v216, v160, v161
    v_cvt_pk_bf16_f32 v217, v162, v163
    v_cvt_pk_bf16_f32 v218, v168, v169
    v_cvt_pk_bf16_f32 v219, v170, v171
    buffer_store_dwordx4 v[216:219], v242, s[8:11], s21 offen offset:0 sc1
    v_cvt_pk_bf16_f32 v220, v164, v165
    v_cvt_pk_bf16_f32 v221, v166, v167
    v_cvt_pk_bf16_f32 v222, v172, v173
    v_cvt_pk_bf16_f32 v223, v174, v175
    buffer_store_dwordx4 v[220:223], v242, s[8:11], s21 offen offset:1024 sc1
    v_cvt_pk_bf16_f32 v216, v176, v177
    v_cvt_pk_bf16_f32 v217, v178, v179
    v_cvt_pk_bf16_f32 v218, v184, v185
    v_cvt_pk_bf16_f32 v219, v186, v187
    buffer_store_dwordx4 v[216:219], v242, s[8:11], s21 offen offset:2048 sc1
    v_cvt_pk_bf16_f32 v220, v180, v181
    v_cvt_pk_bf16_f32 v221, v182, v183
    v_cvt_pk_bf16_f32 v222, v188, v189
    v_cvt_pk_bf16_f32 v223, v190, v191
    buffer_store_dwordx4 v[220:223], v242, s[8:11], s21 offen offset:3072 sc1
    s_sub_u32 s30, s30, 16777216
    s_add_u32 s31, s31, 1
    s_cmp_lt_u32 s31, 2
    s_cbranch_scc1 Lkq_129
    s_waitcnt vmcnt(0)
    s_barrier
    s_add_u32 s92, s92, 2048
Lm_wsig:
    v_mov_b32 v250, 1
    s_cmp_lg_u32 s3, 0
    s_cbranch_scc1 Lm_wloop
    s_mov_b64 exec, 1
    buffer_atomic_add v250, off, s[8:11], s92
    s_mov_b64 exec, -1
    s_branch Lm_wloop
Lm_ffn:
    s_cmp_eq_u32 s83, 1
    s_cbranch_scc1 Lm_lnokb
    s_cmp_lg_u32 s3, 0
    s_cbranch_scc1 Lm_lnbb
    s_mov_b32 s44, s78
    s_and_b32 s45, s79, 0xffff
    s_mov_b32 s46, 256
    s_mov_b32 s47, 0x20000
    s_mov_b32 s94, 0
    v_lshrrev_b32 v244, 2, v242
    v_and_b32 v244, 60, v244
    s_nop 1
Lm_lnwb:
    buffer_load_dword v245, v244, s[44:47], 0 offen offset:128 sc1
    s_waitcnt vmcnt(0)
    v_cmp_gt_u32 vcc, 16, v245
    s_add_u32 s94, s94, 1
    s_cmp_gt_u32 s94, 30000000
    s_cbranch_scc1 Lm_lnbb
    s_cmp_eq_u32 vcc_lo, 0
    s_cselect_b32 s83, 1, 0
    s_lshr_b32 s95, vcc_lo, s4
    s_and_b32 s95, s95, 1
    s_cbranch_scc0 Lm_lnbb
    s_sleep 8
    s_branch Lm_lnwb
Lm_lnbb:
    v_mov_b32 v252, s83
    s_barrier
    v_mov_b32 v247, 162304
    s_cmp_lg_u32 s3, 0
    s_cbranch_scc1 Lm_lncb
    ds_write_b32 v247, v252
    s_waitcnt lgkmcnt(0)
Lm_lncb:
    s_barrier
    ds_read_b32 v246, v247
    s_waitcnt lgkmcnt(0)
    v_readfirstlane_b32 s83, v246
    s_nop 3
    s_nop 0
Lm_lnokb:
    s_lshl_b32 s20, s4, 2
    s_add_u32 s20, s20, s3
    s_lshl_b32 s20, s20, 15
    s_add_u32 s20, s20, 0
    buffer_load_dwordx4 v[0:3], v242, s[8:11], s20 offen offset:0 sc1
    buffer_load_dwordx4 v[4:7], v242, s[8:11], s20 offen offset:1024 sc1
    buffer_load_dwordx4 v[8:11], v242, s[8:11], s20 offen offset:2048 sc1
    buffer_load_dwordx4 v[12:15], v242, s[8:11], s20 offen offset:3072 sc1
    s_add_u32 s20, s20, 4096
    buffer_load_dwordx4 v[16:19], v242, s[8:11], s20 offen offset:0 sc1
    buffer_load_dwordx4 v[20:23], v242, s[8:11], s20 offen offset:1024 sc1
    buffer_load_dwordx4 v[24:27], v242, s[8:11], s20 offen offset:2048 sc1
    buffer_load_dwordx4 v[28:31], v242, s[8:11], s20 offen offset:3072 sc1
    s_add_u32 s20, s20, 4096
    buffer_load_dwordx4 v[32:35], v242, s[8:11], s20 offen offset:0 sc1
    buffer_load_dwordx4 v[36:39], v242, s[8:11], s20 offen offset:1024 sc1
    buffer_load_dwordx4 v[40:43], v242, s[8:11], s20 offen offset:2048 sc1
    buffer_load_dwordx4 v[44:47], v242, s[8:11], s20 offen offset:3072 sc1
    s_add_u32 s20, s20, 4096
    buffer_load_dwordx4 v[48:51], v242, s[8:11], s20 offen offset:0 sc1
    buffer_load_dwordx4 v[52:55], v242, s[8:11], s20 offen offset:1024 sc1
    buffer_load_dwordx4 v[56:59], v242, s[8:11], s20 offen offset:2048 sc1
    buffer_load_dwordx4 v[60:63], v242, s[8:11], s20 offen offset:3072 sc1
    s_add_u32 s20, s20, 4096
    buffer_load_dwordx4 v[64:67], v242, s[8:11], s20 offen offset:0 sc1
    buffer_load_dwordx4 v[68:71], v242, s[8:11], s20 offen offset:1024 sc1
    buffer_load_dwordx4 v[72:75], v242, s[8:11], s20 offen offset:2048 sc1
    buffer_load_dwordx4 v[76:79], v242, s[8:11], s20 offen offset:3072 sc1
    s_add_u32 s20, s20, 4096
    buffer_load_dwordx4 v[80:83], v242, s[8:11], s20 offen offset:0 sc1
    buffer_load_dwordx4 v[84:87], v242, s[8:11], s20 offen offset:1024 sc1
    buffer_load_dwordx4 v[88:91], v242, s[8:11], s20 offen offset:2048 sc1
    buffer_load_dwordx4 v[92:95], v242, s[8:11], s20 offen offset:3072 sc1
    s_add_u32 s20, s20, 4096
    buffer_load_dwordx4 v[96:99], v242, s[8:11], s20 offen offset:0 sc1
    buffer_load_dwordx4 v[100:103], v242, s[8:11], s20 offen offset:1024 sc1
    buffer_load_dwordx4 v[104:107], v242, s[8:11], s20 offen offset:2048 sc1
    buffer_load_dwordx4 v[108:111], v242, s[8:11], s20 offen offset:3072 sc1
    s_add_u32 s20, s20, 4096
    buffer_load_dwordx4 v[112:115], v242, s[8:11], s20 offen offset:0 sc1
    buffer_load_dwordx4 v[116:119], v242, s[8:11], s20 offen offset:1024 sc1
    buffer_load_dwordx4 v[120:123], v242, s[8:11], s20 offen offset:2048 sc1
    buffer_load_dwordx4 v[124:127], v242, s[8:11], s20 offen offset:3072 sc1
    s_sub_u32 s5, s5, 32
    v_lshrrev_b32 v244, 4, v242
    v_bfe_u32 v245, v244, 2, 2
    v_lshrrev_b32 v246, 4, v244
    v_lshl_add_u32 v247, v246, 2, v245
    v_lshlrev_b32 v247, 8, v247
    v_and_b32 v244, 3, v244
    v_lshl_add_u32 v247, v244, 3, v247
    v_and_b32 v246, 1, v246
    v_lshl_add_u32 v245, v246, 2, v245
    v_lshl_add_u32 v232, v245, 5, v247
    v_xor_b32 v233, 32, v232
    v_xor_b32 v234, 64, v232
    v_xor_b32 v235, 96, v232
    v_xor_b32 v236, 128, v232
    v_xor_b32 v237, 160, v232
    v_xor_b32 v238, 192, v232
    v_xor_b32 v239, 224, v232
    v_lshrrev_b32 v244, 8, v242
    v_bfe_u32 v245, v242, 4, 4
    s_and_b32 s20, s3, 1
    s_lshl_b32 s20, s20, 2
    v_or_b32 v246, s20, v244
    v_lshlrev_b32 v246, 1, v246
    v_xor_b32 v245, v245, v246
    v_lshlrev_b32 v245, 4, v245
    s_lshl_b32 s20, s3, 2
    v_add_u32 v244, s20, v244
    v_lshl_add_u32 v241, v244, 10, v245
    v_lshrrev_b32 v244, 7, v242
    v_bfe_u32 v245, v242, 4, 3
    v_bfe_u32 v246, v244, 1, 1
    s_and_b32 s20, s3, 1
    s_lshl_b32 s20, s20, 1
    v_or_b32 v246, s20, v246
    v_lshlrev_b32 v246, 1, v246
    v_xor_b32 v245, v245, v246
    v_lshlrev_b32 v245, 4, v245
    s_lshl_b32 s20, s3, 3
    v_add_u32 v244, s20, v244
    s_movk_i32 s20, 3584
    v_mul_lo_u32 v244, v244, s20
    v_add_u32 v240, v244, v245
    s_lshl_b32 s20, s5, 9
    v_add_u32 v240, s20, v240
    v_lshrrev_b32 v244, 4, v242
    v_bfe_u32 v245, v244, 2, 2
    v_lshrrev_b32 v246, 4, v244
    v_lshl_add_u32 v247, v246, 3, v245
    v_lshlrev_b32 v247, 7, v247
    v_and_b32 v244, 3, v244
    v_lshl_add_u32 v247, v244, 3, v247
    v_lshrrev_b32 v245, 1, v245
    v_and_b32 v246, 1, v246
    v_lshl_add_u32 v245, v246, 1, v245
    v_lshl_add_u32 v248, v245, 5, v247
    v_xor_b32 v249, 32, v248
    v_xor_b32 v250, 64, v248
    v_xor_b32 v251, 96, v248
    s_lshl_b32 s20, s5, 18
    v_add_u32 v241, s20, v241
    s_load_dwordx2 s[32:33], s[0:1], 64
    s_load_dwordx2 s[34:35], s[0:1], 72
    s_load_dwordx2 s[36:37], s[0:1], 80
    s_waitcnt lgkmcnt(0)
    s_mov_b32 s12, s32
    s_and_b32 s13, s33, 0xffff
    s_mov_b32 s14, 1835008
    s_mov_b32 s15, 0x20000
    s_mov_b32 s16, s34
    s_and_b32 s17, s35, 0xffff
    s_mov_b32 s18, 1835008
    s_mov_b32 s19, 0x20000
    s_mov_b32 s24, s36
    s_and_b32 s25, s37, 0xffff
    s_mov_b32 s26, 1835008
    s_mov_b32 s27, 0x20000
    s_mov_b32 s38, 0xc0135761
    s_mov_b32 s39, 0xbdd2d3e8
    s_mov_b32 s40, 0
    s_mov_b32 s41, 0
    s_add_u32 m0, s28, 0
    s_add_u32 s29, s40, 0
    buffer_load_dwordx4 v240, s[12:15], s29 offen lds
    s_add_u32 m0, s28, 4096
    s_add_u32 s29, s40, 114688
    buffer_load_dwordx4 v240, s[12:15], s29 offen lds
    s_add_u32 m0, s28, 8192
    s_add_u32 s29, s40, 0
    buffer_load_dwordx4 v240, s[16:19], s29 offen lds
    s_add_u32 m0, s28, 12288
    s_add_u32 s29, s40, 114688
    buffer_load_dwordx4 v240, s[16:19], s29 offen lds
    s_add_u32 m0, s28, 16384
    s_add_u32 s29, s40, 229376
    buffer_load_dwordx4 v240, s[12:15], s29 offen lds
    s_add_u32 m0, s28, 20480
    s_add_u32 s29, s40, 344064
    buffer_load_dwordx4 v240, s[12:15], s29 offen lds
    s_add_u32 m0, s28, 24576
    s_add_u32 s29, s40, 229376
    buffer_load_dwordx4 v240, s[16:19], s29 offen lds
    s_add_u32 m0, s28, 28672
    s_add_u32 s29, s40, 344064
    buffer_load_dwordx4 v240, s[16:19], s29 offen lds
    s_add_u32 m0, s28, 32768
    s_add_u32 s29, s40, 458752
    buffer_load_dwordx4 v240, s[12:15], s29 offen lds
    s_add_u32 m0, s28, 36864
    s_add_u32 s29, s40, 573440
    buffer_load_dwordx4 v240, s[12:15], s29 offen lds
    s_add_u32 m0, s28, 40960
    s_add_u32 s29, s40, 458752
    buffer_load_dwordx4 v240, s[16:19], s29 offen lds
    s_add_u32 m0, s28, 45056
    s_add_u32 s29, s40, 573440
    buffer_load_dwordx4 v240, s[16:19], s29 offen lds
    v_accvgpr_write_b32 a0, 0
    v_accvgpr_write_b32 a1, 0
    v_accvgpr_write_b32 a2, 0
    v_accvgpr_write_b32 a3, 0
    v_accvgpr_write_b32 a4, 0
    v_accvgpr_write_b32 a5, 0
    v_accvgpr_write_b32 a6, 0
    v_accvgpr_write_b32 a7, 0
    v_accvgpr_write_b32 a8, 0
    v_accvgpr_write_b32 a9, 0
    v_accvgpr_write_b32 a10, 0
    v_accvgpr_write_b32 a11, 0
    v_accvgpr_write_b32 a12, 0
    v_accvgpr_write_b32 a13, 0
    v_accvgpr_write_b32 a14, 0
    v_accvgpr_write_b32 a15, 0
    v_accvgpr_write_b32 a16, 0
    v_accvgpr_write_b32 a17, 0
    v_accvgpr_write_b32 a18, 0
    v_accvgpr_write_b32 a19, 0
    v_accvgpr_write_b32 a20, 0
    v_accvgpr_write_b32 a21, 0
    v_accvgpr_write_b32 a22, 0
    v_accvgpr_write_b32 a23, 0
    v_accvgpr_write_b32 a24, 0
    v_accvgpr_write_b32 a25, 0
    v_accvgpr_write_b32 a26, 0
    v_accvgpr_write_b32 a27, 0
    v_accvgpr_write_b32 a28, 0
    v_accvgpr_write_b32 a29, 0
    v_accvgpr_write_b32 a30, 0
    v_accvgpr_write_b32 a31, 0
    v_accvgpr_write_b32 a32, 0
    v_accvgpr_write_b32 a33, 0
    v_accvgpr_write_b32 a34, 0
    v_accvgpr_write_b32 a35, 0
    v_accvgpr_write_b32 a36, 0
    v_accvgpr_write_b32 a37, 0
    v_accvgpr_write_b32 a38, 0
    v_accvgpr_write_b32 a39, 0
    v_accvgpr_write_b32 a40, 0
    v_accvgpr_write_b32 a41, 0
    v_accvgpr_write_b32 a42, 0
    v_accvgpr_write_b32 a43, 0
    v_accvgpr_write_b32 a44, 0
    v_accvgpr_write_b32 a45, 0
    v_accvgpr_write_b32 a46, 0
    v_accvgpr_write_b32 a47, 0
    v_accvgpr_write_b32 a48, 0
    v_accvgpr_write_b32 a49, 0
    v_accvgpr_write_b32 a50, 0
    v_accvgpr_write_b32 a51, 0
    v_accvgpr_write_b32 a52, 0
    v_accvgpr_write_b32 a53, 0
    v_accvgpr_write_b32 a54, 0
    v_accvgpr_write_b32 a55, 0
    v_accvgpr_write_b32 a56, 0
    v_accvgpr_write_b32 a57, 0
    v_accvgpr_write_b32 a58, 0
    v_accvgpr_write_b32 a59, 0
    v_accvgpr_write_b32 a60, 0
    v_accvgpr_write_b32 a61, 0
    v_accvgpr_write_b32 a62, 0
    v_accvgpr_write_b32 a63, 0
    v_accvgpr_write_b32 a64, 0
    v_accvgpr_write_b32 a65, 0
    v_accvgpr_write_b32 a66, 0
    v_accvgpr_write_b32 a67, 0
    v_accvgpr_write_b32 a68, 0
    v_accvgpr_write_b32 a69, 0
    v_accvgpr_write_b32 a70, 0
    v_accvgpr_write_b32 a71, 0
    v_accvgpr_write_b32 a72, 0
    v_accvgpr_write_b32 a73, 0
    v_accvgpr_write_b32 a74, 0
    v_accvgpr_write_b32 a75, 0
    v_accvgpr_write_b32 a76, 0
    v_accvgpr_write_b32 a77, 0
    v_accvgpr_write_b32 a78, 0
    v_accvgpr_write_b32 a79, 0
    v_accvgpr_write_b32 a80, 0
    v_accvgpr_write_b32 a81, 0
    v_accvgpr_write_b32 a82, 0
    v_accvgpr_write_b32 a83, 0
    v_accvgpr_write_b32 a84, 0
    v_accvgpr_write_b32 a85, 0
    v_accvgpr_write_b32 a86, 0
    v_accvgpr_write_b32 a87, 0
    v_accvgpr_write_b32 a88, 0
    v_accvgpr_write_b32 a89, 0
    v_accvgpr_write_b32 a90, 0
    v_accvgpr_write_b32 a91, 0
    v_accvgpr_write_b32 a92, 0
    v_accvgpr_write_b32 a93, 0
    v_accvgpr_write_b32 a94, 0
    v_accvgpr_write_b32 a95, 0
    v_accvgpr_write_b32 a96, 0
    v_accvgpr_write_b32 a97, 0
    v_accvgpr_write_b32 a98, 0
    v_accvgpr_write_b32 a99, 0
    v_accvgpr_write_b32 a100, 0
    v_accvgpr_write_b32 a101, 0
    v_accvgpr_write_b32 a102, 0
    v_accvgpr_write_b32 a103, 0
    v_accvgpr_write_b32 a104, 0
    v_accvgpr_write_b32 a105, 0
    v_accvgpr_write_b32 a106, 0
    v_accvgpr_write_b32 a107, 0
    v_accvgpr_write_b32 a108, 0
    v_accvgpr_write_b32 a109, 0
    v_accvgpr_write_b32 a110, 0
    v_accvgpr_write_b32 a111, 0
    v_accvgpr_write_b32 a112, 0
    v_accvgpr_write_b32 a113, 0
    v_accvgpr_write_b32 a114, 0
    v_accvgpr_write_b32 a115, 0
    v_accvgpr_write_b32 a116, 0
    v_accvgpr_write_b32 a117, 0
    v_accvgpr_write_b32 a118, 0
    v_accvgpr_write_b32 a119, 0
    v_accvgpr_write_b32 a120, 0
    v_accvgpr_write_b32 a121, 0
    v_accvgpr_write_b32 a122, 0
    v_accvgpr_write_b32 a123, 0
    v_accvgpr_write_b32 a124, 0
    v_accvgpr_write_b32 a125, 0
    v_accvgpr_write_b32 a126, 0
    v_accvgpr_write_b32 a127, 0
    v_accvgpr_write_b32 a128, 0
    v_accvgpr_write_b32 a129, 0
    v_accvgpr_write_b32 a130, 0
    v_accvgpr_write_b32 a131, 0
    v_accvgpr_write_b32 a132, 0
    v_accvgpr_write_b32 a133, 0
    v_accvgpr_write_b32 a134, 0
    v_accvgpr_write_b32 a135, 0
    v_accvgpr_write_b32 a136, 0
    v_accvgpr_write_b32 a137, 0
    v_accvgpr_write_b32 a138, 0
    v_accvgpr_write_b32 a139, 0
    v_accvgpr_write_b32 a140, 0
    v_accvgpr_write_b32 a141, 0
    v_accvgpr_write_b32 a142, 0
    v_accvgpr_write_b32 a143, 0
    v_accvgpr_write_b32 a144, 0
    v_accvgpr_write_b32 a145, 0
    v_accvgpr_write_b32 a146, 0
    v_accvgpr_write_b32 a147, 0
    v_accvgpr_write_b32 a148, 0
    v_accvgpr_write_b32 a149, 0
    v_accvgpr_write_b32 a150, 0
    v_accvgpr_write_b32 a151, 0
    v_accvgpr_write_b32 a152, 0
    v_accvgpr_write_b32 a153, 0
    v_accvgpr_write_b32 a154, 0
    v_accvgpr_write_b32 a155, 0
    v_accvgpr_write_b32 a156, 0
    v_accvgpr_write_b32 a157, 0
    v_accvgpr_write_b32 a158, 0
    v_accvgpr_write_b32 a159, 0
    v_accvgpr_write_b32 a160, 0
    v_accvgpr_write_b32 a161, 0
    v_accvgpr_write_b32 a162, 0
    v_accvgpr_write_b32 a163, 0
    v_accvgpr_write_b32 a164, 0
    v_accvgpr_write_b32 a165, 0
    v_accvgpr_write_b32 a166, 0
    v_accvgpr_write_b32 a167, 0
    v_accvgpr_write_b32 a168, 0
    v_accvgpr_write_b32 a169, 0
    v_accvgpr_write_b32 a170, 0
    v_accvgpr_write_b32 a171, 0
    v_accvgpr_write_b32 a172, 0
    v_accvgpr_write_b32 a173, 0
    v_accvgpr_write_b32 a174, 0
    v_accvgpr_write_b32 a175, 0
    v_accvgpr_write_b32 a176, 0
    v_accvgpr_write_b32 a177, 0
    v_accvgpr_write_b32 a178, 0
    v_accvgpr_write_b32 a179, 0
    v_accvgpr_write_b32 a180, 0
    v_accvgpr_write_b32 a181, 0
    v_accvgpr_write_b32 a182, 0
    v_accvgpr_write_b32 a183, 0
    v_accvgpr_write_b32 a184, 0
    v_accvgpr_write_b32 a185, 0
    v_accvgpr_write_b32 a186, 0
    v_accvgpr_write_b32 a187, 0
    v_accvgpr_write_b32 a188, 0
    v_accvgpr_write_b32 a189, 0
    v_accvgpr_write_b32 a190, 0
    v_accvgpr_write_b32 a191, 0
    v_accvgpr_write_b32 a192, 0
    v_accvgpr_write_b32 a193, 0
    v_accvgpr_write_b32 a194, 0
    v_accvgpr_write_b32 a195, 0
    v_accvgpr_write_b32 a196, 0
    v_accvgpr_write_b32 a197, 0
    v_accvgpr_write_b32 a198, 0
    v_accvgpr_write_b32 a199, 0
    v_accvgpr_write_b32 a200, 0
    v_accvgpr_write_b32 a201, 0
    v_accvgpr_write_b32 a202, 0
    v_accvgpr_write_b32 a203, 0
    v_accvgpr_write_b32 a204, 0
    v_accvgpr_write_b32 a205, 0
    v_accvgpr_write_b32 a206, 0
    v_accvgpr_write_b32 a207, 0
    v_accvgpr_write_b32 a208, 0
    v_accvgpr_write_b32 a209, 0
    v_accvgpr_write_b32 a210, 0
    v_accvgpr_write_b32 a211, 0
    v_accvgpr_write_b32 a212, 0
    v_accvgpr_write_b32 a213, 0
    v_accvgpr_write_b32 a214, 0
    v_accvgpr_write_b32 a215, 0
    v_accvgpr_write_b32 a216, 0
    v_accvgpr_write_b32 a217, 0
    v_accvgpr_write_b32 a218, 0
    v_accvgpr_write_b32 a219, 0
    v_accvgpr_write_b32 a220, 0
    v_accvgpr_write_b32 a221, 0
    v_accvgpr_write_b32 a222, 0
    v_accvgpr_write_b32 a223, 0
    v_accvgpr_write_b32 a224, 0
    v_accvgpr_write_b32 a225, 0
    v_accvgpr_write_b32 a226, 0
    v_accvgpr_write_b32 a227, 0
    v_accvgpr_write_b32 a228, 0
    v_accvgpr_write_b32 a229, 0
    v_accvgpr_write_b32 a230, 0
    v_accvgpr_write_b32 a231, 0
    v_accvgpr_write_b32 a232, 0
    v_accvgpr_write_b32 a233, 0
    v_accvgpr_write_b32 a234, 0
    v_accvgpr_write_b32 a235, 0
    v_accvgpr_write_b32 a236, 0
    v_accvgpr_write_b32 a237, 0
    v_accvgpr_write_b32 a238, 0
    v_accvgpr_write_b32 a239, 0
    v_accvgpr_write_b32 a240, 0
    v_accvgpr_write_b32 a241, 0
    v_accvgpr_write_b32 a242, 0
    v_accvgpr_write_b32 a243, 0
    v_accvgpr_write_b32 a244, 0
    v_accvgpr_write_b32 a245, 0
    v_accvgpr_write_b32 a246, 0
    v_accvgpr_write_b32 a247, 0
    v_accvgpr_write_b32 a248, 0
    v_accvgpr_write_b32 a249, 0
    v_accvgpr_write_b32 a250, 0
    v_accvgpr_write_b32 a251, 0
    v_accvgpr_write_b32 a252, 0
    v_accvgpr_write_b32 a253, 0
    v_accvgpr_write_b32 a254, 0
    v_accvgpr_write_b32 a255, 0
    s_waitcnt vmcnt(12)
    s_nop 0
Lffg_130:
    s_waitcnt vmcnt(8)
    s_waitcnt lgkmcnt(0)
    s_barrier
    s_add_u32 m0, s28, 49152
    s_add_u32 s29, s40, 688128
    buffer_load_dwordx4 v240, s[12:15], s29 offen lds
    s_add_u32 m0, s28, 53248
    s_add_u32 s29, s40, 802816
    buffer_load_dwordx4 v240, s[12:15], s29 offen lds
    s_add_u32 m0, s28, 57344
    s_add_u32 s29, s40, 688128
    buffer_load_dwordx4 v240, s[16:19], s29 offen lds
    s_add_u32 m0, s28, 61440
    s_add_u32 s29, s40, 802816
    buffer_load_dwordx4 v240, s[16:19], s29 offen lds
    ds_read_b64_tr_b16 v[192:193], v248 offset:0
    ds_read_b64_tr_b16 v[194:195], v248 offset:512
    ds_read_b64_tr_b16 v[196:197], v249 offset:0
    ds_read_b64_tr_b16 v[198:199], v249 offset:512
    ds_read_b64_tr_b16 v[200:201], v250 offset:0
    ds_read_b64_tr_b16 v[202:203], v250 offset:512
    ds_read_b64_tr_b16 v[204:205], v251 offset:0
    ds_read_b64_tr_b16 v[206:207], v251 offset:512
    s_waitcnt lgkmcnt(6)
    v_mfma_f32_16x16x32_bf16 v[128:131], v[192:195], v[0:3], 0
    ds_read_b64_tr_b16 v[208:209], v248 offset:8192
    ds_read_b64_tr_b16 v[210:211], v248 offset:8704
    v_mfma_f32_16x16x32_bf16 v[132:135], v[192:195], v[64:67], 0
    s_waitcnt lgkmcnt(6)
    v_mfma_f32_16x16x32_bf16 v[136:139], v[196:199], v[0:3], 0
    ds_read_b64_tr_b16 v[212:213], v249 offset:8192
    ds_read_b64_tr_b16 v[214:215], v249 offset:8704
    v_mfma_f32_16x16x32_bf16 v[140:143], v[196:199], v[64:67], 0
    s_waitcnt lgkmcnt(6)
    v_mfma_f32_16x16x32_bf16 v[144:147], v[200:203], v[0:3], 0
    ds_read_b64_tr_b16 v[192:193], v250 offset:8192
    ds_read_b64_tr_b16 v[194:195], v250 offset:8704
    v_mfma_f32_16x16x32_bf16 v[148:151], v[200:203], v[64:67], 0
    s_waitcnt lgkmcnt(6)
    v_mfma_f32_16x16x32_bf16 v[152:155], v[204:207], v[0:3], 0
    ds_read_b64_tr_b16 v[196:197], v251 offset:8192
    ds_read_b64_tr_b16 v[198:199], v251 offset:8704
    v_mfma_f32_16x16x32_bf16 v[156:159], v[204:207], v[64:67], 0
    s_waitcnt lgkmcnt(6)
    v_mfma_f32_16x16x32_bf16 v[160:163], v[208:211], v[0:3], 0
    ds_read_b64_tr_b16 v[200:201], v248 offset:4096
    ds_read_b64_tr_b16 v[202:203], v248 offset:4608
    v_mfma_f32_16x16x32_bf16 v[164:167], v[208:211], v[64:67], 0
    s_waitcnt lgkmcnt(6)
    v_mfma_f32_16x16x32_bf16 v[168:171], v[212:215], v[0:3], 0
    ds_read_b64_tr_b16 v[204:205], v249 offset:4096
    ds_read_b64_tr_b16 v[206:207], v249 offset:4608
    v_mfma_f32_16x16x32_bf16 v[172:175], v[212:215], v[64:67], 0
    s_waitcnt lgkmcnt(6)
    v_mfma_f32_16x16x32_bf16 v[176:179], v[192:195], v[0:3], 0
    ds_read_b64_tr_b16 v[208:209], v250 offset:4096
    ds_read_b64_tr_b16 v[210:211], v250 offset:4608
    v_mfma_f32_16x16x32_bf16 v[180:183], v[192:195], v[64:67], 0
    s_waitcnt lgkmcnt(6)
    v_mfma_f32_16x16x32_bf16 v[184:187], v[196:199], v[0:3], 0
    ds_read_b64_tr_b16 v[212:213], v251 offset:4096
    ds_read_b64_tr_b16 v[214:215], v251 offset:4608
    v_mfma_f32_16x16x32_bf16 v[188:191], v[196:199], v[64:67], 0
    s_waitcnt lgkmcnt(6)
    v_mfma_f32_16x16x32_bf16 v[128:131], v[200:203], v[4:7], v[128:131]
    ds_read_b64_tr_b16 v[192:193], v248 offset:12288
    ds_read_b64_tr_b16 v[194:195], v248 offset:12800
    v_mfma_f32_16x16x32_bf16 v[132:135], v[200:203], v[68:71], v[132:135]
    s_waitcnt lgkmcnt(6)
    v_mfma_f32_16x16x32_bf16 v[136:139], v[204:207], v[4:7], v[136:139]
    ds_read_b64_tr_b16 v[196:197], v249 offset:12288
    ds_read_b64_tr_b16 v[198:199], v249 offset:12800
    v_mfma_f32_16x16x32_bf16 v[140:143], v[204:207], v[68:71], v[140:143]
    s_waitcnt lgkmcnt(6)
    v_mfma_f32_16x16x32_bf16 v[144:147], v[208:211], v[4:7], v[144:147]
    ds_read_b64_tr_b16 v[200:201], v250 offset:12288
    ds_read_b64_tr_b16 v[202:203], v250 offset:12800
    v_mfma_f32_16x16x32_bf16 v[148:151], v[208:211], v[68:71], v[148:151]
    s_waitcnt lgkmcnt(6)
    v_mfma_f32_16x16x32_bf16 v[152:155], v[212:215], v[4:7], v[152:155]
    ds_read_b64_tr_b16 v[204:205], v251 offset:12288
    ds_read_b64_tr_b16 v[206:207], v251 offset:12800
    v_mfma_f32_16x16x32_bf16 v[156:159], v[212:215], v[68:71], v[156:159]
    s_waitcnt lgkmcnt(6)
    v_mfma_f32_16x16x32_bf16 v[160:163], v[192:195], v[4:7], v[160:163]
    v_mfma_f32_16x16x32_bf16 v[164:167], v[192:195], v[68:71], v[164:167]
    s_waitcnt lgkmcnt(4)
    v_mfma_f32_16x16x32_bf16 v[168:171], v[196:199], v[4:7], v[168:171]
    v_mfma_f32_16x16x32_bf16 v[172:175], v[196:199], v[68:71], v[172:175]
    s_waitcnt lgkmcnt(2)
    v_mfma_f32_16x16x32_bf16 v[176:179], v[200:203], v[4:7], v[176:179]
    v_mfma_f32_16x16x32_bf16 v[180:183], v[200:203], v[68:71], v[180:183]
    s_waitcnt lgkmcnt(0)
    v_mfma_f32_16x16x32_bf16 v[184:187], v[204:207], v[4:7], v[184:187]
    v_mfma_f32_16x16x32_bf16 v[188:191], v[204:207], v[68:71], v[188:191]
    s_waitcnt vmcnt(8)
    s_waitcnt lgkmcnt(0)
    s_barrier
    s_add_u32 m0, s28, 0
    s_add_u32 s29, s40, 917504
    buffer_load_dwordx4 v240, s[12:15], s29 offen lds
    s_add_u32 m0, s28, 4096
    s_add_u32 s29, s40, 1032192
    buffer_load_dwordx4 v240, s[12:15], s29 offen lds
    s_add_u32 m0, s28, 8192
    s_add_u32 s29, s40, 917504
    buffer_load_dwordx4 v240, s[16:19], s29 offen lds
    s_add_u32 m0, s28, 12288
    s_add_u32 s29, s40, 1032192
    buffer_load_dwordx4 v240, s[16:19], s29 offen lds
    ds_read_b64_tr_b16 v[192:193], v248 offset:16384
    ds_read_b64_tr_b16 v[194:195], v248 offset:16896
    ds_read_b64_tr_b16 v[196:197], v249 offset:16384
    ds_read_b64_tr_b16 v[198:199], v249 offset:16896
    ds_read_b64_tr_b16 v[200:201], v250 offset:16384
    ds_read_b64_tr_b16 v[202:203], v250 offset:16896
    ds_read_b64_tr_b16 v[204:205], v251 offset:16384
    ds_read_b64_tr_b16 v[206:207], v251 offset:16896
    s_waitcnt lgkmcnt(6)
    v_mfma_f32_16x16x32_bf16 v[128:131], v[192:195], v[8:11], v[128:131]
    ds_read_b64_tr_b16 v[208:209], v248 offset:24576
    ds_read_b64_tr_b16 v[210:211], v248 offset:25088
    v_mfma_f32_16x16x32_bf16 v[132:135], v[192:195], v[72:75], v[132:135]
    s_waitcnt lgkmcnt(6)
    v_mfma_f32_16x16x32_bf16 v[136:139], v[196:199], v[8:11], v[136:139]
    ds_read_b64_tr_b16 v[212:213], v249 offset:24576
    ds_read_b64_tr_b16 v[214:215], v249 offset:25088
    v_mfma_f32_16x16x32_bf16 v[140:143], v[196:199], v[72:75], v[140:143]
    s_waitcnt lgkmcnt(6)
    v_mfma_f32_16x16x32_bf16 v[144:147], v[200:203], v[8:11], v[144:147]
    ds_read_b64_tr_b16 v[192:193], v250 offset:24576
    ds_read_b64_tr_b16 v[194:195], v250 offset:25088
    v_mfma_f32_16x16x32_bf16 v[148:151], v[200:203], v[72:75], v[148:151]
    s_waitcnt lgkmcnt(6)
    v_mfma_f32_16x16x32_bf16 v[152:155], v[204:207], v[8:11], v[152:155]
    ds_read_b64_tr_b16 v[196:197], v251 offset:24576
    ds_read_b64_tr_b16 v[198:199], v251 offset:25088
    v_mfma_f32_16x16x32_bf16 v[156:159], v[204:207], v[72:75], v[156:159]
    s_waitcnt lgkmcnt(6)
    v_mfma_f32_16x16x32_bf16 v[160:163], v[208:211], v[8:11], v[160:163]
    ds_read_b64_tr_b16 v[200:201], v248 offset:20480
    ds_read_b64_tr_b16 v[202:203], v248 offset:20992
    v_mfma_f32_16x16x32_bf16 v[164:167], v[208:211], v[72:75], v[164:167]
    s_waitcnt lgkmcnt(6)
    v_mfma_f32_16x16x32_bf16 v[168:171], v[212:215], v[8:11], v[168:171]
    ds_read_b64_tr_b16 v[204:205], v249 offset:20480
    ds_read_b64_tr_b16 v[206:207], v249 offset:20992
    v_mfma_f32_16x16x32_bf16 v[172:175], v[212:215], v[72:75], v[172:175]
    s_waitcnt lgkmcnt(6)
    v_mfma_f32_16x16x32_bf16 v[176:179], v[192:195], v[8:11], v[176:179]
    ds_read_b64_tr_b16 v[208:209], v250 offset:20480
    ds_read_b64_tr_b16 v[210:211], v250 offset:20992
    v_mfma_f32_16x16x32_bf16 v[180:183], v[192:195], v[72:75], v[180:183]
    s_waitcnt lgkmcnt(6)
    v_mfma_f32_16x16x32_bf16 v[184:187], v[196:199], v[8:11], v[184:187]
    ds_read_b64_tr_b16 v[212:213], v251 offset:20480
    ds_read_b64_tr_b16 v[214:215], v251 offset:20992
    v_mfma_f32_16x16x32_bf16 v[188:191], v[196:199], v[72:75], v[188:191]
    s_waitcnt lgkmcnt(6)
    v_mfma_f32_16x16x32_bf16 v[128:131], v[200:203], v[12:15], v[128:131]
    ds_read_b64_tr_b16 v[192:193], v248 offset:28672
    ds_read_b64_tr_b16 v[194:195], v248 offset:29184
    v_mfma_f32_16x16x32_bf16 v[132:135], v[200:203], v[76:79], v[132:135]
    s_waitcnt lgkmcnt(6)
    v_mfma_f32_16x16x32_bf16 v[136:139], v[204:207], v[12:15], v[136:139]
    ds_read_b64_tr_b16 v[196:197], v249 offset:28672
    ds_read_b64_tr_b16 v[198:199], v249 offset:29184
    v_mfma_f32_16x16x32_bf16 v[140:143], v[204:207], v[76:79], v[140:143]
    s_waitcnt lgkmcnt(6)
    v_mfma_f32_16x16x32_bf16 v[144:147], v[208:211], v[12:15], v[144:147]
    ds_read_b64_tr_b16 v[200:201], v250 offset:28672
    ds_read_b64_tr_b16 v[202:203], v250 offset:29184
    v_mfma_f32_16x16x32_bf16 v[148:151], v[208:211], v[76:79], v[148:151]
    s_waitcnt lgkmcnt(6)
    v_mfma_f32_16x16x32_bf16 v[152:155], v[212:215], v[12:15], v[152:155]
    ds_read_b64_tr_b16 v[204:205], v251 offset:28672
    ds_read_b64_tr_b16 v[206:207], v251 offset:29184
    v_mfma_f32_16x16x32_bf16 v[156:159], v[212:215], v[76:79], v[156:159]
    s_waitcnt lgkmcnt(6)
    v_mfma_f32_16x16x32_bf16 v[160:163], v[192:195], v[12:15], v[160:163]
    v_mfma_f32_16x16x32_bf16 v[164:167], v[192:195], v[76:79], v[164:167]
    s_waitcnt lgkmcnt(4)
    v_mfma_f32_16x16x32_bf16 v[168:171], v[196:199], v[12:15], v[168:171]
    v_mfma_f32_16x16x32_bf16 v[172:175], v[196:199], v[76:79], v[172:175]
    s_waitcnt lgkmcnt(2)
    v_mfma_f32_16x16x32_bf16 v[176:179], v[200:203], v[12:15], v[176:179]
    v_mfma_f32_16x16x32_bf16 v[180:183], v[200:203], v[76:79], v[180:183]
    s_waitcnt lgkmcnt(0)
    v_mfma_f32_16x16x32_bf16 v[184:187], v[204:207], v[12:15], v[184:187]
    v_mfma_f32_16x16x32_bf16 v[188:191], v[204:207], v[76:79], v[188:191]
    s_waitcnt vmcnt(8)
    s_waitcnt lgkmcnt(0)
    s_barrier
    s_add_u32 m0, s28, 16384
    s_add_u32 s29, s40, 1146880
    buffer_load_dwordx4 v240, s[12:15], s29 offen lds
    s_add_u32 m0, s28, 20480
    s_add_u32 s29, s40, 1261568
    buffer_load_dwordx4 v240, s[12:15], s29 offen lds
    s_add_u32 m0, s28, 24576
    s_add_u32 s29, s40, 1146880
    buffer_load_dwordx4 v240, s[16:19], s29 offen lds
    s_add_u32 m0, s28, 28672
    s_add_u32 s29, s40, 1261568
    buffer_load_dwordx4 v240, s[16:19], s29 offen lds
    ds_read_b64_tr_b16 v[192:193], v248 offset:32768
    ds_read_b64_tr_b16 v[194:195], v248 offset:33280
    ds_read_b64_tr_b16 v[196:197], v249 offset:32768
    ds_read_b64_tr_b16 v[198:199], v249 offset:33280
    ds_read_b64_tr_b16 v[200:201], v250 offset:32768
    ds_read_b64_tr_b16 v[202:203], v250 offset:33280
    ds_read_b64_tr_b16 v[204:205], v251 offset:32768
    ds_read_b64_tr_b16 v[206:207], v251 offset:33280
    s_waitcnt lgkmcnt(6)
    v_mfma_f32_16x16x32_bf16 v[128:131], v[192:195], v[16:19], v[128:131]
    ds_read_b64_tr_b16 v[208:209], v248 offset:40960
    ds_read_b64_tr_b16 v[210:211], v248 offset:41472
    v_mfma_f32_16x16x32_bf16 v[132:135], v[192:195], v[80:83], v[132:135]
    s_waitcnt lgkmcnt(6)
    v_mfma_f32_16x16x32_bf16 v[136:139], v[196:199], v[16:19], v[136:139]
    ds_read_b64_tr_b16 v[212:213], v249 offset:40960
    ds_read_b64_tr_b16 v[214:215], v249 offset:41472
    v_mfma_f32_16x16x32_bf16 v[140:143], v[196:199], v[80:83], v[140:143]
    s_waitcnt lgkmcnt(6)
    v_mfma_f32_16x16x32_bf16 v[144:147], v[200:203], v[16:19], v[144:147]
    ds_read_b64_tr_b16 v[192:193], v250 offset:40960
    ds_read_b64_tr_b16 v[194:195], v250 offset:41472
    v_mfma_f32_16x16x32_bf16 v[148:151], v[200:203], v[80:83], v[148:151]
    s_waitcnt lgkmcnt(6)
    v_mfma_f32_16x16x32_bf16 v[152:155], v[204:207], v[16:19], v[152:155]
    ds_read_b64_tr_b16 v[196:197], v251 offset:40960
    ds_read_b64_tr_b16 v[198:199], v251 offset:41472
    v_mfma_f32_16x16x32_bf16 v[156:159], v[204:207], v[80:83], v[156:159]
    s_waitcnt lgkmcnt(6)
    v_mfma_f32_16x16x32_bf16 v[160:163], v[208:211], v[16:19], v[160:163]
    ds_read_b64_tr_b16 v[200:201], v248 offset:36864
    ds_read_b64_tr_b16 v[202:203], v248 offset:37376
    v_mfma_f32_16x16x32_bf16 v[164:167], v[208:211], v[80:83], v[164:167]
    s_waitcnt lgkmcnt(6)
    v_mfma_f32_16x16x32_bf16 v[168:171], v[212:215], v[16:19], v[168:171]
    ds_read_b64_tr_b16 v[204:205], v249 offset:36864
    ds_read_b64_tr_b16 v[206:207], v249 offset:37376
    v_mfma_f32_16x16x32_bf16 v[172:175], v[212:215], v[80:83], v[172:175]
    s_waitcnt lgkmcnt(6)
    v_mfma_f32_16x16x32_bf16 v[176:179], v[192:195], v[16:19], v[176:179]
    ds_read_b64_tr_b16 v[208:209], v250 offset:36864
    ds_read_b64_tr_b16 v[210:211], v250 offset:37376
    v_mfma_f32_16x16x32_bf16 v[180:183], v[192:195], v[80:83], v[180:183]
    s_waitcnt lgkmcnt(6)
    v_mfma_f32_16x16x32_bf16 v[184:187], v[196:199], v[16:19], v[184:187]
    ds_read_b64_tr_b16 v[212:213], v251 offset:36864
    ds_read_b64_tr_b16 v[214:215], v251 offset:37376
    v_mfma_f32_16x16x32_bf16 v[188:191], v[196:199], v[80:83], v[188:191]
    s_waitcnt lgkmcnt(6)
    v_mfma_f32_16x16x32_bf16 v[128:131], v[200:203], v[20:23], v[128:131]
    ds_read_b64_tr_b16 v[192:193], v248 offset:45056
    ds_read_b64_tr_b16 v[194:195], v248 offset:45568
    v_mfma_f32_16x16x32_bf16 v[132:135], v[200:203], v[84:87], v[132:135]
    s_waitcnt lgkmcnt(6)
    v_mfma_f32_16x16x32_bf16 v[136:139], v[204:207], v[20:23], v[136:139]
    ds_read_b64_tr_b16 v[196:197], v249 offset:45056
    ds_read_b64_tr_b16 v[198:199], v249 offset:45568
    v_mfma_f32_16x16x32_bf16 v[140:143], v[204:207], v[84:87], v[140:143]
    s_waitcnt lgkmcnt(6)
    v_mfma_f32_16x16x32_bf16 v[144:147], v[208:211], v[20:23], v[144:147]
    ds_read_b64_tr_b16 v[200:201], v250 offset:45056
    ds_read_b64_tr_b16 v[202:203], v250 offset:45568
    v_mfma_f32_16x16x32_bf16 v[148:151], v[208:211], v[84:87], v[148:151]
    s_waitcnt lgkmcnt(6)
    v_mfma_f32_16x16x32_bf16 v[152:155], v[212:215], v[20:23], v[152:155]
    ds_read_b64_tr_b16 v[204:205], v251 offset:45056
    ds_read_b64_tr_b16 v[206:207], v251 offset:45568
    v_mfma_f32_16x16x32_bf16 v[156:159], v[212:215], v[84:87], v[156:159]
    s_waitcnt lgkmcnt(6)
    v_mfma_f32_16x16x32_bf16 v[160:163], v[192:195], v[20:23], v[160:163]
    v_mfma_f32_16x16x32_bf16 v[164:167], v[192:195], v[84:87], v[164:167]
    s_waitcnt lgkmcnt(4)
    v_mfma_f32_16x16x32_bf16 v[168:171], v[196:199], v[20:23], v[168:171]
    v_mfma_f32_16x16x32_bf16 v[172:175], v[196:199], v[84:87], v[172:175]
    s_waitcnt lgkmcnt(2)
    v_mfma_f32_16x16x32_bf16 v[176:179], v[200:203], v[20:23], v[176:179]
    v_mfma_f32_16x16x32_bf16 v[180:183], v[200:203], v[84:87], v[180:183]
    s_waitcnt lgkmcnt(0)
    v_mfma_f32_16x16x32_bf16 v[184:187], v[204:207], v[20:23], v[184:187]
    v_mfma_f32_16x16x32_bf16 v[188:191], v[204:207], v[84:87], v[188:191]
    s_waitcnt vmcnt(8)
    s_waitcnt lgkmcnt(0)
    s_barrier
    s_add_u32 m0, s28, 32768
    s_add_u32 s29, s40, 1376256
    buffer_load_dwordx4 v240, s[12:15], s29 offen lds
    s_add_u32 m0, s28, 36864
    s_add_u32 s29, s40, 1490944
    buffer_load_dwordx4 v240, s[12:15], s29 offen lds
    s_add_u32 m0, s28, 40960
    s_add_u32 s29, s40, 1376256
    buffer_load_dwordx4 v240, s[16:19], s29 offen lds
    s_add_u32 m0, s28, 45056
    s_add_u32 s29, s40, 1490944
    buffer_load_dwordx4 v240, s[16:19], s29 offen lds
    ds_read_b64_tr_b16 v[192:193], v248 offset:49152
    ds_read_b64_tr_b16 v[194:195], v248 offset:49664
    ds_read_b64_tr_b16 v[196:197], v249 offset:49152
    ds_read_b64_tr_b16 v[198:199], v249 offset:49664
    ds_read_b64_tr_b16 v[200:201], v250 offset:49152
    ds_read_b64_tr_b16 v[202:203], v250 offset:49664
    ds_read_b64_tr_b16 v[204:205], v251 offset:49152
    ds_read_b64_tr_b16 v[206:207], v251 offset:49664
    s_waitcnt lgkmcnt(6)
    v_mfma_f32_16x16x32_bf16 v[128:131], v[192:195], v[24:27], v[128:131]
    ds_read_b64_tr_b16 v[208:209], v248 offset:57344
    ds_read_b64_tr_b16 v[210:211], v248 offset:57856
    v_mfma_f32_16x16x32_bf16 v[132:135], v[192:195], v[88:91], v[132:135]
    s_waitcnt lgkmcnt(6)
    v_mfma_f32_16x16x32_bf16 v[136:139], v[196:199], v[24:27], v[136:139]
    ds_read_b64_tr_b16 v[212:213], v249 offset:57344
    ds_read_b64_tr_b16 v[214:215], v249 offset:57856
    v_mfma_f32_16x16x32_bf16 v[140:143], v[196:199], v[88:91], v[140:143]
    s_waitcnt lgkmcnt(6)
    v_mfma_f32_16x16x32_bf16 v[144:147], v[200:203], v[24:27], v[144:147]
    ds_read_b64_tr_b16 v[192:193], v250 offset:57344
    ds_read_b64_tr_b16 v[194:195], v250 offset:57856
    v_mfma_f32_16x16x32_bf16 v[148:151], v[200:203], v[88:91], v[148:151]
    s_waitcnt lgkmcnt(6)
    v_mfma_f32_16x16x32_bf16 v[152:155], v[204:207], v[24:27], v[152:155]
    ds_read_b64_tr_b16 v[196:197], v251 offset:57344
    ds_read_b64_tr_b16 v[198:199], v251 offset:57856
    v_mfma_f32_16x16x32_bf16 v[156:159], v[204:207], v[88:91], v[156:159]
    s_waitcnt lgkmcnt(6)
    v_mfma_f32_16x16x32_bf16 v[160:163], v[208:211], v[24:27], v[160:163]
    ds_read_b64_tr_b16 v[200:201], v248 offset:53248
    ds_read_b64_tr_b16 v[202:203], v248 offset:53760
    v_mfma_f32_16x16x32_bf16 v[164:167], v[208:211], v[88:91], v[164:167]
    s_waitcnt lgkmcnt(6)
    v_mfma_f32_16x16x32_bf16 v[168:171], v[212:215], v[24:27], v[168:171]
    ds_read_b64_tr_b16 v[204:205], v249 offset:53248
    ds_read_b64_tr_b16 v[206:207], v249 offset:53760
    v_mfma_f32_16x16x32_bf16 v[172:175], v[212:215], v[88:91], v[172:175]
    s_waitcnt lgkmcnt(6)
    v_mfma_f32_16x16x32_bf16 v[176:179], v[192:195], v[24:27], v[176:179]
    ds_read_b64_tr_b16 v[208:209], v250 offset:53248
    ds_read_b64_tr_b16 v[210:211], v250 offset:53760
    v_mfma_f32_16x16x32_bf16 v[180:183], v[192:195], v[88:91], v[180:183]
    s_waitcnt lgkmcnt(6)
    v_mfma_f32_16x16x32_bf16 v[184:187], v[196:199], v[24:27], v[184:187]
    ds_read_b64_tr_b16 v[212:213], v251 offset:53248
    ds_read_b64_tr_b16 v[214:215], v251 offset:53760
    v_mfma_f32_16x16x32_bf16 v[188:191], v[196:199], v[88:91], v[188:191]
    s_waitcnt lgkmcnt(6)
    v_mfma_f32_16x16x32_bf16 v[128:131], v[200:203], v[28:31], v[128:131]
    ds_read_b64_tr_b16 v[192:193], v248 offset:61440
    ds_read_b64_tr_b16 v[194:195], v248 offset:61952
    v_mfma_f32_16x16x32_bf16 v[132:135], v[200:203], v[92:95], v[132:135]
    s_waitcnt lgkmcnt(6)
    v_mfma_f32_16x16x32_bf16 v[136:139], v[204:207], v[28:31], v[136:139]
    ds_read_b64_tr_b16 v[196:197], v249 offset:61440
    ds_read_b64_tr_b16 v[198:199], v249 offset:61952
    v_mfma_f32_16x16x32_bf16 v[140:143], v[204:207], v[92:95], v[140:143]
    s_waitcnt lgkmcnt(6)
    v_mfma_f32_16x16x32_bf16 v[144:147], v[208:211], v[28:31], v[144:147]
    ds_read_b64_tr_b16 v[200:201], v250 offset:61440
    ds_read_b64_tr_b16 v[202:203], v250 offset:61952
    v_mfma_f32_16x16x32_bf16 v[148:151], v[208:211], v[92:95], v[148:151]
    s_waitcnt lgkmcnt(6)
    v_mfma_f32_16x16x32_bf16 v[152:155], v[212:215], v[28:31], v[152:155]
    ds_read_b64_tr_b16 v[204:205], v251 offset:61440
    ds_read_b64_tr_b16 v[206:207], v251 offset:61952
    v_mfma_f32_16x16x32_bf16 v[156:159], v[212:215], v[92:95], v[156:159]
    s_waitcnt lgkmcnt(6)
    v_mfma_f32_16x16x32_bf16 v[160:163], v[192:195], v[28:31], v[160:163]
    v_mfma_f32_16x16x32_bf16 v[164:167], v[192:195], v[92:95], v[164:167]
    s_waitcnt lgkmcnt(4)
    v_mfma_f32_16x16x32_bf16 v[168:171], v[196:199], v[28:31], v[168:171]
    v_mfma_f32_16x16x32_bf16 v[172:175], v[196:199], v[92:95], v[172:175]
    s_waitcnt lgkmcnt(2)
    v_mfma_f32_16x16x32_bf16 v[176:179], v[200:203], v[28:31], v[176:179]
    v_mfma_f32_16x16x32_bf16 v[180:183], v[200:203], v[92:95], v[180:183]
    s_waitcnt lgkmcnt(0)
    v_mfma_f32_16x16x32_bf16 v[184:187], v[204:207], v[28:31], v[184:187]
    v_mfma_f32_16x16x32_bf16 v[188:191], v[204:207], v[92:95], v[188:191]
    s_waitcnt vmcnt(8)
    s_waitcnt lgkmcnt(0)
    s_barrier
    s_add_u32 m0, s28, 49152
    s_add_u32 s29, s40, 1605632
    buffer_load_dwordx4 v240, s[12:15], s29 offen lds
    s_add_u32 m0, s28, 53248
    s_add_u32 s29, s40, 1720320
    buffer_load_dwordx4 v240, s[12:15], s29 offen lds
    s_add_u32 m0, s28, 57344
    s_add_u32 s29, s40, 1605632
    buffer_load_dwordx4 v240, s[16:19], s29 offen lds
    s_add_u32 m0, s28, 61440
    s_add_u32 s29, s40, 1720320
    buffer_load_dwordx4 v240, s[16:19], s29 offen lds
    ds_read_b64_tr_b16 v[192:193], v248 offset:0
    ds_read_b64_tr_b16 v[194:195], v248 offset:512
    ds_read_b64_tr_b16 v[196:197], v249 offset:0
    ds_read_b64_tr_b16 v[198:199], v249 offset:512
    ds_read_b64_tr_b16 v[200:201], v250 offset:0
    ds_read_b64_tr_b16 v[202:203], v250 offset:512
    ds_read_b64_tr_b16 v[204:205], v251 offset:0
    ds_read_b64_tr_b16 v[206:207], v251 offset:512
    s_waitcnt lgkmcnt(6)
    v_mfma_f32_16x16x32_bf16 v[128:131], v[192:195], v[32:35], v[128:131]
    ds_read_b64_tr_b16 v[208:209], v248 offset:8192
    ds_read_b64_tr_b16 v[210:211], v248 offset:8704
    v_mfma_f32_16x16x32_bf16 v[132:135], v[192:195], v[96:99], v[132:135]
    s_waitcnt lgkmcnt(6)
    v_mfma_f32_16x16x32_bf16 v[136:139], v[196:199], v[32:35], v[136:139]
    ds_read_b64_tr_b16 v[212:213], v249 offset:8192
    ds_read_b64_tr_b16 v[214:215], v249 offset:8704
    v_mfma_f32_16x16x32_bf16 v[140:143], v[196:199], v[96:99], v[140:143]
    s_waitcnt lgkmcnt(6)
    v_mfma_f32_16x16x32_bf16 v[144:147], v[200:203], v[32:35], v[144:147]
    ds_read_b64_tr_b16 v[192:193], v250 offset:8192
    ds_read_b64_tr_b16 v[194:195], v250 offset:8704
    v_mfma_f32_16x16x32_bf16 v[148:151], v[200:203], v[96:99], v[148:151]
    s_waitcnt lgkmcnt(6)
    v_mfma_f32_16x16x32_bf16 v[152:155], v[204:207], v[32:35], v[152:155]
    ds_read_b64_tr_b16 v[196:197], v251 offset:8192
    ds_read_b64_tr_b16 v[198:199], v251 offset:8704
    v_mfma_f32_16x16x32_bf16 v[156:159], v[204:207], v[96:99], v[156:159]
    s_waitcnt lgkmcnt(6)
    v_mfma_f32_16x16x32_bf16 v[160:163], v[208:211], v[32:35], v[160:163]
    ds_read_b64_tr_b16 v[200:201], v248 offset:4096
    ds_read_b64_tr_b16 v[202:203], v248 offset:4608
    v_mfma_f32_16x16x32_bf16 v[164:167], v[208:211], v[96:99], v[164:167]
    s_waitcnt lgkmcnt(6)
    v_mfma_f32_16x16x32_bf16 v[168:171], v[212:215], v[32:35], v[168:171]
    ds_read_b64_tr_b16 v[204:205], v249 offset:4096
    ds_read_b64_tr_b16 v[206:207], v249 offset:4608
    v_mfma_f32_16x16x32_bf16 v[172:175], v[212:215], v[96:99], v[172:175]
    s_waitcnt lgkmcnt(6)
    v_mfma_f32_16x16x32_bf16 v[176:179], v[192:195], v[32:35], v[176:179]
    ds_read_b64_tr_b16 v[208:209], v250 offset:4096
    ds_read_b64_tr_b16 v[210:211], v250 offset:4608
    v_mfma_f32_16x16x32_bf16 v[180:183], v[192:195], v[96:99], v[180:183]
    s_waitcnt lgkmcnt(6)
    v_mfma_f32_16x16x32_bf16 v[184:187], v[196:199], v[32:35], v[184:187]
    ds_read_b64_tr_b16 v[212:213], v251 offset:4096
    ds_read_b64_tr_b16 v[214:215], v251 offset:4608
    v_mfma_f32_16x16x32_bf16 v[188:191], v[196:199], v[96:99], v[188:191]
    s_waitcnt lgkmcnt(6)
    v_mfma_f32_16x16x32_bf16 v[128:131], v[200:203], v[36:39], v[128:131]
    ds_read_b64_tr_b16 v[192:193], v248 offset:12288
    ds_read_b64_tr_b16 v[194:195], v248 offset:12800
    v_mfma_f32_16x16x32_bf16 v[132:135], v[200:203], v[100:103], v[132:135]
    s_waitcnt lgkmcnt(6)
    v_mfma_f32_16x16x32_bf16 v[136:139], v[204:207], v[36:39], v[136:139]
    ds_read_b64_tr_b16 v[196:197], v249 offset:12288
    ds_read_b64_tr_b16 v[198:199], v249 offset:12800
    v_mfma_f32_16x16x32_bf16 v[140:143], v[204:207], v[100:103], v[140:143]
    s_waitcnt lgkmcnt(6)
    v_mfma_f32_16x16x32_bf16 v[144:147], v[208:211], v[36:39], v[144:147]
    ds_read_b64_tr_b16 v[200:201], v250 offset:12288
    ds_read_b64_tr_b16 v[202:203], v250 offset:12800
    v_mfma_f32_16x16x32_bf16 v[148:151], v[208:211], v[100:103], v[148:151]
    s_waitcnt lgkmcnt(6)
    v_mfma_f32_16x16x32_bf16 v[152:155], v[212:215], v[36:39], v[152:155]
    ds_read_b64_tr_b16 v[204:205], v251 offset:12288
    ds_read_b64_tr_b16 v[206:207], v251 offset:12800
    v_mfma_f32_16x16x32_bf16 v[156:159], v[212:215], v[100:103], v[156:159]
    s_waitcnt lgkmcnt(6)
    v_mfma_f32_16x16x32_bf16 v[160:163], v[192:195], v[36:39], v[160:163]
    v_mfma_f32_16x16x32_bf16 v[164:167], v[192:195], v[100:103], v[164:167]
    s_waitcnt lgkmcnt(4)
    v_mfma_f32_16x16x32_bf16 v[168:171], v[196:199], v[36:39], v[168:171]
    v_mfma_f32_16x16x32_bf16 v[172:175], v[196:199], v[100:103], v[172:175]
    s_waitcnt lgkmcnt(2)
    v_mfma_f32_16x16x32_bf16 v[176:179], v[200:203], v[36:39], v[176:179]
    v_mfma_f32_16x16x32_bf16 v[180:183], v[200:203], v[100:103], v[180:183]
    s_waitcnt lgkmcnt(0)
    v_mfma_f32_16x16x32_bf16 v[184:187], v[204:207], v[36:39], v[184:187]
    v_mfma_f32_16x16x32_bf16 v[188:191], v[204:207], v[100:103], v[188:191]
    s_waitcnt vmcnt(8)
    s_waitcnt lgkmcnt(0)
    s_barrier
    s_add_u32 m0, s28, 0
    s_add_u32 s29, s41, 0
    buffer_load_dwordx4 v241, s[24:27], s29 offen lds
    s_add_u32 m0, s28, 4096
    s_add_u32 s29, s41, 16384
    buffer_load_dwordx4 v241, s[24:27], s29 offen lds
    s_add_u32 m0, s28, 8192
    s_add_u32 s29, s41, 32768
    buffer_load_dwordx4 v241, s[24:27], s29 offen lds
    s_add_u32 m0, s28, 12288
    s_add_u32 s29, s41, 49152
    buffer_load_dwordx4 v241, s[24:27], s29 offen lds
    ds_read_b64_tr_b16 v[192:193], v248 offset:16384
    ds_read_b64_tr_b16 v[194:195], v248 offset:16896
    ds_read_b64_tr_b16 v[196:197], v249 offset:16384
    ds_read_b64_tr_b16 v[198:199], v249 offset:16896
    ds_read_b64_tr_b16 v[200:201], v250 offset:16384
    ds_read_b64_tr_b16 v[202:203], v250 offset:16896
    ds_read_b64_tr_b16 v[204:205], v251 offset:16384
    ds_read_b64_tr_b16 v[206:207], v251 offset:16896
    s_waitcnt lgkmcnt(6)
    v_mfma_f32_16x16x32_bf16 v[128:131], v[192:195], v[40:43], v[128:131]
    ds_read_b64_tr_b16 v[208:209], v248 offset:24576
    ds_read_b64_tr_b16 v[210:211], v248 offset:25088
    v_mfma_f32_16x16x32_bf16 v[132:135], v[192:195], v[104:107], v[132:135]
    s_waitcnt lgkmcnt(6)
    v_mfma_f32_16x16x32_bf16 v[136:139], v[196:199], v[40:43], v[136:139]
    ds_read_b64_tr_b16 v[212:213], v249 offset:24576
    ds_read_b64_tr_b16 v[214:215], v249 offset:25088
    v_mfma_f32_16x16x32_bf16 v[140:143], v[196:199], v[104:107], v[140:143]
    s_waitcnt lgkmcnt(6)
    v_mfma_f32_16x16x32_bf16 v[144:147], v[200:203], v[40:43], v[144:147]
    ds_read_b64_tr_b16 v[192:193], v250 offset:24576
    ds_read_b64_tr_b16 v[194:195], v250 offset:25088
    v_mfma_f32_16x16x32_bf16 v[148:151], v[200:203], v[104:107], v[148:151]
    s_waitcnt lgkmcnt(6)
    v_mfma_f32_16x16x32_bf16 v[152:155], v[204:207], v[40:43], v[152:155]
    ds_read_b64_tr_b16 v[196:197], v251 offset:24576
    ds_read_b64_tr_b16 v[198:199], v251 offset:25088
    v_mfma_f32_16x16x32_bf16 v[156:159], v[204:207], v[104:107], v[156:159]
    s_waitcnt lgkmcnt(6)
    v_mfma_f32_16x16x32_bf16 v[160:163], v[208:211], v[40:43], v[160:163]
    ds_read_b64_tr_b16 v[200:201], v248 offset:20480
    ds_read_b64_tr_b16 v[202:203], v248 offset:20992
    v_mfma_f32_16x16x32_bf16 v[164:167], v[208:211], v[104:107], v[164:167]
    s_waitcnt lgkmcnt(6)
    v_mfma_f32_16x16x32_bf16 v[168:171], v[212:215], v[40:43], v[168:171]
    ds_read_b64_tr_b16 v[204:205], v249 offset:20480
    ds_read_b64_tr_b16 v[206:207], v249 offset:20992
    v_mfma_f32_16x16x32_bf16 v[172:175], v[212:215], v[104:107], v[172:175]
    s_waitcnt lgkmcnt(6)
    v_mfma_f32_16x16x32_bf16 v[176:179], v[192:195], v[40:43], v[176:179]
    ds_read_b64_tr_b16 v[208:209], v250 offset:20480
    ds_read_b64_tr_b16 v[210:211], v250 offset:20992
    v_mfma_f32_16x16x32_bf16 v[180:183], v[192:195], v[104:107], v[180:183]
    s_waitcnt lgkmcnt(6)
    v_mfma_f32_16x16x32_bf16 v[184:187], v[196:199], v[40:43], v[184:187]
    ds_read_b64_tr_b16 v[212:213], v251 offset:20480
    ds_read_b64_tr_b16 v[214:215], v251 offset:20992
    v_mfma_f32_16x16x32_bf16 v[188:191], v[196:199], v[104:107], v[188:191]
    s_waitcnt lgkmcnt(6)
    v_mfma_f32_16x16x32_bf16 v[128:131], v[200:203], v[44:47], v[128:131]
    ds_read_b64_tr_b16 v[192:193], v248 offset:28672
    ds_read_b64_tr_b16 v[194:195], v248 offset:29184
    v_mfma_f32_16x16x32_bf16 v[132:135], v[200:203], v[108:111], v[132:135]
    s_waitcnt lgkmcnt(6)
    v_mfma_f32_16x16x32_bf16 v[136:139], v[204:207], v[44:47], v[136:139]
    ds_read_b64_tr_b16 v[196:197], v249 offset:28672
    ds_read_b64_tr_b16 v[198:199], v249 offset:29184
    v_mfma_f32_16x16x32_bf16 v[140:143], v[204:207], v[108:111], v[140:143]
    s_waitcnt lgkmcnt(6)
    v_mfma_f32_16x16x32_bf16 v[144:147], v[208:211], v[44:47], v[144:147]
    ds_read_b64_tr_b16 v[200:201], v250 offset:28672
    ds_read_b64_tr_b16 v[202:203], v250 offset:29184
    v_mfma_f32_16x16x32_bf16 v[148:151], v[208:211], v[108:111], v[148:151]
    s_waitcnt lgkmcnt(6)
    v_mfma_f32_16x16x32_bf16 v[152:155], v[212:215], v[44:47], v[152:155]
    ds_read_b64_tr_b16 v[204:205], v251 offset:28672
    ds_read_b64_tr_b16 v[206:207], v251 offset:29184
    v_mfma_f32_16x16x32_bf16 v[156:159], v[212:215], v[108:111], v[156:159]
    s_waitcnt lgkmcnt(6)
    v_mfma_f32_16x16x32_bf16 v[160:163], v[192:195], v[44:47], v[160:163]
    v_mfma_f32_16x16x32_bf16 v[164:167], v[192:195], v[108:111], v[164:167]
    s_waitcnt lgkmcnt(4)
    v_mfma_f32_16x16x32_bf16 v[168:171], v[196:199], v[44:47], v[168:171]
    v_mfma_f32_16x16x32_bf16 v[172:175], v[196:199], v[108:111], v[172:175]
    s_waitcnt lgkmcnt(2)
    v_mfma_f32_16x16x32_bf16 v[176:179], v[200:203], v[44:47], v[176:179]
    v_mfma_f32_16x16x32_bf16 v[180:183], v[200:203], v[108:111], v[180:183]
    s_waitcnt lgkmcnt(0)
    v_mfma_f32_16x16x32_bf16 v[184:187], v[204:207], v[44:47], v[184:187]
    v_mfma_f32_16x16x32_bf16 v[188:191], v[204:207], v[108:111], v[188:191]
    s_waitcnt vmcnt(8)
    s_waitcnt lgkmcnt(0)
    s_barrier
    s_add_u32 m0, s28, 16384
    s_add_u32 s29, s41, 256
    buffer_load_dwordx4 v241, s[24:27], s29 offen lds
    s_add_u32 m0, s28, 20480
    s_add_u32 s29, s41, 16640
    buffer_load_dwordx4 v241, s[24:27], s29 offen lds
    s_add_u32 m0, s28, 24576
    s_add_u32 s29, s41, 33024
    buffer_load_dwordx4 v241, s[24:27], s29 offen lds
    s_add_u32 m0, s28, 28672
    s_add_u32 s29, s41, 49408
    buffer_load_dwordx4 v241, s[24:27], s29 offen lds
    ds_read_b64_tr_b16 v[192:193], v248 offset:32768
    ds_read_b64_tr_b16 v[194:195], v248 offset:33280
    ds_read_b64_tr_b16 v[196:197], v249 offset:32768
    ds_read_b64_tr_b16 v[198:199], v249 offset:33280
    ds_read_b64_tr_b16 v[200:201], v250 offset:32768
    ds_read_b64_tr_b16 v[202:203], v250 offset:33280
    ds_read_b64_tr_b16 v[204:205], v251 offset:32768
    ds_read_b64_tr_b16 v[206:207], v251 offset:33280
    s_waitcnt lgkmcnt(6)
    v_mfma_f32_16x16x32_bf16 v[128:131], v[192:195], v[48:51], v[128:131]
    ds_read_b64_tr_b16 v[208:209], v248 offset:40960
    ds_read_b64_tr_b16 v[210:211], v248 offset:41472
    v_mfma_f32_16x16x32_bf16 v[132:135], v[192:195], v[112:115], v[132:135]
    s_waitcnt lgkmcnt(6)
    v_mfma_f32_16x16x32_bf16 v[136:139], v[196:199], v[48:51], v[136:139]
    ds_read_b64_tr_b16 v[212:213], v249 offset:40960
    ds_read_b64_tr_b16 v[214:215], v249 offset:41472
    v_mfma_f32_16x16x32_bf16 v[140:143], v[196:199], v[112:115], v[140:143]
    s_waitcnt lgkmcnt(6)
    v_mfma_f32_16x16x32_bf16 v[144:147], v[200:203], v[48:51], v[144:147]
    ds_read_b64_tr_b16 v[192:193], v250 offset:40960
    ds_read_b64_tr_b16 v[194:195], v250 offset:41472
    v_mfma_f32_16x16x32_bf16 v[148:151], v[200:203], v[112:115], v[148:151]
    s_waitcnt lgkmcnt(6)
    v_mfma_f32_16x16x32_bf16 v[152:155], v[204:207], v[48:51], v[152:155]
    ds_read_b64_tr_b16 v[196:197], v251 offset:40960
    ds_read_b64_tr_b16 v[198:199], v251 offset:41472
    v_mfma_f32_16x16x32_bf16 v[156:159], v[204:207], v[112:115], v[156:159]
    s_waitcnt lgkmcnt(6)
    v_mfma_f32_16x16x32_bf16 v[160:163], v[208:211], v[48:51], v[160:163]
    ds_read_b64_tr_b16 v[200:201], v248 offset:36864
    ds_read_b64_tr_b16 v[202:203], v248 offset:37376
    v_mfma_f32_16x16x32_bf16 v[164:167], v[208:211], v[112:115], v[164:167]
    s_waitcnt lgkmcnt(6)
    v_mfma_f32_16x16x32_bf16 v[168:171], v[212:215], v[48:51], v[168:171]
    ds_read_b64_tr_b16 v[204:205], v249 offset:36864
    ds_read_b64_tr_b16 v[206:207], v249 offset:37376
    v_mfma_f32_16x16x32_bf16 v[172:175], v[212:215], v[112:115], v[172:175]
    s_waitcnt lgkmcnt(6)
    v_mfma_f32_16x16x32_bf16 v[176:179], v[192:195], v[48:51], v[176:179]
    ds_read_b64_tr_b16 v[208:209], v250 offset:36864
    ds_read_b64_tr_b16 v[210:211], v250 offset:37376
    v_mfma_f32_16x16x32_bf16 v[180:183], v[192:195], v[112:115], v[180:183]
    s_waitcnt lgkmcnt(6)
    v_mfma_f32_16x16x32_bf16 v[184:187], v[196:199], v[48:51], v[184:187]
    ds_read_b64_tr_b16 v[212:213], v251 offset:36864
    ds_read_b64_tr_b16 v[214:215], v251 offset:37376
    v_mfma_f32_16x16x32_bf16 v[188:191], v[196:199], v[112:115], v[188:191]
    s_waitcnt lgkmcnt(6)
    v_mfma_f32_16x16x32_bf16 v[128:131], v[200:203], v[52:55], v[128:131]
    ds_read_b64_tr_b16 v[192:193], v248 offset:45056
    ds_read_b64_tr_b16 v[194:195], v248 offset:45568
    v_mfma_f32_16x16x32_bf16 v[132:135], v[200:203], v[116:119], v[132:135]
    s_waitcnt lgkmcnt(6)
    v_mfma_f32_16x16x32_bf16 v[136:139], v[204:207], v[52:55], v[136:139]
    ds_read_b64_tr_b16 v[196:197], v249 offset:45056
    ds_read_b64_tr_b16 v[198:199], v249 offset:45568
    v_mfma_f32_16x16x32_bf16 v[140:143], v[204:207], v[116:119], v[140:143]
    s_waitcnt lgkmcnt(6)
    v_mfma_f32_16x16x32_bf16 v[144:147], v[208:211], v[52:55], v[144:147]
    ds_read_b64_tr_b16 v[200:201], v250 offset:45056
    ds_read_b64_tr_b16 v[202:203], v250 offset:45568
    v_mfma_f32_16x16x32_bf16 v[148:151], v[208:211], v[116:119], v[148:151]
    s_waitcnt lgkmcnt(6)
    v_mfma_f32_16x16x32_bf16 v[152:155], v[212:215], v[52:55], v[152:155]
    ds_read_b64_tr_b16 v[204:205], v251 offset:45056
    ds_read_b64_tr_b16 v[206:207], v251 offset:45568
    v_mfma_f32_16x16x32_bf16 v[156:159], v[212:215], v[116:119], v[156:159]
    s_waitcnt lgkmcnt(6)
    v_mfma_f32_16x16x32_bf16 v[160:163], v[192:195], v[52:55], v[160:163]
    v_mfma_f32_16x16x32_bf16 v[164:167], v[192:195], v[116:119], v[164:167]
    s_waitcnt lgkmcnt(4)
    v_mfma_f32_16x16x32_bf16 v[168:171], v[196:199], v[52:55], v[168:171]
    v_mfma_f32_16x16x32_bf16 v[172:175], v[196:199], v[116:119], v[172:175]
    s_waitcnt lgkmcnt(2)
    v_mfma_f32_16x16x32_bf16 v[176:179], v[200:203], v[52:55], v[176:179]
    v_mfma_f32_16x16x32_bf16 v[180:183], v[200:203], v[116:119], v[180:183]
    s_waitcnt lgkmcnt(0)
    v_mfma_f32_16x16x32_bf16 v[184:187], v[204:207], v[52:55], v[184:187]
    v_mfma_f32_16x16x32_bf16 v[188:191], v[204:207], v[116:119], v[188:191]
    s_waitcnt vmcnt(8)
    s_waitcnt lgkmcnt(0)
    s_barrier
    s_add_u32 m0, s28, 32768
    s_add_u32 s29, s41, 512
    buffer_load_dwordx4 v241, s[24:27], s29 offen lds
    s_add_u32 m0, s28, 36864
    s_add_u32 s29, s41, 16896
    buffer_load_dwordx4 v241, s[24:27], s29 offen lds
    s_add_u32 m0, s28, 40960
    s_add_u32 s29, s41, 33280
    buffer_load_dwordx4 v241, s[24:27], s29 offen lds
    s_add_u32 m0, s28, 45056
    s_add_u32 s29, s41, 49664
    buffer_load_dwordx4 v241, s[24:27], s29 offen lds
    ds_read_b64_tr_b16 v[192:193], v248 offset:49152
    ds_read_b64_tr_b16 v[194:195], v248 offset:49664
    ds_read_b64_tr_b16 v[196:197], v249 offset:49152
    ds_read_b64_tr_b16 v[198:199], v249 offset:49664
    ds_read_b64_tr_b16 v[200:201], v250 offset:49152
    ds_read_b64_tr_b16 v[202:203], v250 offset:49664
    ds_read_b64_tr_b16 v[204:205], v251 offset:49152
    ds_read_b64_tr_b16 v[206:207], v251 offset:49664
    s_waitcnt lgkmcnt(6)
    v_mfma_f32_16x16x32_bf16 v[128:131], v[192:195], v[56:59], v[128:131]
    ds_read_b64_tr_b16 v[208:209], v248 offset:57344
    ds_read_b64_tr_b16 v[210:211], v248 offset:57856
    v_mfma_f32_16x16x32_bf16 v[132:135], v[192:195], v[120:123], v[132:135]
    s_waitcnt lgkmcnt(6)
    v_mfma_f32_16x16x32_bf16 v[136:139], v[196:199], v[56:59], v[136:139]
    ds_read_b64_tr_b16 v[212:213], v249 offset:57344
    ds_read_b64_tr_b16 v[214:215], v249 offset:57856
    v_mfma_f32_16x16x32_bf16 v[140:143], v[196:199], v[120:123], v[140:143]
    s_waitcnt lgkmcnt(6)
    v_mfma_f32_16x16x32_bf16 v[144:147], v[200:203], v[56:59], v[144:147]
    ds_read_b64_tr_b16 v[192:193], v250 offset:57344
    ds_read_b64_tr_b16 v[194:195], v250 offset:57856
    v_mfma_f32_16x16x32_bf16 v[148:151], v[200:203], v[120:123], v[148:151]
    s_waitcnt lgkmcnt(6)
    v_mfma_f32_16x16x32_bf16 v[152:155], v[204:207], v[56:59], v[152:155]
    ds_read_b64_tr_b16 v[196:197], v251 offset:57344
    ds_read_b64_tr_b16 v[198:199], v251 offset:57856
    v_mfma_f32_16x16x32_bf16 v[156:159], v[204:207], v[120:123], v[156:159]
    s_waitcnt lgkmcnt(6)
    v_mfma_f32_16x16x32_bf16 v[160:163], v[208:211], v[56:59], v[160:163]
    ds_read_b64_tr_b16 v[200:201], v248 offset:53248
    ds_read_b64_tr_b16 v[202:203], v248 offset:53760
    v_mfma_f32_16x16x32_bf16 v[164:167], v[208:211], v[120:123], v[164:167]
    s_waitcnt lgkmcnt(6)
    v_mfma_f32_16x16x32_bf16 v[168:171], v[212:215], v[56:59], v[168:171]
    ds_read_b64_tr_b16 v[204:205], v249 offset:53248
    ds_read_b64_tr_b16 v[206:207], v249 offset:53760
    v_mfma_f32_16x16x32_bf16 v[172:175], v[212:215], v[120:123], v[172:175]
    s_waitcnt lgkmcnt(6)
    v_mfma_f32_16x16x32_bf16 v[176:179], v[192:195], v[56:59], v[176:179]
    ds_read_b64_tr_b16 v[208:209], v250 offset:53248
    ds_read_b64_tr_b16 v[210:211], v250 offset:53760
    v_mfma_f32_16x16x32_bf16 v[180:183], v[192:195], v[120:123], v[180:183]
    s_waitcnt lgkmcnt(6)
    v_mfma_f32_16x16x32_bf16 v[184:187], v[196:199], v[56:59], v[184:187]
    ds_read_b64_tr_b16 v[212:213], v251 offset:53248
    ds_read_b64_tr_b16 v[214:215], v251 offset:53760
    v_mfma_f32_16x16x32_bf16 v[188:191], v[196:199], v[120:123], v[188:191]
    s_waitcnt lgkmcnt(6)
    v_mfma_f32_16x16x32_bf16 v[128:131], v[200:203], v[60:63], v[128:131]
    ds_read_b64_tr_b16 v[192:193], v248 offset:61440
    ds_read_b64_tr_b16 v[194:195], v248 offset:61952
    v_mfma_f32_16x16x32_bf16 v[132:135], v[200:203], v[124:127], v[132:135]
    s_waitcnt lgkmcnt(6)
    v_mfma_f32_16x16x32_bf16 v[136:139], v[204:207], v[60:63], v[136:139]
    ds_read_b64_tr_b16 v[196:197], v249 offset:61440
    ds_read_b64_tr_b16 v[198:199], v249 offset:61952
    v_mfma_f32_16x16x32_bf16 v[140:143], v[204:207], v[124:127], v[140:143]
    s_waitcnt lgkmcnt(6)
    v_mfma_f32_16x16x32_bf16 v[144:147], v[208:211], v[60:63], v[144:147]
    ds_read_b64_tr_b16 v[200:201], v250 offset:61440
    ds_read_b64_tr_b16 v[202:203], v250 offset:61952
    v_mfma_f32_16x16x32_bf16 v[148:151], v[208:211], v[124:127], v[148:151]
    s_waitcnt lgkmcnt(6)
    v_mfma_f32_16x16x32_bf16 v[152:155], v[212:215], v[60:63], v[152:155]
    ds_read_b64_tr_b16 v[204:205], v251 offset:61440
    ds_read_b64_tr_b16 v[206:207], v251 offset:61952
    v_mfma_f32_16x16x32_bf16 v[156:159], v[212:215], v[124:127], v[156:159]
    s_waitcnt lgkmcnt(6)
    v_mfma_f32_16x16x32_bf16 v[160:163], v[192:195], v[60:63], v[160:163]
    v_mfma_f32_16x16x32_bf16 v[164:167], v[192:195], v[124:127], v[164:167]
    s_waitcnt lgkmcnt(4)
    v_mfma_f32_16x16x32_bf16 v[168:171], v[196:199], v[60:63], v[168:171]
    v_mfma_f32_16x16x32_bf16 v[172:175], v[196:199], v[124:127], v[172:175]
    s_waitcnt lgkmcnt(2)
    v_mfma_f32_16x16x32_bf16 v[176:179], v[200:203], v[60:63], v[176:179]
    v_mfma_f32_16x16x32_bf16 v[180:183], v[200:203], v[124:127], v[180:183]
    s_waitcnt lgkmcnt(0)
    v_mfma_f32_16x16x32_bf16 v[184:187], v[204:207], v[60:63], v[184:187]
    v_mfma_f32_16x16x32_bf16 v[188:191], v[204:207], v[124:127], v[188:191]
    v_mul_f32 v244, v128, v128
    v_mul_f32 v245, v129, v129
    v_mul_f32 v246, v130, v130
    v_mul_f32 v247, v131, v131
    v_mov_b32 v192, s38
    v_fmac_f32 v192, s39, v244
    v_mov_b32 v193, s38
    v_fmac_f32 v193, s39, v245
    v_mov_b32 v194, s38
    v_fmac_f32 v194, s39, v246
    v_mov_b32 v195, s38
    v_fmac_f32 v195, s39, v247
    v_mul_f32 v244, v192, v128
    v_mul_f32 v245, v193, v129
    v_mul_f32 v246, v194, v130
    v_mul_f32 v247, v195, v131
    v_exp_f32 v244, v244
    v_exp_f32 v245, v245
    v_exp_f32 v246, v246
    v_exp_f32 v247, v247
    v_mul_f32 v160, v160, v128
    v_mul_f32 v161, v161, v129
    v_mul_f32 v162, v162, v130
    v_mul_f32 v163, v163, v131
    v_add_f32 v244, 1.0, v244
    v_add_f32 v245, 1.0, v245
    v_add_f32 v246, 1.0, v246
    v_add_f32 v247, 1.0, v247
    v_rcp_f32 v244, v244
    v_rcp_f32 v245, v245
    v_rcp_f32 v246, v246
    v_rcp_f32 v247, v247
    v_mul_f32 v160, v160, v244
    v_mul_f32 v161, v161, v245
    v_mul_f32 v162, v162, v246
    v_mul_f32 v163, v163, v247
    v_cvt_pk_bf16_f32 v216, v160, v161
    v_cvt_pk_bf16_f32 v217, v162, v163
    v_mul_f32 v244, v132, v132
    v_mul_f32 v245, v133, v133
    v_mul_f32 v246, v134, v134
    v_mul_f32 v247, v135, v135
    v_mov_b32 v192, s38
    v_fmac_f32 v192, s39, v244
    v_mov_b32 v193, s38
    v_fmac_f32 v193, s39, v245
    v_mov_b32 v194, s38
    v_fmac_f32 v194, s39, v246
    v_mov_b32 v195, s38
    v_fmac_f32 v195, s39, v247
    v_mul_f32 v244, v192, v132
    v_mul_f32 v245, v193, v133
    v_mul_f32 v246, v194, v134
    v_mul_f32 v247, v195, v135
    v_exp_f32 v244, v244
    v_exp_f32 v245, v245
    v_exp_f32 v246, v246
    v_exp_f32 v247, v247
    v_mul_f32 v164, v164, v132
    v_mul_f32 v165, v165, v133
    v_mul_f32 v166, v166, v134
    v_mul_f32 v167, v167, v135
    v_add_f32 v244, 1.0, v244
    v_add_f32 v245, 1.0, v245
    v_add_f32 v246, 1.0, v246
    v_add_f32 v247, 1.0, v247
    v_rcp_f32 v244, v244
    v_rcp_f32 v245, v245
    v_rcp_f32 v246, v246
    v_rcp_f32 v247, v247
    v_mul_f32 v164, v164, v244
    v_mul_f32 v165, v165, v245
    v_mul_f32 v166, v166, v246
    v_mul_f32 v167, v167, v247
    v_cvt_pk_bf16_f32 v220, v164, v165
    v_cvt_pk_bf16_f32 v221, v166, v167
    v_mul_f32 v244, v136, v136
    v_mul_f32 v245, v137, v137
    v_mul_f32 v246, v138, v138
    v_mul_f32 v247, v139, v139
    v_mov_b32 v192, s38
    v_fmac_f32 v192, s39, v244
    v_mov_b32 v193, s38
    v_fmac_f32 v193, s39, v245
    v_mov_b32 v194, s38
    v_fmac_f32 v194, s39, v246
    v_mov_b32 v195, s38
    v_fmac_f32 v195, s39, v247
    v_mul_f32 v244, v192, v136
    v_mul_f32 v245, v193, v137
    v_mul_f32 v246, v194, v138
    v_mul_f32 v247, v195, v139
    v_exp_f32 v244, v244
    v_exp_f32 v245, v245
    v_exp_f32 v246, v246
    v_exp_f32 v247, v247
    v_mul_f32 v168, v168, v136
    v_mul_f32 v169, v169, v137
    v_mul_f32 v170, v170, v138
    v_mul_f32 v171, v171, v139
    v_add_f32 v244, 1.0, v244
    v_add_f32 v245, 1.0, v245
    v_add_f32 v246, 1.0, v246
    v_add_f32 v247, 1.0, v247
    v_rcp_f32 v244, v244
    v_rcp_f32 v245, v245
    v_rcp_f32 v246, v246
    v_rcp_f32 v247, v247
    v_mul_f32 v168, v168, v244
    v_mul_f32 v169, v169, v245
    v_mul_f32 v170, v170, v246
    v_mul_f32 v171, v171, v247
    v_cvt_pk_bf16_f32 v218, v168, v169
    v_cvt_pk_bf16_f32 v219, v170, v171
    v_mul_f32 v244, v140, v140
    v_mul_f32 v245, v141, v141
    v_mul_f32 v246, v142, v142
    v_mul_f32 v247, v143, v143
    v_mov_b32 v192, s38
    v_fmac_f32 v192, s39, v244
    v_mov_b32 v193, s38
    v_fmac_f32 v193, s39, v245
    v_mov_b32 v194, s38
    v_fmac_f32 v194, s39, v246
    v_mov_b32 v195, s38
    v_fmac_f32 v195, s39, v247
    v_mul_f32 v244, v192, v140
    v_mul_f32 v245, v193, v141
    v_mul_f32 v246, v194, v142
    v_mul_f32 v247, v195, v143
    v_exp_f32 v244, v244
    v_exp_f32 v245, v245
    v_exp_f32 v246, v246
    v_exp_f32 v247, v247
    v_mul_f32 v172, v172, v140
    v_mul_f32 v173, v173, v141
    v_mul_f32 v174, v174, v142
    v_mul_f32 v175, v175, v143
    v_add_f32 v244, 1.0, v244
    v_add_f32 v245, 1.0, v245
    v_add_f32 v246, 1.0, v246
    v_add_f32 v247, 1.0, v247
    v_rcp_f32 v244, v244
    v_rcp_f32 v245, v245
    v_rcp_f32 v246, v246
    v_rcp_f32 v247, v247
    v_mul_f32 v172, v172, v244
    v_mul_f32 v173, v173, v245
    v_mul_f32 v174, v174, v246
    v_mul_f32 v175, v175, v247
    v_cvt_pk_bf16_f32 v222, v172, v173
    v_cvt_pk_bf16_f32 v223, v174, v175
    v_mul_f32 v244, v144, v144
    v_mul_f32 v245, v145, v145
    v_mul_f32 v246, v146, v146
    v_mul_f32 v247, v147, v147
    v_mov_b32 v192, s38
    v_fmac_f32 v192, s39, v244
    v_mov_b32 v193, s38
    v_fmac_f32 v193, s39, v245
    v_mov_b32 v194, s38
    v_fmac_f32 v194, s39, v246
    v_mov_b32 v195, s38
    v_fmac_f32 v195, s39, v247
    v_mul_f32 v244, v192, v144
    v_mul_f32 v245, v193, v145
    v_mul_f32 v246, v194, v146
    v_mul_f32 v247, v195, v147
    v_exp_f32 v244, v244
    v_exp_f32 v245, v245
    v_exp_f32 v246, v246
    v_exp_f32 v247, v247
    v_mul_f32 v176, v176, v144
    v_mul_f32 v177, v177, v145
    v_mul_f32 v178, v178, v146
    v_mul_f32 v179, v179, v147
    v_add_f32 v244, 1.0, v244
    v_add_f32 v245, 1.0, v245
    v_add_f32 v246, 1.0, v246
    v_add_f32 v247, 1.0, v247
    v_rcp_f32 v244, v244
    v_rcp_f32 v245, v245
    v_rcp_f32 v246, v246
    v_rcp_f32 v247, v247
    v_mul_f32 v176, v176, v244
    v_mul_f32 v177, v177, v245
    v_mul_f32 v178, v178, v246
    v_mul_f32 v179, v179, v247
    v_cvt_pk_bf16_f32 v224, v176, v177
    v_cvt_pk_bf16_f32 v225, v178, v179
    v_mul_f32 v244, v148, v148
    v_mul_f32 v245, v149, v149
    v_mul_f32 v246, v150, v150
    v_mul_f32 v247, v151, v151
    v_mov_b32 v192, s38
    v_fmac_f32 v192, s39, v244
    v_mov_b32 v193, s38
    v_fmac_f32 v193, s39, v245
    v_mov_b32 v194, s38
    v_fmac_f32 v194, s39, v246
    v_mov_b32 v195, s38
    v_fmac_f32 v195, s39, v247
    v_mul_f32 v244, v192, v148
    v_mul_f32 v245, v193, v149
    v_mul_f32 v246, v194, v150
    v_mul_f32 v247, v195, v151
    v_exp_f32 v244, v244
    v_exp_f32 v245, v245
    v_exp_f32 v246, v246
    v_exp_f32 v247, v247
    v_mul_f32 v180, v180, v148
    v_mul_f32 v181, v181, v149
    v_mul_f32 v182, v182, v150
    v_mul_f32 v183, v183, v151
    v_add_f32 v244, 1.0, v244
    v_add_f32 v245, 1.0, v245
    v_add_f32 v246, 1.0, v246
    v_add_f32 v247, 1.0, v247
    v_rcp_f32 v244, v244
    v_rcp_f32 v245, v245
    v_rcp_f32 v246, v246
    v_rcp_f32 v247, v247
    v_mul_f32 v180, v180, v244
    v_mul_f32 v181, v181, v245
    v_mul_f32 v182, v182, v246
    v_mul_f32 v183, v183, v247
    v_cvt_pk_bf16_f32 v228, v180, v181
    v_cvt_pk_bf16_f32 v229, v182, v183
    v_mul_f32 v244, v152, v152
    v_mul_f32 v245, v153, v153
    v_mul_f32 v246, v154, v154
    v_mul_f32 v247, v155, v155
    v_mov_b32 v192, s38
    v_fmac_f32 v192, s39, v244
    v_mov_b32 v193, s38
    v_fmac_f32 v193, s39, v245
    v_mov_b32 v194, s38
    v_fmac_f32 v194, s39, v246
    v_mov_b32 v195, s38
    v_fmac_f32 v195, s39, v247
    v_mul_f32 v244, v192, v152
    v_mul_f32 v245, v193, v153
    v_mul_f32 v246, v194, v154
    v_mul_f32 v247, v195, v155
    v_exp_f32 v244, v244
    v_exp_f32 v245, v245
    v_exp_f32 v246, v246
    v_exp_f32 v247, v247
    v_mul_f32 v184, v184, v152
    v_mul_f32 v185, v185, v153
    v_mul_f32 v186, v186, v154
    v_mul_f32 v187, v187, v155
    v_add_f32 v244, 1.0, v244
    v_add_f32 v245, 1.0, v245
    v_add_f32 v246, 1.0, v246
    v_add_f32 v247, 1.0, v247
    v_rcp_f32 v244, v244
    v_rcp_f32 v245, v245
    v_rcp_f32 v246, v246
    v_rcp_f32 v247, v247
    v_mul_f32 v184, v184, v244
    v_mul_f32 v185, v185, v245
    v_mul_f32 v186, v186, v246
    v_mul_f32 v187, v187, v247
    v_cvt_pk_bf16_f32 v226, v184, v185
    v_cvt_pk_bf16_f32 v227, v186, v187
    v_mul_f32 v244, v156, v156
    v_mul_f32 v245, v157, v157
    v_mul_f32 v246, v158, v158
    v_mul_f32 v247, v159, v159
    v_mov_b32 v192, s38
    v_fmac_f32 v192, s39, v244
    v_mov_b32 v193, s38
    v_fmac_f32 v193, s39, v245
    v_mov_b32 v194, s38
    v_fmac_f32 v194, s39, v246
    v_mov_b32 v195, s38
    v_fmac_f32 v195, s39, v247
    v_mul_f32 v244, v192, v156
    v_mul_f32 v245, v193, v157
    v_mul_f32 v246, v194, v158
    v_mul_f32 v247, v195, v159
    v_exp_f32 v244, v244
    v_exp_f32 v245, v245
    v_exp_f32 v246, v246
    v_exp_f32 v247, v247
    v_mul_f32 v188, v188, v156
    v_mul_f32 v189, v189, v157
    v_mul_f32 v190, v190, v158
    v_mul_f32 v191, v191, v159
    v_add_f32 v244, 1.0, v244
    v_add_f32 v245, 1.0, v245
    v_add_f32 v246, 1.0, v246
    v_add_f32 v247, 1.0, v247
    v_rcp_f32 v244, v244
    v_rcp_f32 v245, v245
    v_rcp_f32 v246, v246
    v_rcp_f32 v247, v247
    v_mul_f32 v188, v188, v244
    v_mul_f32 v189, v189, v245
    v_mul_f32 v190, v190, v246
    v_mul_f32 v191, v191, v247
    v_cvt_pk_bf16_f32 v230, v188, v189
    v_cvt_pk_bf16_f32 v231, v190, v191
    s_waitcnt vmcnt(8)
    s_waitcnt lgkmcnt(0)
    s_barrier
    s_add_u32 m0, s28, 49152
    s_add_u32 s29, s41, 768
    buffer_load_dwordx4 v241, s[24:27], s29 offen lds
    s_add_u32 m0, s28, 53248
    s_add_u32 s29, s41, 17152
    buffer_load_dwordx4 v241, s[24:27], s29 offen lds
    s_add_u32 m0, s28, 57344
    s_add_u32 s29, s41, 33536
    buffer_load_dwordx4 v241, s[24:27], s29 offen lds
    s_add_u32 m0, s28, 61440
    s_add_u32 s29, s41, 49920
    buffer_load_dwordx4 v241, s[24:27], s29 offen lds
    ds_read_b64_tr_b16 v[192:193], v232 offset:0
    ds_read_b64_tr_b16 v[194:195], v232 offset:4096
    ds_read_b64_tr_b16 v[196:197], v233 offset:0
    ds_read_b64_tr_b16 v[198:199], v233 offset:4096
    ds_read_b64_tr_b16 v[200:201], v234 offset:0
    ds_read_b64_tr_b16 v[202:203], v234 offset:4096
    ds_read_b64_tr_b16 v[204:205], v235 offset:0
    ds_read_b64_tr_b16 v[206:207], v235 offset:4096
    s_waitcnt lgkmcnt(6)
    v_mfma_f32_16x16x32_bf16 a[0:3], v[192:195], v[216:219], a[0:3]
    ds_read_b64_tr_b16 v[208:209], v236 offset:0
    ds_read_b64_tr_b16 v[210:211], v236 offset:4096
    v_mfma_f32_16x16x32_bf16 a[4:7], v[192:195], v[220:223], a[4:7]
    s_waitcnt lgkmcnt(6)
    v_mfma_f32_16x16x32_bf16 a[8:11], v[196:199], v[216:219], a[8:11]
    ds_read_b64_tr_b16 v[212:213], v237 offset:0
    ds_read_b64_tr_b16 v[214:215], v237 offset:4096
    v_mfma_f32_16x16x32_bf16 a[12:15], v[196:199], v[220:223], a[12:15]
    s_waitcnt lgkmcnt(6)
    v_mfma_f32_16x16x32_bf16 a[16:19], v[200:203], v[216:219], a[16:19]
    ds_read_b64_tr_b16 v[192:193], v238 offset:0
    ds_read_b64_tr_b16 v[194:195], v238 offset:4096
    v_mfma_f32_16x16x32_bf16 a[20:23], v[200:203], v[220:223], a[20:23]
    s_waitcnt lgkmcnt(6)
    v_mfma_f32_16x16x32_bf16 a[24:27], v[204:207], v[216:219], a[24:27]
    ds_read_b64_tr_b16 v[196:197], v239 offset:0
    ds_read_b64_tr_b16 v[198:199], v239 offset:4096
    v_mfma_f32_16x16x32_bf16 a[28:31], v[204:207], v[220:223], a[28:31]
    s_waitcnt lgkmcnt(6)
    v_mfma_f32_16x16x32_bf16 a[32:35], v[208:211], v[216:219], a[32:35]
    ds_read_b64_tr_b16 v[200:201], v232 offset:8192
    ds_read_b64_tr_b16 v[202:203], v232 offset:12288
    v_mfma_f32_16x16x32_bf16 a[36:39], v[208:211], v[220:223], a[36:39]
    s_waitcnt lgkmcnt(6)
    v_mfma_f32_16x16x32_bf16 a[40:43], v[212:215], v[216:219], a[40:43]
    ds_read_b64_tr_b16 v[204:205], v233 offset:8192
    ds_read_b64_tr_b16 v[206:207], v233 offset:12288
    v_mfma_f32_16x16x32_bf16 a[44:47], v[212:215], v[220:223], a[44:47]
    s_waitcnt lgkmcnt(6)
    v_mfma_f32_16x16x32_bf16 a[48:51], v[192:195], v[216:219], a[48:51]
    ds_read_b64_tr_b16 v[208:209], v234 offset:8192
    ds_read_b64_tr_b16 v[210:211], v234 offset:12288
    v_mfma_f32_16x16x32_bf16 a[52:55], v[192:195], v[220:223], a[52:55]
    s_waitcnt lgkmcnt(6)
    v_mfma_f32_16x16x32_bf16 a[56:59], v[196:199], v[216:219], a[56:59]
    ds_read_b64_tr_b16 v[212:213], v235 offset:8192
    ds_read_b64_tr_b16 v[214:215], v235 offset:12288
    v_mfma_f32_16x16x32_bf16 a[60:63], v[196:199], v[220:223], a[60:63]
    s_waitcnt lgkmcnt(6)
    v_mfma_f32_16x16x32_bf16 a[0:3], v[200:203], v[224:227], a[0:3]
    ds_read_b64_tr_b16 v[192:193], v236 offset:8192
    ds_read_b64_tr_b16 v[194:195], v236 offset:12288
    v_mfma_f32_16x16x32_bf16 a[4:7], v[200:203], v[228:231], a[4:7]
    s_waitcnt lgkmcnt(6)
    v_mfma_f32_16x16x32_bf16 a[8:11], v[204:207], v[224:227], a[8:11]
    ds_read_b64_tr_b16 v[196:197], v237 offset:8192
    ds_read_b64_tr_b16 v[198:199], v237 offset:12288
    v_mfma_f32_16x16x32_bf16 a[12:15], v[204:207], v[228:231], a[12:15]
    s_waitcnt lgkmcnt(6)
    v_mfma_f32_16x16x32_bf16 a[16:19], v[208:211], v[224:227], a[16:19]
    ds_read_b64_tr_b16 v[200:201], v238 offset:8192
    ds_read_b64_tr_b16 v[202:203], v238 offset:12288
    v_mfma_f32_16x16x32_bf16 a[20:23], v[208:211], v[228:231], a[20:23]
    s_waitcnt lgkmcnt(6)
    v_mfma_f32_16x16x32_bf16 a[24:27], v[212:215], v[224:227], a[24:27]
    ds_read_b64_tr_b16 v[204:205], v239 offset:8192
    ds_read_b64_tr_b16 v[206:207], v239 offset:12288
    v_mfma_f32_16x16x32_bf16 a[28:31], v[212:215], v[228:231], a[28:31]
    s_waitcnt lgkmcnt(6)
    v_mfma_f32_16x16x32_bf16 a[32:35], v[192:195], v[224:227], a[32:35]
    v_mfma_f32_16x16x32_bf16 a[36:39], v[192:195], v[228:231], a[36:39]
    s_waitcnt lgkmcnt(4)
    v_mfma_f32_16x16x32_bf16 a[40:43], v[196:199], v[224:227], a[40:43]
    v_mfma_f32_16x16x32_bf16 a[44:47], v[196:199], v[228:231], a[44:47]
    s_waitcnt lgkmcnt(2)
    v_mfma_f32_16x16x32_bf16 a[48:51], v[200:203], v[224:227], a[48:51]
    v_mfma_f32_16x16x32_bf16 a[52:55], v[200:203], v[228:231], a[52:55]
    s_waitcnt lgkmcnt(0)
    v_mfma_f32_16x16x32_bf16 a[56:59], v[204:207], v[224:227], a[56:59]
    v_mfma_f32_16x16x32_bf16 a[60:63], v[204:207], v[228:231], a[60:63]
    s_waitcnt vmcnt(8)
    s_waitcnt lgkmcnt(0)
    s_barrier
    s_add_u32 m0, s28, 0
    s_add_u32 s29, s40, 128
    buffer_load_dwordx4 v240, s[12:15], s29 offen lds
    s_add_u32 m0, s28, 4096
    s_add_u32 s29, s40, 114816
    buffer_load_dwordx4 v240, s[12:15], s29 offen lds
    s_add_u32 m0, s28, 8192
    s_add_u32 s29, s40, 128
    buffer_load_dwordx4 v240, s[16:19], s29 offen lds
    s_add_u32 m0, s28, 12288
    s_add_u32 s29, s40, 114816
    buffer_load_dwordx4 v240, s[16:19], s29 offen lds
    ds_read_b64_tr_b16 v[192:193], v232 offset:16384
    ds_read_b64_tr_b16 v[194:195], v232 offset:20480
    ds_read_b64_tr_b16 v[196:197], v233 offset:16384
    ds_read_b64_tr_b16 v[198:199], v233 offset:20480
    ds_read_b64_tr_b16 v[200:201], v234 offset:16384
    ds_read_b64_tr_b16 v[202:203], v234 offset:20480
    ds_read_b64_tr_b16 v[204:205], v235 offset:16384
    ds_read_b64_tr_b16 v[206:207], v235 offset:20480
    s_waitcnt lgkmcnt(6)
    v_mfma_f32_16x16x32_bf16 a[64:67], v[192:195], v[216:219], a[64:67]
    ds_read_b64_tr_b16 v[208:209], v236 offset:16384
    ds_read_b64_tr_b16 v[210:211], v236 offset:20480
    v_mfma_f32_16x16x32_bf16 a[68:71], v[192:195], v[220:223], a[68:71]
    s_waitcnt lgkmcnt(6)
    v_mfma_f32_16x16x32_bf16 a[72:75], v[196:199], v[216:219], a[72:75]
    ds_read_b64_tr_b16 v[212:213], v237 offset:16384
    ds_read_b64_tr_b16 v[214:215], v237 offset:20480
    v_mfma_f32_16x16x32_bf16 a[76:79], v[196:199], v[220:223], a[76:79]
    s_waitcnt lgkmcnt(6)
    v_mfma_f32_16x16x32_bf16 a[80:83], v[200:203], v[216:219], a[80:83]
    ds_read_b64_tr_b16 v[192:193], v238 offset:16384
    ds_read_b64_tr_b16 v[194:195], v238 offset:20480
    v_mfma_f32_16x16x32_bf16 a[84:87], v[200:203], v[220:223], a[84:87]
    s_waitcnt lgkmcnt(6)
    v_mfma_f32_16x16x32_bf16 a[88:91], v[204:207], v[216:219], a[88:91]
    ds_read_b64_tr_b16 v[196:197], v239 offset:16384
    ds_read_b64_tr_b16 v[198:199], v239 offset:20480
    v_mfma_f32_16x16x32_bf16 a[92:95], v[204:207], v[220:223], a[92:95]
    s_waitcnt lgkmcnt(6)
    v_mfma_f32_16x16x32_bf16 a[96:99], v[208:211], v[216:219], a[96:99]
    ds_read_b64_tr_b16 v[200:201], v232 offset:24576
    ds_read_b64_tr_b16 v[202:203], v232 offset:28672
    v_mfma_f32_16x16x32_bf16 a[100:103], v[208:211], v[220:223], a[100:103]
    s_waitcnt lgkmcnt(6)
    v_mfma_f32_16x16x32_bf16 a[104:107], v[212:215], v[216:219], a[104:107]
    ds_read_b64_tr_b16 v[204:205], v233 offset:24576
    ds_read_b64_tr_b16 v[206:207], v233 offset:28672
    v_mfma_f32_16x16x32_bf16 a[108:111], v[212:215], v[220:223], a[108:111]
    s_waitcnt lgkmcnt(6)
    v_mfma_f32_16x16x32_bf16 a[112:115], v[192:195], v[216:219], a[112:115]
    ds_read_b64_tr_b16 v[208:209], v234 offset:24576
    ds_read_b64_tr_b16 v[210:211], v234 offset:28672
    v_mfma_f32_16x16x32_bf16 a[116:119], v[192:195], v[220:223], a[116:119]
    s_waitcnt lgkmcnt(6)
    v_mfma_f32_16x16x32_bf16 a[120:123], v[196:199], v[216:219], a[120:123]
    ds_read_b64_tr_b16 v[212:213], v235 offset:24576
    ds_read_b64_tr_b16 v[214:215], v235 offset:28672
    v_mfma_f32_16x16x32_bf16 a[124:127], v[196:199], v[220:223], a[124:127]
    s_waitcnt lgkmcnt(6)
    v_mfma_f32_16x16x32_bf16 a[64:67], v[200:203], v[224:227], a[64:67]
    ds_read_b64_tr_b16 v[192:193], v236 offset:24576
    ds_read_b64_tr_b16 v[194:195], v236 offset:28672
    v_mfma_f32_16x16x32_bf16 a[68:71], v[200:203], v[228:231], a[68:71]
    s_waitcnt lgkmcnt(6)
    v_mfma_f32_16x16x32_bf16 a[72:75], v[204:207], v[224:227], a[72:75]
    ds_read_b64_tr_b16 v[196:197], v237 offset:24576
    ds_read_b64_tr_b16 v[198:199], v237 offset:28672
    v_mfma_f32_16x16x32_bf16 a[76:79], v[204:207], v[228:231], a[76:79]
    s_waitcnt lgkmcnt(6)
    v_mfma_f32_16x16x32_bf16 a[80:83], v[208:211], v[224:227], a[80:83]
    ds_read_b64_tr_b16 v[200:201], v238 offset:24576
    ds_read_b64_tr_b16 v[202:203], v238 offset:28672
    v_mfma_f32_16x16x32_bf16 a[84:87], v[208:211], v[228:231], a[84:87]
    s_waitcnt lgkmcnt(6)
    v_mfma_f32_16x16x32_bf16 a[88:91], v[212:215], v[224:227], a[88:91]
    ds_read_b64_tr_b16 v[204:205], v239 offset:24576
    ds_read_b64_tr_b16 v[206:207], v239 offset:28672
    v_mfma_f32_16x16x32_bf16 a[92:95], v[212:215], v[228:231], a[92:95]
    s_waitcnt lgkmcnt(6)
    v_mfma_f32_16x16x32_bf16 a[96:99], v[192:195], v[224:227], a[96:99]
    v_mfma_f32_16x16x32_bf16 a[100:103], v[192:195], v[228:231], a[100:103]
    s_waitcnt lgkmcnt(4)
    v_mfma_f32_16x16x32_bf16 a[104:107], v[196:199], v[224:227], a[104:107]
    v_mfma_f32_16x16x32_bf16 a[108:111], v[196:199], v[228:231], a[108:111]
    s_waitcnt lgkmcnt(2)
    v_mfma_f32_16x16x32_bf16 a[112:115], v[200:203], v[224:227], a[112:115]
    v_mfma_f32_16x16x32_bf16 a[116:119], v[200:203], v[228:231], a[116:119]
    s_waitcnt lgkmcnt(0)
    v_mfma_f32_16x16x32_bf16 a[120:123], v[204:207], v[224:227], a[120:123]
    v_mfma_f32_16x16x32_bf16 a[124:127], v[204:207], v[228:231], a[124:127]
    s_waitcnt vmcnt(8)
    s_waitcnt lgkmcnt(0)
    s_barrier
    s_add_u32 m0, s28, 16384
    s_add_u32 s29, s40, 229504
    buffer_load_dwordx4 v240, s[12:15], s29 offen lds
    s_add_u32 m0, s28, 20480
    s_add_u32 s29, s40, 344192
    buffer_load_dwordx4 v240, s[12:15], s29 offen lds
    s_add_u32 m0, s28, 24576
    s_add_u32 s29, s40, 229504
    buffer_load_dwordx4 v240, s[16:19], s29 offen lds
    s_add_u32 m0, s28, 28672
    s_add_u32 s29, s40, 344192
    buffer_load_dwordx4 v240, s[16:19], s29 offen lds
    ds_read_b64_tr_b16 v[192:193], v232 offset:32768
    ds_read_b64_tr_b16 v[194:195], v232 offset:36864
    ds_read_b64_tr_b16 v[196:197], v233 offset:32768
    ds_read_b64_tr_b16 v[198:199], v233 offset:36864
    ds_read_b64_tr_b16 v[200:201], v234 offset:32768
    ds_read_b64_tr_b16 v[202:203], v234 offset:36864
    ds_read_b64_tr_b16 v[204:205], v235 offset:32768
    ds_read_b64_tr_b16 v[206:207], v235 offset:36864
    s_waitcnt lgkmcnt(6)
    v_mfma_f32_16x16x32_bf16 a[128:131], v[192:195], v[216:219], a[128:131]
    ds_read_b64_tr_b16 v[208:209], v236 offset:32768
    ds_read_b64_tr_b16 v[210:211], v236 offset:36864
    v_mfma_f32_16x16x32_bf16 a[132:135], v[192:195], v[220:223], a[132:135]
    s_waitcnt lgkmcnt(6)
    v_mfma_f32_16x16x32_bf16 a[136:139], v[196:199], v[216:219], a[136:139]
    ds_read_b64_tr_b16 v[212:213], v237 offset:32768
    ds_read_b64_tr_b16 v[214:215], v237 offset:36864
    v_mfma_f32_16x16x32_bf16 a[140:143], v[196:199], v[220:223], a[140:143]
    s_waitcnt lgkmcnt(6)
    v_mfma_f32_16x16x32_bf16 a[144:147], v[200:203], v[216:219], a[144:147]
    ds_read_b64_tr_b16 v[192:193], v238 offset:32768
    ds_read_b64_tr_b16 v[194:195], v238 offset:36864
    v_mfma_f32_16x16x32_bf16 a[148:151], v[200:203], v[220:223], a[148:151]
    s_waitcnt lgkmcnt(6)
    v_mfma_f32_16x16x32_bf16 a[152:155], v[204:207], v[216:219], a[152:155]
    ds_read_b64_tr_b16 v[196:197], v239 offset:32768
    ds_read_b64_tr_b16 v[198:199], v239 offset:36864
    v_mfma_f32_16x16x32_bf16 a[156:159], v[204:207], v[220:223], a[156:159]
    s_waitcnt lgkmcnt(6)
    v_mfma_f32_16x16x32_bf16 a[160:163], v[208:211], v[216:219], a[160:163]
    ds_read_b64_tr_b16 v[200:201], v232 offset:40960
    ds_read_b64_tr_b16 v[202:203], v232 offset:45056
    v_mfma_f32_16x16x32_bf16 a[164:167], v[208:211], v[220:223], a[164:167]
    s_waitcnt lgkmcnt(6)
    v_mfma_f32_16x16x32_bf16 a[168:171], v[212:215], v[216:219], a[168:171]
    ds_read_b64_tr_b16 v[204:205], v233 offset:40960
    ds_read_b64_tr_b16 v[206:207], v233 offset:45056
    v_mfma_f32_16x16x32_bf16 a[172:175], v[212:215], v[220:223], a[172:175]
    s_waitcnt lgkmcnt(6)
    v_mfma_f32_16x16x32_bf16 a[176:179], v[192:195], v[216:219], a[176:179]
    ds_read_b64_tr_b16 v[208:209], v234 offset:40960
    ds_read_b64_tr_b16 v[210:211], v234 offset:45056
    v_mfma_f32_16x16x32_bf16 a[180:183], v[192:195], v[220:223], a[180:183]
    s_waitcnt lgkmcnt(6)
    v_mfma_f32_16x16x32_bf16 a[184:187], v[196:199], v[216:219], a[184:187]
    ds_read_b64_tr_b16 v[212:213], v235 offset:40960
    ds_read_b64_tr_b16 v[214:215], v235 offset:45056
    v_mfma_f32_16x16x32_bf16 a[188:191], v[196:199], v[220:223], a[188:191]
    s_waitcnt lgkmcnt(6)
    v_mfma_f32_16x16x32_bf16 a[128:131], v[200:203], v[224:227], a[128:131]
    ds_read_b64_tr_b16 v[192:193], v236 offset:40960
    ds_read_b64_tr_b16 v[194:195], v236 offset:45056
    v_mfma_f32_16x16x32_bf16 a[132:135], v[200:203], v[228:231], a[132:135]
    s_waitcnt lgkmcnt(6)
    v_mfma_f32_16x16x32_bf16 a[136:139], v[204:207], v[224:227], a[136:139]
    ds_read_b64_tr_b16 v[196:197], v237 offset:40960
    ds_read_b64_tr_b16 v[198:199], v237 offset:45056
    v_mfma_f32_16x16x32_bf16 a[140:143], v[204:207], v[228:231], a[140:143]
    s_waitcnt lgkmcnt(6)
    v_mfma_f32_16x16x32_bf16 a[144:147], v[208:211], v[224:227], a[144:147]
    ds_read_b64_tr_b16 v[200:201], v238 offset:40960
    ds_read_b64_tr_b16 v[202:203], v238 offset:45056
    v_mfma_f32_16x16x32_bf16 a[148:151], v[208:211], v[228:231], a[148:151]
    s_waitcnt lgkmcnt(6)
    v_mfma_f32_16x16x32_bf16 a[152:155], v[212:215], v[224:227], a[152:155]
    ds_read_b64_tr_b16 v[204:205], v239 offset:40960
    ds_read_b64_tr_b16 v[206:207], v239 offset:45056
    v_mfma_f32_16x16x32_bf16 a[156:159], v[212:215], v[228:231], a[156:159]
    s_waitcnt lgkmcnt(6)
    v_mfma_f32_16x16x32_bf16 a[160:163], v[192:195], v[224:227], a[160:163]
    v_mfma_f32_16x16x32_bf16 a[164:167], v[192:195], v[228:231], a[164:167]
    s_waitcnt lgkmcnt(4)
    v_mfma_f32_16x16x32_bf16 a[168:171], v[196:199], v[224:227], a[168:171]
    v_mfma_f32_16x16x32_bf16 a[172:175], v[196:199], v[228:231], a[172:175]
    s_waitcnt lgkmcnt(2)
    v_mfma_f32_16x16x32_bf16 a[176:179], v[200:203], v[224:227], a[176:179]
    v_mfma_f32_16x16x32_bf16 a[180:183], v[200:203], v[228:231], a[180:183]
    s_waitcnt lgkmcnt(0)
    v_mfma_f32_16x16x32_bf16 a[184:187], v[204:207], v[224:227], a[184:187]
    v_mfma_f32_16x16x32_bf16 a[188:191], v[204:207], v[228:231], a[188:191]
    s_waitcnt vmcnt(8)
    s_waitcnt lgkmcnt(0)
    s_barrier
    s_add_u32 m0, s28, 32768
    s_add_u32 s29, s40, 458880
    buffer_load_dwordx4 v240, s[12:15], s29 offen lds
    s_add_u32 m0, s28, 36864
    s_add_u32 s29, s40, 573568
    buffer_load_dwordx4 v240, s[12:15], s29 offen lds
    s_add_u32 m0, s28, 40960
    s_add_u32 s29, s40, 458880
    buffer_load_dwordx4 v240, s[16:19], s29 offen lds
    s_add_u32 m0, s28, 45056
    s_add_u32 s29, s40, 573568
    buffer_load_dwordx4 v240, s[16:19], s29 offen lds
    ds_read_b64_tr_b16 v[192:193], v232 offset:49152
    ds_read_b64_tr_b16 v[194:195], v232 offset:53248
    ds_read_b64_tr_b16 v[196:197], v233 offset:49152
    ds_read_b64_tr_b16 v[198:199], v233 offset:53248
    ds_read_b64_tr_b16 v[200:201], v234 offset:49152
    ds_read_b64_tr_b16 v[202:203], v234 offset:53248
    ds_read_b64_tr_b16 v[204:205], v235 offset:49152
    ds_read_b64_tr_b16 v[206:207], v235 offset:53248
    s_waitcnt lgkmcnt(6)
    v_mfma_f32_16x16x32_bf16 a[192:195], v[192:195], v[216:219], a[192:195]
    ds_read_b64_tr_b16 v[208:209], v236 offset:49152
    ds_read_b64_tr_b16 v[210:211], v236 offset:53248
    v_mfma_f32_16x16x32_bf16 a[196:199], v[192:195], v[220:223], a[196:199]
    s_waitcnt lgkmcnt(6)
    v_mfma_f32_16x16x32_bf16 a[200:203], v[196:199], v[216:219], a[200:203]
    ds_read_b64_tr_b16 v[212:213], v237 offset:49152
    ds_read_b64_tr_b16 v[214:215], v237 offset:53248
    v_mfma_f32_16x16x32_bf16 a[204:207], v[196:199], v[220:223], a[204:207]
    s_waitcnt lgkmcnt(6)
    v_mfma_f32_16x16x32_bf16 a[208:211], v[200:203], v[216:219], a[208:211]
    ds_read_b64_tr_b16 v[192:193], v238 offset:49152
    ds_read_b64_tr_b16 v[194:195], v238 offset:53248
    v_mfma_f32_16x16x32_bf16 a[212:215], v[200:203], v[220:223], a[212:215]
    s_waitcnt lgkmcnt(6)
    v_mfma_f32_16x16x32_bf16 a[216:219], v[204:207], v[216:219], a[216:219]
    ds_read_b64_tr_b16 v[196:197], v239 offset:49152
    ds_read_b64_tr_b16 v[198:199], v239 offset:53248
    v_mfma_f32_16x16x32_bf16 a[220:223], v[204:207], v[220:223], a[220:223]
    s_waitcnt lgkmcnt(6)
    v_mfma_f32_16x16x32_bf16 a[224:227], v[208:211], v[216:219], a[224:227]
    ds_read_b64_tr_b16 v[200:201], v232 offset:57344
    ds_read_b64_tr_b16 v[202:203], v232 offset:61440
    v_mfma_f32_16x16x32_bf16 a[228:231], v[208:211], v[220:223], a[228:231]
    s_waitcnt lgkmcnt(6)
    v_mfma_f32_16x16x32_bf16 a[232:235], v[212:215], v[216:219], a[232:235]
    ds_read_b64_tr_b16 v[204:205], v233 offset:57344
    ds_read_b64_tr_b16 v[206:207], v233 offset:61440
    v_mfma_f32_16x16x32_bf16 a[236:239], v[212:215], v[220:223], a[236:239]
    s_waitcnt lgkmcnt(6)
    v_mfma_f32_16x16x32_bf16 a[240:243], v[192:195], v[216:219], a[240:243]
    ds_read_b64_tr_b16 v[208:209], v234 offset:57344
    ds_read_b64_tr_b16 v[210:211], v234 offset:61440
    v_mfma_f32_16x16x32_bf16 a[244:247], v[192:195], v[220:223], a[244:247]
    s_waitcnt lgkmcnt(6)
    v_mfma_f32_16x16x32_bf16 a[248:251], v[196:199], v[216:219], a[248:251]
    ds_read_b64_tr_b16 v[212:213], v235 offset:57344
    ds_read_b64_tr_b16 v[214:215], v235 offset:61440
    v_mfma_f32_16x16x32_bf16 a[252:255], v[196:199], v[220:223], a[252:255]
    s_waitcnt lgkmcnt(6)
    v_mfma_f32_16x16x32_bf16 a[192:195], v[200:203], v[224:227], a[192:195]
    ds_read_b64_tr_b16 v[192:193], v236 offset:57344
    ds_read_b64_tr_b16 v[194:195], v236 offset:61440
    v_mfma_f32_16x16x32_bf16 a[196:199], v[200:203], v[228:231], a[196:199]
    s_waitcnt lgkmcnt(6)
    v_mfma_f32_16x16x32_bf16 a[200:203], v[204:207], v[224:227], a[200:203]
    ds_read_b64_tr_b16 v[196:197], v237 offset:57344
    ds_read_b64_tr_b16 v[198:199], v237 offset:61440
    v_mfma_f32_16x16x32_bf16 a[204:207], v[204:207], v[228:231], a[204:207]
    s_waitcnt lgkmcnt(6)
    v_mfma_f32_16x16x32_bf16 a[208:211], v[208:211], v[224:227], a[208:211]
    ds_read_b64_tr_b16 v[200:201], v238 offset:57344
    ds_read_b64_tr_b16 v[202:203], v238 offset:61440
    v_mfma_f32_16x16x32_bf16 a[212:215], v[208:211], v[228:231], a[212:215]
    s_waitcnt lgkmcnt(6)
    v_mfma_f32_16x16x32_bf16 a[216:219], v[212:215], v[224:227], a[216:219]
    ds_read_b64_tr_b16 v[204:205], v239 offset:57344
    ds_read_b64_tr_b16 v[206:207], v239 offset:61440
    v_mfma_f32_16x16x32_bf16 a[220:223], v[212:215], v[228:231], a[220:223]
    s_waitcnt lgkmcnt(6)
    v_mfma_f32_16x16x32_bf16 a[224:227], v[192:195], v[224:227], a[224:227]
    v_mfma_f32_16x16x32_bf16 a[228:231], v[192:195], v[228:231], a[228:231]
    s_waitcnt lgkmcnt(4)
    v_mfma_f32_16x16x32_bf16 a[232:235], v[196:199], v[224:227], a[232:235]
    v_mfma_f32_16x16x32_bf16 a[236:239], v[196:199], v[228:231], a[236:239]
    s_waitcnt lgkmcnt(2)
    v_mfma_f32_16x16x32_bf16 a[240:243], v[200:203], v[224:227], a[240:243]
    v_mfma_f32_16x16x32_bf16 a[244:247], v[200:203], v[228:231], a[244:247]
    s_waitcnt lgkmcnt(0)
    v_mfma_f32_16x16x32_bf16 a[248:251], v[204:207], v[224:227], a[248:251]
    v_mfma_f32_16x16x32_bf16 a[252:255], v[204:207], v[228:231], a[252:255]
    s_add_u32 s40, s40, 128
    s_add_u32 s41, s41, 65536
    s_cmp_lt_u32 s40, 512
    s_nop 4
    s_cbranch_scc1 Lffg_130
    s_lshl_b32 s30, s4, 2
    s_add_u32 s30, s30, s3
    s_lshl_b32 s30, s30, 16
    s_lshl_b32 s20, s5, 22
    s_add_u32 s30, s30, s20
    s_add_u32 s30, s30, 83886080
    buffer_store_dwordx4 a[0:3], v242, s[8:11], s30 offen offset:0 sc1
    buffer_store_dwordx4 a[4:7], v242, s[8:11], s30 offen offset:1024 sc1
    buffer_store_dwordx4 a[8:11], v242, s[8:11], s30 offen offset:2048 sc1
    buffer_store_dwordx4 a[12:15], v242, s[8:11], s30 offen offset:3072 sc1
    s_add_u32 s30, s30, 4096
    buffer_store_dwordx4 a[16:19], v242, s[8:11], s30 offen offset:0 sc1
    buffer_store_dwordx4 a[20:23], v242, s[8:11], s30 offen offset:1024 sc1
    buffer_store_dwordx4 a[24:27], v242, s[8:11], s30 offen offset:2048 sc1
    buffer_store_dwordx4 a[28:31], v242, s[8:11], s30 offen offset:3072 sc1
    s_add_u32 s30, s30, 4096
    buffer_store_dwordx4 a[32:35], v242, s[8:11], s30 offen offset:0 sc1
    buffer_store_dwordx4 a[36:39], v242, s[8:11], s30 offen offset:1024 sc1
    buffer_store_dwordx4 a[40:43], v242, s[8:11], s30 offen offset:2048 sc1
    buffer_store_dwordx4 a[44:47], v242, s[8:11], s30 offen offset:3072 sc1
    s_add_u32 s30, s30, 4096
    buffer_store_dwordx4 a[48:51], v242, s[8:11], s30 offen offset:0 sc1
    buffer_store_dwordx4 a[52:55], v242, s[8:11], s30 offen offset:1024 sc1
    buffer_store_dwordx4 a[56:59], v242, s[8:11], s30 offen offset:2048 sc1
    buffer_store_dwordx4 a[60:63], v242, s[8:11], s30 offen offset:3072 sc1
    s_add_u32 s30, s30, 4096
    buffer_store_dwordx4 a[64:67], v242, s[8:11], s30 offen offset:0 sc1
    buffer_store_dwordx4 a[68:71], v242, s[8:11], s30 offen offset:1024 sc1
    buffer_store_dwordx4 a[72:75], v242, s[8:11], s30 offen offset:2048 sc1
    buffer_store_dwordx4 a[76:79], v242, s[8:11], s30 offen offset:3072 sc1
    s_add_u32 s30, s30, 4096
    buffer_store_dwordx4 a[80:83], v242, s[8:11], s30 offen offset:0 sc1
    buffer_store_dwordx4 a[84:87], v242, s[8:11], s30 offen offset:1024 sc1
    buffer_store_dwordx4 a[88:91], v242, s[8:11], s30 offen offset:2048 sc1
    buffer_store_dwordx4 a[92:95], v242, s[8:11], s30 offen offset:3072 sc1
    s_add_u32 s30, s30, 4096
    buffer_store_dwordx4 a[96:99], v242, s[8:11], s30 offen offset:0 sc1
    buffer_store_dwordx4 a[100:103], v242, s[8:11], s30 offen offset:1024 sc1
    buffer_store_dwordx4 a[104:107], v242, s[8:11], s30 offen offset:2048 sc1
    buffer_store_dwordx4 a[108:111], v242, s[8:11], s30 offen offset:3072 sc1
    s_add_u32 s30, s30, 4096
    buffer_store_dwordx4 a[112:115], v242, s[8:11], s30 offen offset:0 sc1
    buffer_store_dwordx4 a[116:119], v242, s[8:11], s30 offen offset:1024 sc1
    buffer_store_dwordx4 a[120:123], v242, s[8:11], s30 offen offset:2048 sc1
    buffer_store_dwordx4 a[124:127], v242, s[8:11], s30 offen offset:3072 sc1
    s_add_u32 s30, s30, 4096
    buffer_store_dwordx4 a[128:131], v242, s[8:11], s30 offen offset:0 sc1
    buffer_store_dwordx4 a[132:135], v242, s[8:11], s30 offen offset:1024 sc1
    buffer_store_dwordx4 a[136:139], v242, s[8:11], s30 offen offset:2048 sc1
    buffer_store_dwordx4 a[140:143], v242, s[8:11], s30 offen offset:3072 sc1
    s_add_u32 s30, s30, 4096
    buffer_store_dwordx4 a[144:147], v242, s[8:11], s30 offen offset:0 sc1
    buffer_store_dwordx4 a[148:151], v242, s[8:11], s30 offen offset:1024 sc1
    buffer_store_dwordx4 a[152:155], v242, s[8:11], s30 offen offset:2048 sc1
    buffer_store_dwordx4 a[156:159], v242, s[8:11], s30 offen offset:3072 sc1
    s_add_u32 s30, s30, 4096
    buffer_store_dwordx4 a[160:163], v242, s[8:11], s30 offen offset:0 sc1
    buffer_store_dwordx4 a[164:167], v242, s[8:11], s30 offen offset:1024 sc1
    buffer_store_dwordx4 a[168:171], v242, s[8:11], s30 offen offset:2048 sc1
    buffer_store_dwordx4 a[172:175], v242, s[8:11], s30 offen offset:3072 sc1
    s_add_u32 s30, s30, 4096
    buffer_store_dwordx4 a[176:179], v242, s[8:11], s30 offen offset:0 sc1
    buffer_store_dwordx4 a[180:183], v242, s[8:11], s30 offen offset:1024 sc1
    buffer_store_dwordx4 a[184:187], v242, s[8:11], s30 offen offset:2048 sc1
    buffer_store_dwordx4 a[188:191], v242, s[8:11], s30 offen offset:3072 sc1
    s_add_u32 s30, s30, 4096
    buffer_store_dwordx4 a[192:195], v242, s[8:11], s30 offen offset:0 sc1
    buffer_store_dwordx4 a[196:199], v242, s[8:11], s30 offen offset:1024 sc1
    buffer_store_dwordx4 a[200:203], v242, s[8:11], s30 offen offset:2048 sc1
    buffer_store_dwordx4 a[204:207], v242, s[8:11], s30 offen offset:3072 sc1
    s_add_u32 s30, s30, 4096
    buffer_store_dwordx4 a[208:211], v242, s[8:11], s30 offen offset:0 sc1
    buffer_store_dwordx4 a[212:215], v242, s[8:11], s30 offen offset:1024 sc1
    buffer_store_dwordx4 a[216:219], v242, s[8:11], s30 offen offset:2048 sc1
    buffer_store_dwordx4 a[220:223], v242, s[8:11], s30 offen offset:3072 sc1
    s_add_u32 s30, s30, 4096
    buffer_store_dwordx4 a[224:227], v242, s[8:11], s30 offen offset:0 sc1
    buffer_store_dwordx4 a[228:231], v242, s[8:11], s30 offen offset:1024 sc1
    buffer_store_dwordx4 a[232:235], v242, s[8:11], s30 offen offset:2048 sc1
    buffer_store_dwordx4 a[236:239], v242, s[8:11], s30 offen offset:3072 sc1
    s_add_u32 s30, s30, 4096
    buffer_store_dwordx4 a[240:243], v242, s[8:11], s30 offen offset:0 sc1
    buffer_store_dwordx4 a[244:247], v242, s[8:11], s30 offen offset:1024 sc1
    buffer_store_dwordx4 a[248:251], v242, s[8:11], s30 offen offset:2048 sc1
    buffer_store_dwordx4 a[252:255], v242, s[8:11], s30 offen offset:3072 sc1
    s_waitcnt vmcnt(0)
    s_barrier
    s_lshl_b32 s92, s4, 7
    s_add_u32 s92, s92, 131076096
    s_branch Lm_wsig
Lm_wexit:
Lm_exit:
    s_endpgm
Lm_code_end:
.section .rodata,"a"
.p2align 6
.amdhsa_kernel parallel_sum__memory_aug_recurrent_mem_tr__glu_gated_geglu__prompt_kernel
  .amdhsa_next_free_vgpr 512
  .amdhsa_next_free_sgpr 102
  .amdhsa_accum_offset 256
  .amdhsa_group_segment_fixed_size 0
  .amdhsa_kernarg_size 112
  .amdhsa_user_sgpr_count 2
  .amdhsa_user_sgpr_kernarg_segment_ptr 1
  .amdhsa_system_sgpr_workgroup_id_x 1
.end_amdhsa_kernel
```
